```python
import torch

def _softmax(x, axis=-1):
    return torch.softmax(x, dim=axis)
def _gelu(x):
    return torch.nn.functional.gelu(x, approximate="tanh")
def _silu(x):
    return torch.nn.functional.silu(x)
def _sigmoid(x):
    return torch.sigmoid(x)
def _layernorm(x, axis=-1, eps=1e-5):
    m = x.mean(dim=axis, keepdim=True)
    v = x.var(dim=axis, keepdim=True, unbiased=False)
    return (x - m) / torch.sqrt(v + eps)
def _scatter_add(tgt, idx, src, axis=0):
    return tgt.clone().index_add_(axis, idx, src)
def _segment_sum(src, seg, n):
    out = torch.zeros((n,) + src.shape[1:], dtype=src.dtype)
    return out.index_add_(0, seg, src)
def _pad(x, pw):
    flat = tuple(v for pair in reversed(pw) for v in pair)
    return torch.nn.functional.pad(x, flat)

kernel_name = 'gated_mix__gqa_block_cached__dense_activation_mish__decode'

def setup_inputs():

    _w = (lambda a: (lambda t: t.to(torch.bfloat16) if t.is_floating_point() else t)(torch.as_tensor(a)))
    def _A_setup():
        B, Sq, D = 2, 1, 640
        Hq, Hkv, Sk, Dh = 32, 32, 4096, 192
        assert Hq % Hkv == 0, (Hq, Hkv)
        return {
            "x": _w((lambda *s: torch.randn(*s, dtype=torch.bfloat16) * 0.05)(B, Sq, D)),
            "k_cache": _w((lambda *s: torch.randn(*s, dtype=torch.bfloat16) * 6.4)(B, Hkv, Sk, Dh)),
            "v_cache": _w((lambda *s: torch.randn(*s, dtype=torch.bfloat16) * 0.1)(B, Hkv, Sk, Dh)),
            "wq": _w((lambda *s: torch.randn(*s, dtype=torch.bfloat16) * 6.4)(D, Hq * Dh) * (D ** -0.5)),
            "wo": _w((lambda *s: torch.randn(*s, dtype=torch.bfloat16) * 0.1)(Hq * Dh, D) * ((Hq * Dh) ** -0.5)),
        }
    _A_in = _A_setup()

    def _B_setup():
        B, S, D, F = 2, 1, 640, 1536
        return {
            "x": _w((lambda *s: torch.randn(*s, dtype=torch.bfloat16) * 0.05)(B, S, D)),
            "w1": _w((lambda *s: torch.randn(*s, dtype=torch.bfloat16) * 3.2)(D, F) * (D ** -0.5)),
            "b1": _w((lambda *s: torch.randn(*s, dtype=torch.bfloat16) * 0.05)(F)),
            "w2": _w((lambda *s: torch.randn(*s, dtype=torch.bfloat16) * 0.05)(F, D) * (F ** -0.5)),
        }
    _B_in = _B_setup()

    return {
        "A_x": _A_in["x"],
        "A_k_cache": _A_in["k_cache"],
        "A_v_cache": _A_in["v_cache"],
        "A_wq": _A_in["wq"],
        "A_wo": _A_in["wo"],
        "B_x": _B_in["x"],
        "B_w1": _B_in["w1"],
        "B_b1": _B_in["b1"],
        "B_w2": _B_in["w2"],
        "gate_w": _w((lambda *s: torch.randn(*s, dtype=torch.bfloat16) * 0.05)(640) * 16.0),
    }

def reference(A_x, A_k_cache, A_v_cache, A_wq, A_wo, B_x, B_w1, B_b1, B_w2, gate_w):
    def _A_ref(x, k_cache, v_cache, wq, wo):
        B, Sq, D = x.shape
        Hq, Dh = 32, 192
        Hkv = k_cache.shape[1]
        rep = Hq // Hkv
        q = (lambda x, *d: x.permute(*d))((x @ wq).reshape(B, Sq, Hq, Dh), 0, 2, 1, 3)
        k = (lambda x, n, axis: torch.repeat_interleave(x, n, dim=axis))(k_cache, rep, axis=1)
        v = (lambda x, n, axis: torch.repeat_interleave(x, n, dim=axis))(v_cache, rep, axis=1)
        scores = torch.einsum("bhqd,bhkd->bhqk", q, k) * (Dh ** -0.5)
        p = _softmax(scores, axis=-1)
        o = torch.einsum("bhqk,bhkd->bhqd", p, v)
        return (lambda x, *d: x.permute(*d))(o, 0, 2, 1, 3).reshape(B, Sq, Hq * Dh) @ wo

    def _B_ref(x, w1, b1, w2):
        h = torch.einsum("bsd,df->bsf", x, w1) + b1
        sp = torch.log1p(torch.exp(-torch.abs(h))) + torch.where(h > 0, h, torch.zeros_like(h))
        act = h * torch.tanh(sp)
        return torch.einsum("bsf,fd->bsd", act, w2)

    x = A_x
    g = _sigmoid((x * gate_w).sum(-1, keepdims=True))
    a = _A_ref(x, A_k_cache, A_v_cache, A_wq, A_wo)
    b = _B_ref(x, B_w1, B_b1, B_w2)
    return g * a + (1 - g) * b
```

```asm
; @launch grid=(256,1,1) block=(512,1,1) lds=117248
.amdgcn_target "amdgcn-amd-amdhsa--gfx950"
.text
.globl gated_mix__gqa_block_cached__dense_activation_mish__decode_kernel
.p2align 8
.type gated_mix__gqa_block_cached__dense_activation_mish__decode_kernel,@function
gated_mix__gqa_block_cached__dense_activation_mish__decode_kernel:
    s_load_dwordx16 s[4:19], s[0:1], 0
    s_load_dwordx8 s[20:27], s[0:1], 64
    s_load_dwordx2 s[28:29], s[0:1], 96
    v_readfirstlane_b32 s3, v0
    s_cmp_ge_u32 s2, 256
    s_cbranch_scc1 L_exit
    s_and_b32 s30, s2, 7
    s_lshr_b32 s31, s2, 3
    s_lshr_b32 s3, s3, 6
    s_cmp_ge_u32 s3, 4
    s_cbranch_scc1 L_aux
    s_lshr_b32 s53, s31, 1
    s_mul_i32 s52, s31, 43
    s_lshr_b32 s52, s52, 8
    s_mul_i32 s54, s52, 3
    s_sub_u32 s53, s53, s54
    s_mul_i32 s54, s52, 1
    s_add_u32 s54, s54, s30
    s_and_b32 s54, s54, 7
    s_lshl3_add_u32 s54, s52, s54
    s_cmp_ge_u32 s52, 4
    s_cselect_b32 s54, s30, s54
    s_movk_i32 s62, 12288
    s_cselect_b32 s62, 3072, s62
    s_mul_i32 s54, s54, 384
    s_lshl_b32 s53, s53, 7
    s_add_u32 s64, s54, s53
    s_and_b32 s53, s31, 1
    s_lshl2_add_u32 s53, s53, s3
    s_mul_i32 s53, s53, 80
    s_mul_i32 s54, s53, s62
    s_add_u32 s64, s64, s54
    v_bfe_u32 v6, v0, 3, 3
    v_and_b32 v253, 7, v0
    v_and_b32 v7, 6, v6
    v_xor_b32 v7, v253, v7
    v_lshlrev_b32 v7, 4, v7
    v_mad_u32_u24 v10, v6, s62, v7
    s_mul_i32 s46, s62, 640
    s_cmp_lt_u32 s31, 30
    s_cselect_b32 s46, s46, 0
    s_mov_b32 s47, 0x20000
    s_lshl_b32 s62, s62, 3
    s_mul_i32 s63, s3, 10240
    s_add_u32 s63, s63, 75008
    s_mov_b32 m0, s63
    s_cmp_ge_u32 s52, 4
    s_waitcnt lgkmcnt(0)
    s_cselect_b64 s[44:45], s[16:17], s[10:11]
    buffer_load_dwordx4 v10, s[44:47], s64 offen nt lds
    s_add_u32 m0, s63, 1024
    s_add_u32 s64, s64, s62
    buffer_load_dwordx4 v10, s[44:47], s64 offen nt lds
    s_add_u32 m0, s63, 2048
    s_add_u32 s64, s64, s62
    buffer_load_dwordx4 v10, s[44:47], s64 offen nt lds
    s_add_u32 m0, s63, 3072
    s_add_u32 s64, s64, s62
    buffer_load_dwordx4 v10, s[44:47], s64 offen nt lds
    s_add_u32 m0, s63, 4096
    s_add_u32 s64, s64, s62
    buffer_load_dwordx4 v10, s[44:47], s64 offen nt lds
    s_add_u32 m0, s63, 5120
    s_add_u32 s64, s64, s62
    buffer_load_dwordx4 v10, s[44:47], s64 offen nt lds
    s_add_u32 m0, s63, 6144
    s_add_u32 s64, s64, s62
    buffer_load_dwordx4 v10, s[44:47], s64 offen nt lds
    s_add_u32 m0, s63, 7168
    s_add_u32 s64, s64, s62
    buffer_load_dwordx4 v10, s[44:47], s64 offen nt lds
    s_add_u32 m0, s63, 8192
    s_add_u32 s64, s64, s62
    buffer_load_dwordx4 v10, s[44:47], s64 offen nt lds
    s_add_u32 m0, s63, 9216
    s_add_u32 s64, s64, s62
    buffer_load_dwordx4 v10, s[44:47], s64 offen nt lds
    s_branch L_str
L_aux:
    v_and_b32 v0, 63, v0
    v_cmp_eq_u32 vcc, 1, v0
    v_lshlrev_b32 v12, 2, v0
    v_mov_b32 v2, 0
    v_mov_b32 v3, 1
    v_cndmask_b32 v14, 0, 5, vcc
    ds_write_b32 v12, v14 offset:0
    s_sub_u32 s51, s3, 4
    s_getpc_b64 s[94:95]
L_pc:
    s_sub_u32 s94, s94, L_pc-gated_mix__gqa_block_cached__dense_activation_mish__decode_kernel
    s_subb_u32 s95, s95, 0
    s_lshl2_add_u32 s52, s31, s51
    s_lshl_b32 s52, s52, 10
    v_lshl_add_u32 v20, v0, 4, s52
    v_mov_b32 v23, s95
    v_add_co_u32 v22, vcc, s94, v20
    s_nop 1
    v_addc_co_u32 v23, vcc, 0, v23, vcc
    s_mov_b32 s52, L_end-gated_mix__gqa_block_cached__dense_activation_mish__decode_kernel-16
    v_cmp_gt_u32 vcc, s52, v20
    s_and_saveexec_b64 s[92:93], vcc
    s_cbranch_execz L_noipf
    global_load_dwordx4 v[24:27], v[22:23], off
L_noipf:
    s_mov_b64 exec, -1
    s_and_b32 s53, s31, 1
    s_lshl2_add_u32 s53, s53, s51
    s_mul_i32 s53, s53, 160
    v_cmp_lt_u32 vcc, 9, v0
    v_lshlrev_b32 v11, 4, v0
    v_mov_b32 v9, 1120
    v_cndmask_b32 v9, 0, v9, vcc
    v_add_u32 v11, v11, v9
    s_mul_i32 s63, s51, 10240
    s_add_u32 s63, s63, 75008
    v_lshrrev_b32 v6, 3, v0
    s_waitcnt lgkmcnt(0)
    s_load_dword s50, s[28:29], 0
    s_mov_b32 s36, s4
    s_mov_b32 s37, s5
    s_mov_b32 s38, 2560
    s_mov_b32 s39, 0x20000
    s_mov_b32 s40, s28
    s_mov_b32 s41, s29
    s_mov_b32 s42, 402653184
    s_mov_b32 s43, 0x20000
    s_mul_i32 s58, s51, 320
    s_add_u32 s58, s58, 115968
    s_mov_b32 m0, s58
    s_mov_b64 exec, 0xfffff
    buffer_load_dwordx4 v11, s[36:39], s53 offen lds
    s_mov_b64 exec, -1
    v_and_b32 v11, 1, v0
    v_mul_u32_u24 v11, 160, v11
    v_lshrrev_b32 v9, 4, v0
    v_lshl_add_u32 v11, v9, 3, v11
    v_add_u32 v11, s58, v11
    s_barrier
    s_getreg_b32 s66, hwreg(HW_REG_XCC_ID, 0, 4)
    v_lshlrev_b32 v12, 4, v0
    s_lshl_b32 s65, s30, 14
    s_add_u32 s65, s65, 262144
    s_lshl_b32 s64, s31, 9
    s_add_u32 s64, s64, s65
    s_lshl_b32 s55, s51, 12
    s_add_u32 s65, s65, s55
    s_waitcnt lgkmcnt(0)
    s_add_u32 s50, s50, 0x9e3779b1
    s_lshr_b32 s90, s50, 12
    s_add_u32 s90, s90, s66
    s_and_b32 s90, s90, 15
    s_bfe_u32 s91, s50, 0x40000
    s_bfe_u32 s92, s50, 0x40004
    s_bfe_u32 s93, s50, 0x40008
    s_add_u32 s48, s31, 30
    s_and_b32 s48, s48, 31
    s_mul_i32 s49, s48, 43
    s_lshr_b32 s49, s49, 7
    s_mul_i32 s52, s49, 3
    s_sub_u32 s48, s48, s52
    s_sub_u32 s54, s50, 1
    v_mov_b32 v84, s54
    v_mov_b32 v85, s54
    v_mov_b32 v86, s54
    v_mov_b32 v87, s54
    v_mov_b32 v92, 0
    v_mov_b32 v93, 0
    v_mov_b32 v94, 0
    v_mov_b32 v95, 0
    v_lshrrev_b32 v15, 4, v0
    v_lshlrev_b32 v15, 13, v15
    v_and_b32 v21, 15, v0
    v_lshl_add_u32 v15, v21, 4, v15
    s_lshl2_add_u32 s54, s30, s51
    s_mul_i32 s54, s54, 96
    s_add_u32 s54, s54, s31
    s_lshl_b32 s54, s54, 8
    s_add_u32 s54, s54, 1048576
    s_lshl_b32 s55, s51, 7
    s_add_u32 s55, s55, s64
    s_mov_b64 exec, 0xff
    buffer_load_dwordx4 v[88:91], v12, s[40:43], s55 offen nt
    s_mov_b64 exec, -1
    s_mov_b32 exec_hi, 0xffff
    buffer_load_dwordx4 v[88:91], v15, s[40:43], s54 offen nt
    buffer_store_dwordx4 v[92:95], v15, s[40:43], s54 offen
    s_mov_b32 exec_hi, -1
    s_lshl_b32 s54, s30, 12
    s_lshl_b32 s55, s31, 4
    s_add_u32 s54, s54, s55
    s_lshl_b32 s55, s51, 10
    s_add_u32 s54, s54, s55
    s_add_u32 s54, s54, 131072
    v_lshlrev_b32 v21, 9, v0
    s_mov_b64 exec, 3
    buffer_load_dwordx4 v[88:91], v21, s[40:43], s54 offen nt
    buffer_store_dwordx4 v[84:87], v21, s[40:43], s54 offen
    s_mov_b64 exec, -1
    s_cmp_eq_u32 s51, 3
    s_cbranch_scc0 L_nogl
    s_cmp_lt_u32 s49, 10
    s_cbranch_scc0 L_nogl
    s_mul_i32 s53, s30, 3
    s_add_u32 s53, s53, s48
    s_mov_b32 s44, s18
    s_mov_b32 s45, s19
    s_mov_b32 s46, 3072
    s_mov_b32 s47, 0x20000
    v_and_b32 v31, 31, v0
    v_lshlrev_b32 v31, 2, v31
    s_lshl_b32 s53, s53, 7
    buffer_load_dword v180, v31, s[44:47], s53 offen
    s_cmp_eq_u32 s48, 0
    s_cbranch_scc0 L_nogl
    s_mov_b32 s32, s22
    s_mov_b32 s33, s23
    s_mov_b32 s34, 1280
    s_mov_b32 s35, 0x20000
    v_lshlrev_b32 v4, 2, v31
    v_lshrrev_b32 v5, 5, v0
    v_mul_u32_u24 v5, 1280, v5
    v_lshlrev_b32 v29, 1, v31
    v_add_u32 v28, v29, v5
    v_add_u32 v5, v4, v5
    buffer_load_dwordx4 v[160:163], v5, s[36:39], 0 offen offset:0
    buffer_load_dwordx4 v[170:173], v4, s[32:35], 0 offen offset:0
    buffer_load_dwordx4 v[164:167], v5, s[36:39], 0 offen offset:512
    buffer_load_dwordx4 v[174:177], v4, s[32:35], 0 offen offset:512
    buffer_load_dwordx2 v[168:169], v28, s[36:39], 0 offen offset:1024
    buffer_load_dwordx2 v[178:179], v29, s[32:35], 0 offen offset:1024
L_nogl:
    v_lshrrev_b32 v7, 2, v0
    v_and_b32 v8, 3, v6
    v_and_b32 v9, 3, v0
    v_lshlrev_b32 v9, 3, v9
    v_lshl_add_u32 v9, v7, 7, v9
    v_add_u32 v9, s63, v9
    v_xor_b32 v7, 0, v8
    v_lshl_add_u32 v16, v7, 5, v9
    v_xor_b32 v7, 1, v8
    v_lshl_add_u32 v17, v7, 5, v9
    v_xor_b32 v7, 2, v8
    v_lshl_add_u32 v18, v7, 5, v9
    v_xor_b32 v7, 3, v8
    v_lshl_add_u32 v19, v7, 5, v9
    s_mov_b32 s58, 0
    s_mov_b32 s59, -1
    s_mov_b32 s60, 0xffff0000
    s_mov_b32 s61, 0xffff0000
    s_lshl_b32 s52, s51, 2
    v_mov_b32 v10, s52
    s_waitcnt vmcnt(0)
    s_mov_b32 s57, 524288
L_lw153:
    ds_read_b32 v13, v10 offset:80
    s_waitcnt lgkmcnt(0)
    v_readfirstlane_b32 s52, v13
    s_cmp_ge_u32 s52, 1
    s_cbranch_scc1 L_lwok153
    s_sub_u32 s57, s57, 1
    s_cbranch_scc1 L_lwok153
    s_sleep 1
    s_branch L_lw153
L_lwok153:
    ds_read_b64 v[32:33], v11 offset:0
    ds_read_b64 v[34:35], v11 offset:32
    ds_read_b64 v[36:37], v11 offset:64
    ds_read_b64 v[38:39], v11 offset:96
    ds_read_b64 v[40:41], v11 offset:128
    ds_read_b64_tr_b16 v[44:45], v16 offset:0
    ds_read_b64_tr_b16 v[46:47], v17 offset:0
    ds_read_b64_tr_b16 v[48:49], v18 offset:0
    ds_read_b64_tr_b16 v[50:51], v19 offset:0
    ds_read_b64_tr_b16 v[52:53], v16 offset:2048
    ds_read_b64_tr_b16 v[54:55], v17 offset:2048
    ds_read_b64_tr_b16 v[56:57], v18 offset:2048
    ds_read_b64_tr_b16 v[58:59], v19 offset:2048
    s_waitcnt lgkmcnt(4)
    v_mfma_f32_16x16x16_bf16 v[60:63], v[32:33], v[44:45], 0
    v_mfma_f32_16x16x16_bf16 v[64:67], v[32:33], v[46:47], 0
    v_mfma_f32_16x16x16_bf16 v[68:71], v[32:33], v[48:49], 0
    v_mfma_f32_16x16x16_bf16 v[72:75], v[32:33], v[50:51], 0
    ds_read_b64_tr_b16 v[44:45], v16 offset:4096
    ds_read_b64_tr_b16 v[46:47], v17 offset:4096
    ds_read_b64_tr_b16 v[48:49], v18 offset:4096
    ds_read_b64_tr_b16 v[50:51], v19 offset:4096
    s_waitcnt lgkmcnt(4)
    v_mfma_f32_16x16x16_bf16 v[60:63], v[34:35], v[52:53], v[60:63]
    v_mfma_f32_16x16x16_bf16 v[64:67], v[34:35], v[54:55], v[64:67]
    v_mfma_f32_16x16x16_bf16 v[68:71], v[34:35], v[56:57], v[68:71]
    v_mfma_f32_16x16x16_bf16 v[72:75], v[34:35], v[58:59], v[72:75]
    ds_read_b64_tr_b16 v[52:53], v16 offset:6144
    ds_read_b64_tr_b16 v[54:55], v17 offset:6144
    ds_read_b64_tr_b16 v[56:57], v18 offset:6144
    ds_read_b64_tr_b16 v[58:59], v19 offset:6144
    s_waitcnt lgkmcnt(4)
    v_mfma_f32_16x16x16_bf16 v[60:63], v[36:37], v[44:45], v[60:63]
    v_mfma_f32_16x16x16_bf16 v[64:67], v[36:37], v[46:47], v[64:67]
    v_mfma_f32_16x16x16_bf16 v[68:71], v[36:37], v[48:49], v[68:71]
    v_mfma_f32_16x16x16_bf16 v[72:75], v[36:37], v[50:51], v[72:75]
    ds_read_b64_tr_b16 v[44:45], v16 offset:8192
    ds_read_b64_tr_b16 v[46:47], v17 offset:8192
    ds_read_b64_tr_b16 v[48:49], v18 offset:8192
    ds_read_b64_tr_b16 v[50:51], v19 offset:8192
    s_waitcnt lgkmcnt(4)
    v_mfma_f32_16x16x16_bf16 v[60:63], v[38:39], v[52:53], v[60:63]
    v_mfma_f32_16x16x16_bf16 v[64:67], v[38:39], v[54:55], v[64:67]
    v_mfma_f32_16x16x16_bf16 v[68:71], v[38:39], v[56:57], v[68:71]
    v_mfma_f32_16x16x16_bf16 v[72:75], v[38:39], v[58:59], v[72:75]
    s_waitcnt lgkmcnt(0)
    v_mfma_f32_16x16x16_bf16 v[60:63], v[40:41], v[44:45], v[60:63]
    v_mfma_f32_16x16x16_bf16 v[64:67], v[40:41], v[46:47], v[64:67]
    v_mfma_f32_16x16x16_bf16 v[68:71], v[40:41], v[48:49], v[68:71]
    v_mfma_f32_16x16x16_bf16 v[72:75], v[40:41], v[50:51], v[72:75]
    s_nop 4
    v_cndmask_b32 v60, v60, v61, s[58:59]
    v_cndmask_b32 v64, v64, v65, s[58:59]
    v_cndmask_b32 v68, v68, v69, s[58:59]
    v_cndmask_b32 v72, v72, v73, s[58:59]
    v_cndmask_b32 v28, v60, v68, s[60:61]
    v_cndmask_b32 v29, v64, v72, s[60:61]
    v_lshlrev_b32 v9, 3, v0
    s_lshl_b32 s53, s51, 9
    v_add_u32 v8, s53, v9
    ds_write_b64 v8, v[28:29] offset:7424
    s_mov_b64 exec, 1
    ds_add_u32 v2, v3 offset:16
    s_mov_b64 exec, -1
    s_mov_b32 s57, 524288
L_lw154:
    ds_read_b32 v13, v2 offset:16
    s_waitcnt lgkmcnt(0)
    v_readfirstlane_b32 s53, v13
    s_cmp_ge_u32 s53, 4
    s_cbranch_scc1 L_lwok154
    s_sub_u32 s57, s57, 1
    s_cbranch_scc1 L_lwok154
    s_branch L_lw154
L_lwok154:
    ds_read_b64 v[60:61], v9 offset:7424
    ds_read_b64 v[62:63], v9 offset:7936
    ds_read_b64 v[64:65], v9 offset:8448
    ds_read_b64 v[66:67], v9 offset:8960
    v_mov_b32 v30, -16
    s_waitcnt lgkmcnt(0)
    v_add_f32 v60, v60, v62
    v_add_f32 v64, v64, v66
    v_add_f32 v61, v61, v63
    v_add_f32 v65, v65, v67
    v_add_f32 v80, v60, v64
    v_add_f32 v81, v61, v65
    v_add_u32 v80, 8, v80
    v_add_u32 v81, 8, v81
    v_mov_b32 v82, v80
    v_mov_b32 v83, v81
    s_nop 1
    v_permlane32_swap_b32 v80, v82
    v_permlane32_swap_b32 v81, v83
    v_and_or_b32 v80, v80, v30, s90
    v_and_or_b32 v81, v81, v30, s91
    v_and_or_b32 v82, v82, v30, s92
    v_and_or_b32 v83, v83, v30, s93
    s_cmp_eq_u32 s51, 0
    s_cbranch_scc0 L_nopub
    s_mov_b32 exec_hi, 0
    buffer_store_dwordx4 v[80:83], v12, s[40:43], s64 offen
    s_mov_b32 exec_hi, -1
L_nopub:
    s_mov_b32 s67, 0x100
    s_mov_b32 s57, 40
L_fh:
    buffer_load_dwordx4 v[96:99], v12, s[40:43], s65 offen offset:0 nt
    buffer_load_dwordx4 v[100:103], v12, s[40:43], s65 offen offset:1024 nt
    buffer_load_dwordx4 v[104:107], v12, s[40:43], s65 offen offset:2048 nt
    buffer_load_dwordx4 v[108:111], v12, s[40:43], s65 offen offset:3072 nt
    s_waitcnt vmcnt(0)
    v_xor_b32 v13, s91, v97
    v_bitop3_b32 v13, v96, s90, v13 bitop3:0xbe
    v_bitop3_b32 v13, v98, s92, v13 bitop3:0xbe
    v_bitop3_b32 v13, v99, s93, v13 bitop3:0xbe
    v_bitop3_b32 v13, v100, s90, v13 bitop3:0xbe
    v_bitop3_b32 v13, v101, s91, v13 bitop3:0xbe
    v_bitop3_b32 v13, v102, s92, v13 bitop3:0xbe
    v_bitop3_b32 v13, v103, s93, v13 bitop3:0xbe
    v_bitop3_b32 v13, v104, s90, v13 bitop3:0xbe
    v_bitop3_b32 v13, v105, s91, v13 bitop3:0xbe
    v_bitop3_b32 v13, v106, s92, v13 bitop3:0xbe
    v_bitop3_b32 v13, v107, s93, v13 bitop3:0xbe
    v_bitop3_b32 v13, v108, s90, v13 bitop3:0xbe
    v_bitop3_b32 v13, v109, s91, v13 bitop3:0xbe
    v_bitop3_b32 v13, v110, s92, v13 bitop3:0xbe
    v_bitop3_b32 v13, v111, s93, v13 bitop3:0xbe
    v_and_b32 v13, 15, v13
    v_cmp_ne_u32 vcc, 0, v13
    s_nop 4
    s_cbranch_vccz L_fhok
    s_sub_u32 s57, s57, 1
    s_cbranch_scc1 L_fhs
    s_sleep 8
    s_branch L_fh
L_fhs:
    s_mov_b32 s67, 0x101
    s_mov_b32 exec_hi, 0
    buffer_store_dwordx4 v[80:83], v12, s[40:43], s64 offen sc1
    s_mov_b32 exec_hi, -1
    s_mov_b32 s57, 65536
L_fs:
    buffer_load_dwordx4 v[96:99], v12, s[40:43], s65 offen offset:0 sc1
    buffer_load_dwordx4 v[100:103], v12, s[40:43], s65 offen offset:1024 sc1
    buffer_load_dwordx4 v[104:107], v12, s[40:43], s65 offen offset:2048 sc1
    buffer_load_dwordx4 v[108:111], v12, s[40:43], s65 offen offset:3072 sc1
    s_waitcnt vmcnt(0)
    v_xor_b32 v13, s91, v97
    v_bitop3_b32 v13, v98, s92, v13 bitop3:0xbe
    v_bitop3_b32 v13, v99, s93, v13 bitop3:0xbe
    v_bitop3_b32 v13, v101, s91, v13 bitop3:0xbe
    v_bitop3_b32 v13, v102, s92, v13 bitop3:0xbe
    v_bitop3_b32 v13, v103, s93, v13 bitop3:0xbe
    v_bitop3_b32 v13, v105, s91, v13 bitop3:0xbe
    v_bitop3_b32 v13, v106, s92, v13 bitop3:0xbe
    v_bitop3_b32 v13, v107, s93, v13 bitop3:0xbe
    v_bitop3_b32 v13, v109, s91, v13 bitop3:0xbe
    v_bitop3_b32 v13, v110, s92, v13 bitop3:0xbe
    v_bitop3_b32 v13, v111, s93, v13 bitop3:0xbe
    v_and_b32 v13, 15, v13
    v_cmp_ne_u32 vcc, 0, v13
    s_nop 4
    s_cbranch_vccz L_fhok
    s_sleep 8
    s_sub_u32 s57, s57, 1
    s_cbranch_scc0 L_fs
L_fhok:
    v_and_b32 v8, 15, v0
    v_and_b32 v9, 16, v0
    v_lshl_add_u32 v8, v9, 1, v8
    v_and_b32 v9, 32, v0
    v_lshl_add_u32 v8, v9, 5, v8
    s_lshl_b32 s53, s51, 9
    v_lshl_add_u32 v8, v8, 1, s53
    v_and_b32 v96, v30, v96
    v_and_b32 v97, v30, v97
    v_and_b32 v98, v30, v98
    v_and_b32 v99, v30, v99
    v_and_b32 v100, v30, v100
    v_and_b32 v101, v30, v101
    v_and_b32 v102, v30, v102
    v_and_b32 v103, v30, v103
    v_and_b32 v104, v30, v104
    v_and_b32 v105, v30, v105
    v_and_b32 v106, v30, v106
    v_and_b32 v107, v30, v107
    v_and_b32 v108, v30, v108
    v_and_b32 v109, v30, v109
    v_and_b32 v110, v30, v110
    v_and_b32 v111, v30, v111
    s_nop 0
    v_permlane32_swap_b32 v96, v98
    v_permlane32_swap_b32 v97, v99
    v_permlane32_swap_b32 v100, v102
    v_permlane32_swap_b32 v101, v103
    v_permlane32_swap_b32 v104, v106
    v_permlane32_swap_b32 v105, v107
    v_permlane32_swap_b32 v108, v110
    v_permlane32_swap_b32 v109, v111
    v_add_f32 v96, v96, v98
    v_add_f32 v97, v97, v99
    v_cvt_pk_bf16_f32 v96, v96, v97
    ds_write_b16 v8, v96 offset:3328
    ds_write_b16_d16_hi v8, v96 offset:3360
    v_add_f32 v100, v100, v102
    v_add_f32 v101, v101, v103
    v_cvt_pk_bf16_f32 v100, v100, v101
    ds_write_b16 v8, v100 offset:3456
    ds_write_b16_d16_hi v8, v100 offset:3488
    v_add_f32 v104, v104, v106
    v_add_f32 v105, v105, v107
    v_cvt_pk_bf16_f32 v104, v104, v105
    ds_write_b16 v8, v104 offset:3584
    ds_write_b16_d16_hi v8, v104 offset:3616
    v_add_f32 v108, v108, v110
    v_add_f32 v109, v109, v111
    v_cvt_pk_bf16_f32 v108, v108, v109
    ds_write_b16 v8, v108 offset:3712
    ds_write_b16_d16_hi v8, v108 offset:3744
    v_mov_b32 v13, s67
    s_mov_b64 exec, 1
    ds_add_u32 v2, v13 offset:12
    s_mov_b64 exec, -1
    s_cmp_eq_u32 s51, 0
    s_cbranch_scc0 L_roles
    s_mov_b32 s57, 524288
L_lw155:
    ds_read_b32 v13, v2 offset:12
    s_waitcnt lgkmcnt(0)
    v_readfirstlane_b32 s67, v13
    s_cmp_ge_u32 s67, 1024
    s_cbranch_scc1 L_lwok155
    s_sub_u32 s57, s57, 1
    s_cbranch_scc1 L_lwok155
    s_sleep 4
    s_branch L_lw155
L_lwok155:
    s_and_b32 s67, s67, 0xff
    v_lshlrev_b32 v9, 2, v0
    s_cmp_eq_u32 s67, 0
    s_cbranch_scc0 L_a0end
    s_lshl_b32 s54, s30, 8
    s_add_u32 s54, s54, 196608
    s_lshl_b32 s55, s31, 2
    v_mov_b32 v5, s55
    s_and_b32 s55, s66, 7
    s_lshl_b32 s55, s55, 2
    s_lshr_b32 s55, 0x2020202, s55
    s_and_b32 s55, s55, 15
    s_mov_b32 s57, 524288
L_lw156:
    ds_read_b32 v13, v2 offset:0
    s_waitcnt lgkmcnt(0)
    v_readfirstlane_b32 s52, v13
    s_cmp_ge_u32 s52, 4
    s_cbranch_scc1 L_lwok156
    s_sub_u32 s57, s57, 1
    s_cbranch_scc1 L_lwok156
    s_sleep 2
    s_branch L_lw156
L_lwok156:
    s_add_u32 s52, s50, 1
    v_mov_b32 v13, s52
    s_mov_b64 exec, 1
    buffer_store_dword v13, v5, s[40:43], s54 offen
    s_mov_b32 exec_lo, -1
    s_mov_b32 exec_hi, 1
    buffer_load_dword v6, v9, s[40:43], s54 offen sc1
    s_waitcnt vmcnt(0)
    v_subrev_u32 v7, s52, v6
    v_cmp_gt_u32 vcc, 64, v7
    s_mov_b64 exec, -1
    s_nop 3
    s_bcnt1_i32_b32 s52, vcc_lo
    v_readlane_b32 s65, v6, 32
    s_sub_u32 s65, s65, s50
    s_cmp_lt_u32 s65, 64
    s_cselect_b32 s65, s65, 32
    s_add_u32 s52, s52, s65
    s_add_u32 s52, s52, s55
    s_mov_b32 s53, 4
    s_cmp_ge_i32 s52, 39
    s_cselect_b32 s53, 5, s53
    s_cmp_ge_i32 s52, 57
    s_cselect_b32 s53, 6, s53
    s_cmp_ge_i32 s52, 63
    s_cselect_b32 s53, 7, s53
    v_mov_b32 v13, s53
    ds_write_b32 v2, v13 offset:4
    s_mov_b32 s57, 524288
L_lw157:
    ds_read_b32 v13, v2 offset:0
    s_waitcnt lgkmcnt(0)
    v_readfirstlane_b32 s52, v13
    s_cmp_ge_u32 s52, 8
    s_cbranch_scc1 L_lwok157
    s_sub_u32 s57, s57, 1
    s_cbranch_scc1 L_lwok157
    s_sleep 2
    s_branch L_lw157
L_lwok157:
    s_add_u32 s52, s50, 2
    v_mov_b32 v13, s52
    s_mov_b64 exec, 1
    buffer_store_dword v13, v5, s[40:43], s54 offen
    s_mov_b32 exec_lo, -1
    s_mov_b32 exec_hi, 1
    buffer_load_dword v6, v9, s[40:43], s54 offen sc1
    s_waitcnt vmcnt(0)
    v_subrev_u32 v7, s52, v6
    v_cmp_gt_u32 vcc, 64, v7
    s_mov_b64 exec, -1
    s_nop 3
    s_bcnt1_i32_b32 s52, vcc_lo
    v_readlane_b32 s65, v6, 32
    s_sub_u32 s65, s65, s50
    s_cmp_lt_u32 s65, 64
    s_cselect_b32 s65, s65, 32
    s_add_u32 s52, s52, s65
    s_add_u32 s52, s52, s55
    s_mov_b32 s53, 4
    s_cmp_ge_i32 s52, 39
    s_cselect_b32 s53, 5, s53
    s_cmp_ge_i32 s52, 57
    s_cselect_b32 s53, 6, s53
    s_cmp_ge_i32 s52, 63
    s_cselect_b32 s53, 7, s53
    v_mov_b32 v13, s53
    ds_write_b32 v2, v13 offset:4
    s_mov_b32 s57, 524288
L_lw158:
    ds_read_b32 v13, v2 offset:0
    s_waitcnt lgkmcnt(0)
    v_readfirstlane_b32 s52, v13
    s_cmp_ge_u32 s52, 12
    s_cbranch_scc1 L_lwok158
    s_sub_u32 s57, s57, 1
    s_cbranch_scc1 L_lwok158
    s_sleep 2
    s_branch L_lw158
L_lwok158:
    s_add_u32 s52, s50, 3
    v_mov_b32 v13, s52
    s_mov_b64 exec, 1
    buffer_store_dword v13, v5, s[40:43], s54 offen
    s_mov_b32 exec_lo, -1
    s_mov_b32 exec_hi, 1
    buffer_load_dword v6, v9, s[40:43], s54 offen sc1
    s_waitcnt vmcnt(0)
    v_subrev_u32 v7, s52, v6
    v_cmp_gt_u32 vcc, 64, v7
    s_mov_b64 exec, -1
    s_nop 3
    s_bcnt1_i32_b32 s52, vcc_lo
    v_readlane_b32 s65, v6, 32
    s_sub_u32 s65, s65, s50
    s_cmp_lt_u32 s65, 64
    s_cselect_b32 s65, s65, 32
    s_add_u32 s52, s52, s65
    s_add_u32 s52, s52, s55
    s_mov_b32 s53, 4
    s_cmp_ge_i32 s52, 39
    s_cselect_b32 s53, 5, s53
    s_cmp_ge_i32 s52, 57
    s_cselect_b32 s53, 6, s53
    s_cmp_ge_i32 s52, 63
    s_cselect_b32 s53, 7, s53
    v_mov_b32 v13, s53
    ds_write_b32 v2, v13 offset:4
    s_mov_b32 s57, 524288
L_lw159:
    ds_read_b32 v13, v2 offset:0
    s_waitcnt lgkmcnt(0)
    v_readfirstlane_b32 s52, v13
    s_cmp_ge_u32 s52, 16
    s_cbranch_scc1 L_lwok159
    s_sub_u32 s57, s57, 1
    s_cbranch_scc1 L_lwok159
    s_sleep 2
    s_branch L_lw159
L_lwok159:
    s_add_u32 s52, s50, 4
    v_mov_b32 v13, s52
    s_mov_b64 exec, 1
    buffer_store_dword v13, v5, s[40:43], s54 offen
    s_mov_b32 exec_lo, -1
    s_mov_b32 exec_hi, 1
    buffer_load_dword v6, v9, s[40:43], s54 offen sc1
    s_waitcnt vmcnt(0)
    v_subrev_u32 v7, s52, v6
    v_cmp_gt_u32 vcc, 64, v7
    s_mov_b64 exec, -1
    s_nop 3
    s_bcnt1_i32_b32 s52, vcc_lo
    v_readlane_b32 s65, v6, 32
    s_sub_u32 s65, s65, s50
    s_cmp_lt_u32 s65, 64
    s_cselect_b32 s65, s65, 32
    s_add_u32 s52, s52, s65
    s_add_u32 s52, s52, s55
    s_mov_b32 s53, 4
    s_cmp_ge_i32 s52, 39
    s_cselect_b32 s53, 5, s53
    s_cmp_ge_i32 s52, 57
    s_cselect_b32 s53, 6, s53
    s_cmp_ge_i32 s52, 63
    s_cselect_b32 s53, 7, s53
    v_mov_b32 v13, s53
    ds_write_b32 v2, v13 offset:4
    s_mov_b32 s57, 524288
L_lw160:
    ds_read_b32 v13, v2 offset:0
    s_waitcnt lgkmcnt(0)
    v_readfirstlane_b32 s52, v13
    s_cmp_ge_u32 s52, 20
    s_cbranch_scc1 L_lwok160
    s_sub_u32 s57, s57, 1
    s_cbranch_scc1 L_lwok160
    s_sleep 2
    s_branch L_lw160
L_lwok160:
    s_add_u32 s52, s50, 5
    v_mov_b32 v13, s52
    s_mov_b64 exec, 1
    buffer_store_dword v13, v5, s[40:43], s54 offen
    s_mov_b32 exec_lo, -1
    s_mov_b32 exec_hi, 1
    buffer_load_dword v6, v9, s[40:43], s54 offen sc1
    s_waitcnt vmcnt(0)
    v_subrev_u32 v7, s52, v6
    v_cmp_gt_u32 vcc, 64, v7
    s_mov_b64 exec, -1
    s_nop 3
    s_bcnt1_i32_b32 s52, vcc_lo
    v_readlane_b32 s65, v6, 32
    s_sub_u32 s65, s65, s50
    s_cmp_lt_u32 s65, 64
    s_cselect_b32 s65, s65, 32
    s_add_u32 s52, s52, s65
    s_add_u32 s52, s52, s55
    s_mov_b32 s53, 4
    s_cmp_ge_i32 s52, 39
    s_cselect_b32 s53, 5, s53
    s_cmp_ge_i32 s52, 57
    s_cselect_b32 s53, 6, s53
    s_cmp_ge_i32 s52, 63
    s_cselect_b32 s53, 7, s53
    v_mov_b32 v13, s53
    ds_write_b32 v2, v13 offset:4
    s_mov_b32 s57, 524288
L_lw161:
    ds_read_b32 v13, v2 offset:0
    s_waitcnt lgkmcnt(0)
    v_readfirstlane_b32 s52, v13
    s_cmp_ge_u32 s52, 24
    s_cbranch_scc1 L_lwok161
    s_sub_u32 s57, s57, 1
    s_cbranch_scc1 L_lwok161
    s_sleep 2
    s_branch L_lw161
L_lwok161:
    s_add_u32 s52, s50, 6
    v_mov_b32 v13, s52
    s_mov_b64 exec, 1
    buffer_store_dword v13, v5, s[40:43], s54 offen
    s_mov_b32 exec_lo, -1
    s_mov_b32 exec_hi, 1
    buffer_load_dword v6, v9, s[40:43], s54 offen sc1
    s_waitcnt vmcnt(0)
    v_subrev_u32 v7, s52, v6
    v_cmp_gt_u32 vcc, 64, v7
    s_mov_b64 exec, -1
    s_nop 3
    s_bcnt1_i32_b32 s52, vcc_lo
    v_readlane_b32 s65, v6, 32
    s_sub_u32 s65, s65, s50
    s_cmp_lt_u32 s65, 64
    s_cselect_b32 s65, s65, 32
    s_add_u32 s52, s52, s65
    s_add_u32 s52, s52, s55
    s_mov_b32 s53, 4
    s_cmp_ge_i32 s52, 39
    s_cselect_b32 s53, 5, s53
    s_cmp_ge_i32 s52, 57
    s_cselect_b32 s53, 6, s53
    s_cmp_ge_i32 s52, 63
    s_cselect_b32 s53, 7, s53
    v_mov_b32 v13, s53
    ds_write_b32 v2, v13 offset:4
    s_mov_b32 s57, 524288
L_lw162:
    ds_read_b32 v13, v2 offset:0
    s_waitcnt lgkmcnt(0)
    v_readfirstlane_b32 s52, v13
    s_cmp_ge_u32 s52, 28
    s_cbranch_scc1 L_lwok162
    s_sub_u32 s57, s57, 1
    s_cbranch_scc1 L_lwok162
    s_sleep 2
    s_branch L_lw162
L_lwok162:
    s_add_u32 s52, s50, 7
    v_mov_b32 v13, s52
    s_mov_b64 exec, 1
    buffer_store_dword v13, v5, s[40:43], s54 offen
    s_mov_b32 exec_lo, -1
    s_mov_b32 exec_hi, 1
    buffer_load_dword v6, v9, s[40:43], s54 offen sc1
    s_waitcnt vmcnt(0)
    v_subrev_u32 v7, s52, v6
    v_cmp_gt_u32 vcc, 64, v7
    s_mov_b64 exec, -1
    s_nop 3
    s_bcnt1_i32_b32 s52, vcc_lo
    v_readlane_b32 s65, v6, 32
    s_sub_u32 s65, s65, s50
    s_cmp_lt_u32 s65, 64
    s_cselect_b32 s65, s65, 32
    s_add_u32 s52, s52, s65
    s_add_u32 s52, s52, s55
    s_mov_b32 s53, 4
    s_cmp_ge_i32 s52, 39
    s_cselect_b32 s53, 5, s53
    s_cmp_ge_i32 s52, 57
    s_cselect_b32 s53, 6, s53
    s_cmp_ge_i32 s52, 63
    s_cselect_b32 s53, 7, s53
    v_mov_b32 v13, s53
    ds_write_b32 v2, v13 offset:4
    s_mov_b32 s57, 524288
L_lw163:
    ds_read_b32 v13, v2 offset:0
    s_waitcnt lgkmcnt(0)
    v_readfirstlane_b32 s52, v13
    s_cmp_ge_u32 s52, 32
    s_cbranch_scc1 L_lwok163
    s_sub_u32 s57, s57, 1
    s_cbranch_scc1 L_lwok163
    s_sleep 2
    s_branch L_lw163
L_lwok163:
    s_add_u32 s52, s50, 8
    v_mov_b32 v13, s52
    s_mov_b64 exec, 1
    buffer_store_dword v13, v5, s[40:43], s54 offen
    s_mov_b32 exec_lo, -1
    s_mov_b32 exec_hi, 1
    buffer_load_dword v6, v9, s[40:43], s54 offen sc1
    s_waitcnt vmcnt(0)
    v_subrev_u32 v7, s52, v6
    v_cmp_gt_u32 vcc, 64, v7
    s_mov_b64 exec, -1
    s_nop 3
    s_bcnt1_i32_b32 s52, vcc_lo
    v_readlane_b32 s65, v6, 32
    s_sub_u32 s65, s65, s50
    s_cmp_lt_u32 s65, 64
    s_cselect_b32 s65, s65, 32
    s_add_u32 s52, s52, s65
    s_add_u32 s52, s52, s55
    s_mov_b32 s53, 4
    s_cmp_ge_i32 s52, 39
    s_cselect_b32 s53, 5, s53
    s_cmp_ge_i32 s52, 57
    s_cselect_b32 s53, 6, s53
    s_cmp_ge_i32 s52, 63
    s_cselect_b32 s53, 7, s53
    v_mov_b32 v13, s53
    ds_write_b32 v2, v13 offset:4
    s_mov_b32 s57, 524288
L_lw164:
    ds_read_b32 v13, v2 offset:0
    s_waitcnt lgkmcnt(0)
    v_readfirstlane_b32 s52, v13
    s_cmp_ge_u32 s52, 36
    s_cbranch_scc1 L_lwok164
    s_sub_u32 s57, s57, 1
    s_cbranch_scc1 L_lwok164
    s_sleep 2
    s_branch L_lw164
L_lwok164:
    s_add_u32 s52, s50, 9
    v_mov_b32 v13, s52
    s_mov_b64 exec, 1
    buffer_store_dword v13, v5, s[40:43], s54 offen
    s_mov_b32 exec_lo, -1
    s_mov_b32 exec_hi, 1
    buffer_load_dword v6, v9, s[40:43], s54 offen sc1
    s_waitcnt vmcnt(0)
    v_subrev_u32 v7, s52, v6
    v_cmp_gt_u32 vcc, 64, v7
    s_mov_b64 exec, -1
    s_nop 3
    s_bcnt1_i32_b32 s52, vcc_lo
    s_sub_u32 s64, s52, 16
    v_readlane_b32 s65, v6, 32
    s_sub_u32 s65, s65, s50
    s_cmp_lt_u32 s65, 64
    s_cselect_b32 s65, s65, 32
    s_add_u32 s52, s52, s65
    s_add_u32 s52, s52, s55
    s_mov_b32 s53, 4
    s_cmp_ge_i32 s52, 39
    s_cselect_b32 s53, 5, s53
    s_cmp_ge_i32 s52, 57
    s_cselect_b32 s53, 6, s53
    s_cmp_ge_i32 s52, 63
    s_cselect_b32 s53, 7, s53
    v_mov_b32 v13, s53
    ds_write_b32 v2, v13 offset:4
    s_cmp_lt_u32 s64, 2
    s_cbranch_scc0 L_xe8
    s_lshl_b32 s52, s30, 2
    s_lshl_b32 s52, 1, s52
    s_atomic_add s52, s[26:27], 0 glc
    s_waitcnt lgkmcnt(0)
    s_quadmask_b32 s52, s52
    s_bitcmp1_b32 s52, s30
    s_cbranch_scc1 L_xe8
    s_bcnt1_i32_b32 s52, s52
    s_lshl_b32 s52, s52, 2
    s_lshr_b32 s52, 0xeca98654, s52
    s_and_b32 s52, s52, 15
    s_sub_u32 s52, s52, 8
    s_add_u32 s52, s52, s65
    s_add_u32 s52, s52, s50
    v_mov_b32 v13, s52
    v_mov_b32 v18, 128
    s_mov_b64 exec, 1
    buffer_store_dword v13, v18, s[40:43], s54 offen
    s_mov_b64 exec, -1
L_xe8:
    s_mov_b32 s57, 524288
L_lw165:
    ds_read_b32 v13, v2 offset:0
    s_waitcnt lgkmcnt(0)
    v_readfirstlane_b32 s52, v13
    s_cmp_ge_u32 s52, 40
    s_cbranch_scc1 L_lwok165
    s_sub_u32 s57, s57, 1
    s_cbranch_scc1 L_lwok165
    s_sleep 2
    s_branch L_lw165
L_lwok165:
    s_add_u32 s52, s50, 10
    v_mov_b32 v13, s52
    s_mov_b64 exec, 1
    buffer_store_dword v13, v5, s[40:43], s54 offen
    s_mov_b32 exec_lo, -1
    s_mov_b32 exec_hi, 1
    buffer_load_dword v6, v9, s[40:43], s54 offen sc1
    s_waitcnt vmcnt(0)
    v_subrev_u32 v7, s52, v6
    v_cmp_gt_u32 vcc, 64, v7
    s_mov_b64 exec, -1
    s_nop 3
    s_bcnt1_i32_b32 s52, vcc_lo
    v_readlane_b32 s65, v6, 32
    s_sub_u32 s65, s65, s50
    s_cmp_lt_u32 s65, 64
    s_cselect_b32 s65, s65, 32
    s_add_u32 s52, s52, s65
    s_lshl_b32 s53, s30, 2
    s_lshr_b32 s53, 0xa888889a, s53
    s_and_b32 s53, s53, 15
    s_sub_u32 s53, s53, 8
    s_lshl2_add_u32 s52, s53, s52
    s_add_u32 s52, s52, s55
    s_mov_b32 s53, 4
    s_cmp_ge_i32 s52, 39
    s_cselect_b32 s53, 5, s53
    s_cmp_ge_i32 s52, 57
    s_cselect_b32 s53, 6, s53
    s_cmp_ge_i32 s52, 63
    s_cselect_b32 s53, 7, s53
    v_mov_b32 v13, s53
    ds_write_b32 v2, v13 offset:4
    s_mov_b32 s57, 524288
L_lw166:
    ds_read_b32 v13, v2 offset:0
    s_waitcnt lgkmcnt(0)
    v_readfirstlane_b32 s52, v13
    s_cmp_ge_u32 s52, 44
    s_cbranch_scc1 L_lwok166
    s_sub_u32 s57, s57, 1
    s_cbranch_scc1 L_lwok166
    s_sleep 2
    s_branch L_lw166
L_lwok166:
    s_add_u32 s52, s50, 11
    v_mov_b32 v13, s52
    s_mov_b64 exec, 1
    buffer_store_dword v13, v5, s[40:43], s54 offen
    s_mov_b32 exec_lo, -1
    s_mov_b32 exec_hi, 1
    buffer_load_dword v6, v9, s[40:43], s54 offen sc1
    s_waitcnt vmcnt(0)
    v_subrev_u32 v7, s52, v6
    v_cmp_gt_u32 vcc, 64, v7
    s_mov_b64 exec, -1
    s_nop 3
    s_bcnt1_i32_b32 s52, vcc_lo
    v_readlane_b32 s65, v6, 32
    s_sub_u32 s65, s65, s50
    s_cmp_lt_u32 s65, 64
    s_cselect_b32 s65, s65, 32
    s_add_u32 s52, s52, s65
    s_lshl_b32 s53, s30, 2
    s_lshr_b32 s53, 0xa888889a, s53
    s_and_b32 s53, s53, 15
    s_sub_u32 s53, s53, 8
    s_lshl2_add_u32 s52, s53, s52
    s_add_u32 s52, s52, s55
    s_mov_b32 s53, 4
    s_cmp_ge_i32 s52, 39
    s_cselect_b32 s53, 5, s53
    s_cmp_ge_i32 s52, 57
    s_cselect_b32 s53, 6, s53
    s_cmp_ge_i32 s52, 63
    s_cselect_b32 s53, 7, s53
    v_mov_b32 v13, s53
    ds_write_b32 v2, v13 offset:4
    s_mov_b32 s57, 524288
L_lw167:
    ds_read_b32 v13, v2 offset:0
    s_waitcnt lgkmcnt(0)
    v_readfirstlane_b32 s52, v13
    s_cmp_ge_u32 s52, 48
    s_cbranch_scc1 L_lwok167
    s_sub_u32 s57, s57, 1
    s_cbranch_scc1 L_lwok167
    s_sleep 2
    s_branch L_lw167
L_lwok167:
    s_add_u32 s52, s50, 12
    v_mov_b32 v13, s52
    s_mov_b64 exec, 1
    buffer_store_dword v13, v5, s[40:43], s54 offen
    s_mov_b32 exec_lo, -1
    s_mov_b32 exec_hi, 1
    buffer_load_dword v6, v9, s[40:43], s54 offen sc1
    s_waitcnt vmcnt(0)
    v_subrev_u32 v7, s52, v6
    v_cmp_gt_u32 vcc, 64, v7
    s_mov_b64 exec, -1
    s_nop 3
    s_bcnt1_i32_b32 s52, vcc_lo
    v_readlane_b32 s65, v6, 32
    s_sub_u32 s65, s65, s50
    s_cmp_lt_u32 s65, 64
    s_cselect_b32 s65, s65, 32
    s_add_u32 s52, s52, s65
    s_lshl_b32 s53, s30, 2
    s_lshr_b32 s53, 0xa888889a, s53
    s_and_b32 s53, s53, 15
    s_sub_u32 s53, s53, 8
    s_lshl2_add_u32 s52, s53, s52
    s_add_u32 s52, s52, s55
    s_mov_b32 s53, 4
    s_cmp_ge_i32 s52, 39
    s_cselect_b32 s53, 5, s53
    s_cmp_ge_i32 s52, 57
    s_cselect_b32 s53, 6, s53
    s_cmp_ge_i32 s52, 63
    s_cselect_b32 s53, 7, s53
    v_mov_b32 v13, s53
    ds_write_b32 v2, v13 offset:4
    s_mov_b32 s57, 524288
L_lw168:
    ds_read_b32 v13, v2 offset:0
    s_waitcnt lgkmcnt(0)
    v_readfirstlane_b32 s52, v13
    s_cmp_ge_u32 s52, 52
    s_cbranch_scc1 L_lwok168
    s_sub_u32 s57, s57, 1
    s_cbranch_scc1 L_lwok168
    s_sleep 2
    s_branch L_lw168
L_lwok168:
    s_add_u32 s52, s50, 13
    v_mov_b32 v13, s52
    s_mov_b64 exec, 1
    buffer_store_dword v13, v5, s[40:43], s54 offen
    s_mov_b32 exec_lo, -1
    s_mov_b32 exec_hi, 1
    buffer_load_dword v6, v9, s[40:43], s54 offen sc1
    s_waitcnt vmcnt(0)
    v_subrev_u32 v7, s52, v6
    v_cmp_gt_u32 vcc, 64, v7
    s_mov_b64 exec, -1
    s_nop 3
    s_bcnt1_i32_b32 s52, vcc_lo
    v_readlane_b32 s65, v6, 32
    s_sub_u32 s65, s65, s50
    s_cmp_lt_u32 s65, 64
    s_cselect_b32 s65, s65, 32
    s_add_u32 s52, s52, s65
    s_lshl_b32 s53, s30, 2
    s_lshr_b32 s53, 0xa888889a, s53
    s_and_b32 s53, s53, 15
    s_sub_u32 s53, s53, 8
    s_lshl2_add_u32 s52, s53, s52
    s_add_u32 s52, s52, s55
    s_mov_b32 s53, 4
    s_cmp_ge_i32 s52, 39
    s_cselect_b32 s53, 5, s53
    s_cmp_ge_i32 s52, 57
    s_cselect_b32 s53, 6, s53
    s_cmp_ge_i32 s52, 63
    s_cselect_b32 s53, 7, s53
    v_mov_b32 v13, s53
    ds_write_b32 v2, v13 offset:4
    s_mov_b32 s57, 524288
L_lw169:
    ds_read_b32 v13, v2 offset:0
    s_waitcnt lgkmcnt(0)
    v_readfirstlane_b32 s52, v13
    s_cmp_ge_u32 s52, 56
    s_cbranch_scc1 L_lwok169
    s_sub_u32 s57, s57, 1
    s_cbranch_scc1 L_lwok169
    s_sleep 2
    s_branch L_lw169
L_lwok169:
    s_add_u32 s52, s50, 14
    v_mov_b32 v13, s52
    s_mov_b64 exec, 1
    buffer_store_dword v13, v5, s[40:43], s54 offen
    s_mov_b32 exec_lo, -1
    s_mov_b32 exec_hi, 1
    buffer_load_dword v6, v9, s[40:43], s54 offen sc1
    s_waitcnt vmcnt(0)
    v_subrev_u32 v7, s52, v6
    v_cmp_gt_u32 vcc, 64, v7
    s_mov_b64 exec, -1
    s_nop 3
    s_bcnt1_i32_b32 s52, vcc_lo
    v_readlane_b32 s65, v6, 32
    s_sub_u32 s65, s65, s50
    s_cmp_lt_u32 s65, 64
    s_cselect_b32 s65, s65, 32
    s_add_u32 s52, s52, s65
    s_lshl_b32 s53, s30, 2
    s_lshr_b32 s53, 0xa888889a, s53
    s_and_b32 s53, s53, 15
    s_sub_u32 s53, s53, 8
    s_lshl2_add_u32 s52, s53, s52
    s_add_u32 s52, s52, s55
    s_mov_b32 s53, 4
    s_cmp_ge_i32 s52, 39
    s_cselect_b32 s53, 5, s53
    s_cmp_ge_i32 s52, 57
    s_cselect_b32 s53, 6, s53
    s_cmp_ge_i32 s52, 63
    s_cselect_b32 s53, 7, s53
    v_mov_b32 v13, s53
    ds_write_b32 v2, v13 offset:4
    s_mov_b32 s57, 524288
L_lw170:
    ds_read_b32 v13, v2 offset:0
    s_waitcnt lgkmcnt(0)
    v_readfirstlane_b32 s52, v13
    s_cmp_ge_u32 s52, 60
    s_cbranch_scc1 L_lwok170
    s_sub_u32 s57, s57, 1
    s_cbranch_scc1 L_lwok170
    s_sleep 2
    s_branch L_lw170
L_lwok170:
    s_add_u32 s52, s50, 15
    v_mov_b32 v13, s52
    s_mov_b64 exec, 1
    buffer_store_dword v13, v5, s[40:43], s54 offen
    s_mov_b32 exec_lo, -1
    s_mov_b32 exec_hi, 1
    buffer_load_dword v6, v9, s[40:43], s54 offen sc1
    s_waitcnt vmcnt(0)
    v_subrev_u32 v7, s52, v6
    v_cmp_gt_u32 vcc, 64, v7
    s_mov_b64 exec, -1
    s_nop 3
    s_bcnt1_i32_b32 s52, vcc_lo
    v_readlane_b32 s65, v6, 32
    s_sub_u32 s65, s65, s50
    s_cmp_lt_u32 s65, 64
    s_cselect_b32 s65, s65, 32
    s_add_u32 s52, s52, s65
    s_lshl_b32 s53, s30, 2
    s_lshr_b32 s53, 0xa888889a, s53
    s_and_b32 s53, s53, 15
    s_sub_u32 s53, s53, 8
    s_lshl2_add_u32 s52, s53, s52
    s_add_u32 s52, s52, s55
    s_mov_b32 s53, 4
    s_cmp_ge_i32 s52, 39
    s_cselect_b32 s53, 5, s53
    s_cmp_ge_i32 s52, 57
    s_cselect_b32 s53, 6, s53
    s_cmp_ge_i32 s52, 63
    s_cselect_b32 s53, 7, s53
    v_mov_b32 v13, s53
    ds_write_b32 v2, v13 offset:4
    s_mov_b32 s57, 524288
L_lw171:
    ds_read_b32 v13, v2 offset:0
    s_waitcnt lgkmcnt(0)
    v_readfirstlane_b32 s52, v13
    s_cmp_ge_u32 s52, 64
    s_cbranch_scc1 L_lwok171
    s_sub_u32 s57, s57, 1
    s_cbranch_scc1 L_lwok171
    s_sleep 2
    s_branch L_lw171
L_lwok171:
    s_add_u32 s52, s50, 16
    v_mov_b32 v13, s52
    s_mov_b64 exec, 1
    buffer_store_dword v13, v5, s[40:43], s54 offen
    s_mov_b32 exec_lo, -1
    s_mov_b32 exec_hi, 1
    buffer_load_dword v6, v9, s[40:43], s54 offen sc1
    s_waitcnt vmcnt(0)
    v_subrev_u32 v7, s52, v6
    v_cmp_gt_u32 vcc, 64, v7
    s_mov_b64 exec, -1
    s_nop 3
    s_bcnt1_i32_b32 s52, vcc_lo
    v_readlane_b32 s65, v6, 32
    s_sub_u32 s65, s65, s50
    s_cmp_lt_u32 s65, 64
    s_cselect_b32 s65, s65, 32
    s_add_u32 s52, s52, s65
    s_lshl_b32 s53, s30, 2
    s_lshr_b32 s53, 0xa888889a, s53
    s_and_b32 s53, s53, 15
    s_sub_u32 s53, s53, 8
    s_lshl2_add_u32 s52, s53, s52
    s_add_u32 s52, s52, s55
    s_mov_b32 s53, 4
    s_cmp_ge_i32 s52, 39
    s_cselect_b32 s53, 5, s53
    s_cmp_ge_i32 s52, 57
    s_cselect_b32 s53, 6, s53
    s_cmp_ge_i32 s52, 63
    s_cselect_b32 s53, 7, s53
    v_mov_b32 v13, s53
    ds_write_b32 v2, v13 offset:4
    s_mov_b32 s57, 524288
L_lw172:
    ds_read_b32 v13, v2 offset:0
    s_waitcnt lgkmcnt(0)
    v_readfirstlane_b32 s52, v13
    s_cmp_ge_u32 s52, 68
    s_cbranch_scc1 L_lwok172
    s_sub_u32 s57, s57, 1
    s_cbranch_scc1 L_lwok172
    s_sleep 2
    s_branch L_lw172
L_lwok172:
    s_add_u32 s52, s50, 17
    v_mov_b32 v13, s52
    s_mov_b64 exec, 1
    buffer_store_dword v13, v5, s[40:43], s54 offen
    s_mov_b32 exec_lo, -1
    s_mov_b32 exec_hi, 1
    buffer_load_dword v6, v9, s[40:43], s54 offen sc1
    s_waitcnt vmcnt(0)
    v_subrev_u32 v7, s52, v6
    v_cmp_gt_u32 vcc, 64, v7
    s_mov_b64 exec, -1
    s_nop 3
    s_bcnt1_i32_b32 s52, vcc_lo
    v_readlane_b32 s65, v6, 32
    s_sub_u32 s65, s65, s50
    s_cmp_lt_u32 s65, 64
    s_cselect_b32 s65, s65, 32
    s_add_u32 s52, s52, s65
    s_add_u32 s52, s52, s55
    s_mov_b32 s53, 4
    s_cmp_ge_i32 s52, 39
    s_cselect_b32 s53, 5, s53
    s_cmp_ge_i32 s52, 57
    s_cselect_b32 s53, 6, s53
    s_cmp_ge_i32 s52, 63
    s_cselect_b32 s53, 7, s53
    v_mov_b32 v13, s53
    ds_write_b32 v2, v13 offset:4
    s_mov_b32 s57, 524288
L_lw173:
    ds_read_b32 v13, v2 offset:0
    s_waitcnt lgkmcnt(0)
    v_readfirstlane_b32 s52, v13
    s_cmp_ge_u32 s52, 72
    s_cbranch_scc1 L_lwok173
    s_sub_u32 s57, s57, 1
    s_cbranch_scc1 L_lwok173
    s_sleep 2
    s_branch L_lw173
L_lwok173:
    s_add_u32 s52, s50, 18
    v_mov_b32 v13, s52
    s_mov_b64 exec, 1
    buffer_store_dword v13, v5, s[40:43], s54 offen
    s_mov_b32 exec_lo, -1
    s_mov_b32 exec_hi, 1
    buffer_load_dword v6, v9, s[40:43], s54 offen sc1
    s_waitcnt vmcnt(0)
    v_subrev_u32 v7, s52, v6
    v_cmp_gt_u32 vcc, 64, v7
    s_mov_b64 exec, -1
    s_nop 3
    s_bcnt1_i32_b32 s52, vcc_lo
    v_readlane_b32 s65, v6, 32
    s_sub_u32 s65, s65, s50
    s_cmp_lt_u32 s65, 64
    s_cselect_b32 s65, s65, 32
    s_add_u32 s52, s52, s65
    s_add_u32 s52, s52, s55
    s_mov_b32 s53, 4
    s_cmp_ge_i32 s52, 39
    s_cselect_b32 s53, 5, s53
    s_cmp_ge_i32 s52, 57
    s_cselect_b32 s53, 6, s53
    s_cmp_ge_i32 s52, 63
    s_cselect_b32 s53, 7, s53
    v_mov_b32 v13, s53
    ds_write_b32 v2, v13 offset:4
    s_mov_b32 s57, 524288
L_lw174:
    ds_read_b32 v13, v2 offset:0
    s_waitcnt lgkmcnt(0)
    v_readfirstlane_b32 s52, v13
    s_cmp_ge_u32 s52, 76
    s_cbranch_scc1 L_lwok174
    s_sub_u32 s57, s57, 1
    s_cbranch_scc1 L_lwok174
    s_sleep 2
    s_branch L_lw174
L_lwok174:
    s_add_u32 s52, s50, 19
    v_mov_b32 v13, s52
    s_mov_b64 exec, 1
    buffer_store_dword v13, v5, s[40:43], s54 offen
    s_mov_b32 exec_lo, -1
    s_mov_b32 exec_hi, 1
    buffer_load_dword v6, v9, s[40:43], s54 offen sc1
    s_waitcnt vmcnt(0)
    v_subrev_u32 v7, s52, v6
    v_cmp_gt_u32 vcc, 64, v7
    s_mov_b64 exec, -1
    s_nop 3
    s_bcnt1_i32_b32 s52, vcc_lo
    v_readlane_b32 s65, v6, 32
    s_sub_u32 s65, s65, s50
    s_cmp_lt_u32 s65, 64
    s_cselect_b32 s65, s65, 32
    s_add_u32 s52, s52, s65
    s_add_u32 s52, s52, s55
    s_mov_b32 s53, 4
    s_cmp_ge_i32 s52, 39
    s_cselect_b32 s53, 5, s53
    s_cmp_ge_i32 s52, 57
    s_cselect_b32 s53, 6, s53
    s_cmp_ge_i32 s52, 63
    s_cselect_b32 s53, 7, s53
    v_mov_b32 v13, s53
    ds_write_b32 v2, v13 offset:4
L_a0end:
    s_waitcnt lgkmcnt(0)
    s_endpgm
L_roles:
    s_cmp_eq_u32 s51, 2
    s_cbranch_scc1 L_a2
    s_cmp_eq_u32 s51, 3
    s_cbranch_scc1 L_a3
    s_mov_b32 s57, 524288
L_lw175:
    ds_read_b32 v13, v2 offset:12
    s_waitcnt lgkmcnt(0)
    v_readfirstlane_b32 s67, v13
    s_cmp_ge_u32 s67, 1024
    s_cbranch_scc1 L_lwok175
    s_sub_u32 s57, s57, 1
    s_cbranch_scc1 L_lwok175
    s_sleep 8
    s_branch L_lw175
L_lwok175:
    s_and_b32 s67, s67, 0xff
    s_cmp_eq_u32 s67, 0
    s_cbranch_scc1 L_noclr
    s_mul_i32 s54, s30, 384
    s_add_u32 s54, s54, s31
    s_lshl_b32 s54, s54, 8
    s_add_u32 s54, s54, 1048576
    s_mov_b32 exec_hi, 0xffff
    buffer_store_dwordx4 v[92:95], v15, s[40:43], s54 offen sc1
    s_add_u32 s54, s54, 24576
    buffer_store_dwordx4 v[92:95], v15, s[40:43], s54 offen sc1
    s_add_u32 s54, s54, 24576
    buffer_store_dwordx4 v[92:95], v15, s[40:43], s54 offen sc1
    s_add_u32 s54, s54, 24576
    buffer_store_dwordx4 v[92:95], v15, s[40:43], s54 offen sc1
    s_add_u32 s54, s54, 24576
    s_mov_b32 exec_hi, -1
    s_waitcnt vmcnt(0)
L_noclr:
    s_mov_b32 s57, 524288
L_lw176:
    ds_read_b32 v13, v2 offset:20
    s_waitcnt lgkmcnt(0)
    v_readfirstlane_b32 s52, v13
    s_cmp_ge_u32 s52, 4
    s_cbranch_scc1 L_lwok176
    s_sub_u32 s57, s57, 1
    s_cbranch_scc1 L_lwok176
    s_sleep 8
    s_branch L_lw176
L_lwok176:
    v_and_b32 v9, 31, v0
    v_lshlrev_b32 v9, 3, v9
    ds_read_b64 v[20:21], v9 offset:256
    s_lshl_b32 s54, s30, 12
    s_lshl_b32 s53, s31, 4
    s_add_u32 s54, s54, s53
    s_add_u32 s54, s54, 131072
    v_lshlrev_b32 v9, 7, v0
    s_waitcnt lgkmcnt(0)
    v_max_f32_dpp v24, v20, v20 quad_perm:[1,0,3,2] row_mask:0xf bank_mask:0xf
    s_nop 1
    v_max_f32_dpp v24, v24, v24 quad_perm:[2,3,0,1] row_mask:0xf bank_mask:0xf
    v_sub_f32 v22, v20, v24
    v_exp_f32 v22, v22
    s_nop 0
    v_mul_f32 v25, v21, v22
    s_nop 1
    v_add_f32_dpp v25, v25, v25 quad_perm:[1,0,3,2] row_mask:0xf bank_mask:0xf
    s_nop 1
    v_add_f32_dpp v25, v25, v25 quad_perm:[2,3,0,1] row_mask:0xf bank_mask:0xf
    v_mov_b32 v26, s50
    v_mov_b32 v27, s50
    s_mov_b64 exec, 0x11111111
    s_cmp_eq_u32 s67, 0
    s_cbranch_scc0 L_bm177
    buffer_store_dwordx4 v[24:27], v9, s[40:43], s54 offen
    s_branch L_bme177
L_bm177:
    buffer_store_dwordx4 v[24:27], v9, s[40:43], s54 offen sc1
L_bme177:
    s_mov_b64 exec, -1
    s_mul_i32 s54, s30, 384
    s_add_u32 s54, s54, s31
    s_lshl_b32 s54, s54, 8
    s_add_u32 s54, s54, 1048576
    v_mov_b32 v31, 0xffffff00
    v_lshrrev_b32 v8, 4, v0
    v_lshlrev_b32 v24, 2, v8
    s_mul_i32 s64, s30, 12
    s_add_u32 s64, s64, s48
    s_lshl_b32 s64, s64, 13
    s_add_u32 s64, s64, 1122304
    s_add_u32 s65, s64, 4096
    v_and_b32 v9, 8, v0
    v_lshl_add_u32 v8, v9, 2, v8
    v_and_b32 v9, 3, v0
    v_lshl_add_u32 v8, v9, 3, v8
    v_and_b32 v9, 4, v0
    v_add_lshl_u32 v25, v8, v9, 1
    v_mov_b32 v26, 0xffffff00
    s_cmp_eq_u32 s67, 0
    s_cbranch_scc0 L_bm178
    v_readlane_b32 s90, v22, 0
    v_readlane_b32 s91, v22, 1
    v_readlane_b32 s92, v22, 2
    v_readlane_b32 s93, v22, 3
    s_mov_b32 s57, 524288
L_lw179:
    ds_read_b32 v13, v2 offset:32
    s_waitcnt lgkmcnt(0)
    v_readfirstlane_b32 s52, v13
    s_cmp_ge_u32 s52, 4
    s_cbranch_scc1 L_lwok179
    s_sub_u32 s57, s57, 1
    s_cbranch_scc1 L_lwok179
    s_sleep 4
    s_branch L_lw179
L_lwok179:
    s_mov_b32 exec_hi, 0xffff
    ds_read_b128 v[96:99], v12 offset:17664
    ds_read_b128 v[100:103], v12 offset:18432
    ds_read_b128 v[104:107], v12 offset:19200
    ds_read_b128 v[108:111], v12 offset:19968
    s_waitcnt lgkmcnt(3)
    v_mul_f32 v114, s90, v98
    v_mul_f32 v115, s90, v99
    v_mul_f32 v112, s90, v96
    v_mul_f32 v113, s90, v97
    s_waitcnt lgkmcnt(2)
    v_fmac_f32 v114, s91, v102
    v_fmac_f32 v115, s91, v103
    v_fmac_f32 v112, s91, v100
    v_fmac_f32 v113, s91, v101
    s_waitcnt lgkmcnt(1)
    v_fmac_f32 v114, s92, v106
    v_fmac_f32 v115, s92, v107
    v_fmac_f32 v112, s92, v104
    v_fmac_f32 v113, s92, v105
    s_waitcnt lgkmcnt(0)
    v_fmac_f32 v114, s93, v110
    v_fmac_f32 v115, s93, v111
    v_fmac_f32 v112, s93, v108
    v_fmac_f32 v113, s93, v109
    v_and_or_b32 v115, v115, -4, 1
    buffer_store_dwordx4 v[112:115], v15, s[40:43], s54 offen
    s_mov_b32 exec_hi, -1
    s_add_u32 s54, s54, 24576
    v_readlane_b32 s90, v22, 4
    v_readlane_b32 s91, v22, 5
    v_readlane_b32 s92, v22, 6
    v_readlane_b32 s93, v22, 7
    s_mov_b32 s57, 524288
L_lw180:
    ds_read_b32 v13, v2 offset:36
    s_waitcnt lgkmcnt(0)
    v_readfirstlane_b32 s52, v13
    s_cmp_ge_u32 s52, 4
    s_cbranch_scc1 L_lwok180
    s_sub_u32 s57, s57, 1
    s_cbranch_scc1 L_lwok180
    s_sleep 4
    s_branch L_lw180
L_lwok180:
    s_mov_b32 exec_hi, 0xffff
    ds_read_b128 v[96:99], v12 offset:20736
    ds_read_b128 v[100:103], v12 offset:21504
    ds_read_b128 v[104:107], v12 offset:22272
    ds_read_b128 v[108:111], v12 offset:23040
    s_waitcnt lgkmcnt(3)
    v_mul_f32 v118, s90, v98
    v_mul_f32 v119, s90, v99
    v_mul_f32 v116, s90, v96
    v_mul_f32 v117, s90, v97
    s_waitcnt lgkmcnt(2)
    v_fmac_f32 v118, s91, v102
    v_fmac_f32 v119, s91, v103
    v_fmac_f32 v116, s91, v100
    v_fmac_f32 v117, s91, v101
    s_waitcnt lgkmcnt(1)
    v_fmac_f32 v118, s92, v106
    v_fmac_f32 v119, s92, v107
    v_fmac_f32 v116, s92, v104
    v_fmac_f32 v117, s92, v105
    s_waitcnt lgkmcnt(0)
    v_fmac_f32 v118, s93, v110
    v_fmac_f32 v119, s93, v111
    v_fmac_f32 v116, s93, v108
    v_fmac_f32 v117, s93, v109
    v_and_or_b32 v119, v119, -4, 1
    buffer_store_dwordx4 v[116:119], v15, s[40:43], s54 offen
    s_mov_b32 exec_hi, -1
    s_add_u32 s54, s54, 24576
    v_readlane_b32 s90, v22, 8
    v_readlane_b32 s91, v22, 9
    v_readlane_b32 s92, v22, 10
    v_readlane_b32 s93, v22, 11
    s_mov_b32 s57, 524288
L_lw181:
    ds_read_b32 v13, v2 offset:68
    s_waitcnt lgkmcnt(0)
    v_readfirstlane_b32 s52, v13
    s_cmp_ge_u32 s52, 1
    s_cbranch_scc1 L_lwok181
    s_sub_u32 s57, s57, 1
    s_cbranch_scc1 L_lwok181
    s_sleep 4
    s_branch L_lw181
L_lwok181:
    s_mov_b32 s57, 524288
L_lw182:
    ds_read_b32 v13, v2 offset:40
    s_waitcnt lgkmcnt(0)
    v_readfirstlane_b32 s52, v13
    s_cmp_ge_u32 s52, 4
    s_cbranch_scc1 L_lwok182
    s_sub_u32 s57, s57, 1
    s_cbranch_scc1 L_lwok182
    s_sleep 4
    s_branch L_lw182
L_lwok182:
    s_mov_b32 exec_hi, 0xffff
    ds_read_b128 v[96:99], v12 offset:23808
    ds_read_b128 v[100:103], v12 offset:24576
    ds_read_b128 v[104:107], v12 offset:25344
    ds_read_b128 v[108:111], v12 offset:26112
    s_waitcnt lgkmcnt(3)
    v_mul_f32 v114, s90, v98
    v_mul_f32 v115, s90, v99
    v_mul_f32 v112, s90, v96
    v_mul_f32 v113, s90, v97
    s_waitcnt lgkmcnt(2)
    v_fmac_f32 v114, s91, v102
    v_fmac_f32 v115, s91, v103
    v_fmac_f32 v112, s91, v100
    v_fmac_f32 v113, s91, v101
    s_waitcnt lgkmcnt(1)
    v_fmac_f32 v114, s92, v106
    v_fmac_f32 v115, s92, v107
    v_fmac_f32 v112, s92, v104
    v_fmac_f32 v113, s92, v105
    s_waitcnt lgkmcnt(0)
    v_fmac_f32 v114, s93, v110
    v_fmac_f32 v115, s93, v111
    v_fmac_f32 v112, s93, v108
    v_fmac_f32 v113, s93, v109
    v_and_or_b32 v115, v115, -4, 1
    buffer_store_dwordx4 v[112:115], v15, s[40:43], s54 offen
    s_mov_b32 exec_hi, -1
    s_add_u32 s54, s54, 24576
    v_readlane_b32 s90, v22, 12
    v_readlane_b32 s91, v22, 13
    v_readlane_b32 s92, v22, 14
    v_readlane_b32 s93, v22, 15
    s_mov_b32 s57, 524288
L_lw183:
    ds_read_b32 v13, v2 offset:68
    s_waitcnt lgkmcnt(0)
    v_readfirstlane_b32 s52, v13
    s_cmp_ge_u32 s52, 2
    s_cbranch_scc1 L_lwok183
    s_sub_u32 s57, s57, 1
    s_cbranch_scc1 L_lwok183
    s_sleep 4
    s_branch L_lw183
L_lwok183:
    s_mov_b32 s57, 524288
L_lw184:
    ds_read_b32 v13, v2 offset:44
    s_waitcnt lgkmcnt(0)
    v_readfirstlane_b32 s52, v13
    s_cmp_ge_u32 s52, 4
    s_cbranch_scc1 L_lwok184
    s_sub_u32 s57, s57, 1
    s_cbranch_scc1 L_lwok184
    s_sleep 4
    s_branch L_lw184
L_lwok184:
    s_mov_b32 exec_hi, 0xffff
    ds_read_b128 v[96:99], v12 offset:26880
    ds_read_b128 v[100:103], v12 offset:27648
    ds_read_b128 v[104:107], v12 offset:28416
    ds_read_b128 v[108:111], v12 offset:29184
    s_waitcnt lgkmcnt(3)
    v_mul_f32 v118, s90, v98
    v_mul_f32 v119, s90, v99
    v_mul_f32 v116, s90, v96
    v_mul_f32 v117, s90, v97
    s_waitcnt lgkmcnt(2)
    v_fmac_f32 v118, s91, v102
    v_fmac_f32 v119, s91, v103
    v_fmac_f32 v116, s91, v100
    v_fmac_f32 v117, s91, v101
    s_waitcnt lgkmcnt(1)
    v_fmac_f32 v118, s92, v106
    v_fmac_f32 v119, s92, v107
    v_fmac_f32 v116, s92, v104
    v_fmac_f32 v117, s92, v105
    s_waitcnt lgkmcnt(0)
    v_fmac_f32 v118, s93, v110
    v_fmac_f32 v119, s93, v111
    v_fmac_f32 v116, s93, v108
    v_fmac_f32 v117, s93, v109
    v_and_or_b32 v119, v119, -4, 1
    buffer_store_dwordx4 v[116:119], v15, s[40:43], s54 offen
    s_mov_b32 exec_hi, -1
    s_sub_u32 s54, s54, 73728
    v_readlane_b32 s90, v22, 16
    v_readlane_b32 s91, v22, 17
    v_readlane_b32 s92, v22, 18
    v_readlane_b32 s93, v22, 19
    s_mov_b32 s57, 524288
L_lw185:
    ds_read_b32 v13, v2 offset:68
    s_waitcnt lgkmcnt(0)
    v_readfirstlane_b32 s52, v13
    s_cmp_ge_u32 s52, 3
    s_cbranch_scc1 L_lwok185
    s_sub_u32 s57, s57, 1
    s_cbranch_scc1 L_lwok185
    s_sleep 4
    s_branch L_lw185
L_lwok185:
    s_mov_b32 s57, 524288
L_lw186:
    ds_read_b32 v13, v2 offset:48
    s_waitcnt lgkmcnt(0)
    v_readfirstlane_b32 s52, v13
    s_cmp_ge_u32 s52, 4
    s_cbranch_scc1 L_lwok186
    s_sub_u32 s57, s57, 1
    s_cbranch_scc1 L_lwok186
    s_sleep 4
    s_branch L_lw186
L_lwok186:
    s_mov_b32 exec_hi, 0xffff
    ds_read_b128 v[96:99], v12 offset:29952
    ds_read_b128 v[100:103], v12 offset:30720
    ds_read_b128 v[104:107], v12 offset:31488
    ds_read_b128 v[108:111], v12 offset:32256
    s_waitcnt lgkmcnt(3)
    v_mul_f32 v114, s90, v98
    v_mul_f32 v115, s90, v99
    v_mul_f32 v112, s90, v96
    v_mul_f32 v113, s90, v97
    s_waitcnt lgkmcnt(2)
    v_fmac_f32 v114, s91, v102
    v_fmac_f32 v115, s91, v103
    v_fmac_f32 v112, s91, v100
    v_fmac_f32 v113, s91, v101
    s_waitcnt lgkmcnt(1)
    v_fmac_f32 v114, s92, v106
    v_fmac_f32 v115, s92, v107
    v_fmac_f32 v112, s92, v104
    v_fmac_f32 v113, s92, v105
    s_waitcnt lgkmcnt(0)
    v_fmac_f32 v114, s93, v110
    v_fmac_f32 v115, s93, v111
    v_fmac_f32 v112, s93, v108
    v_fmac_f32 v113, s93, v109
    v_and_or_b32 v115, v115, -4, 2
    buffer_store_dwordx4 v[112:115], v15, s[40:43], s54 offen
    s_mov_b32 exec_hi, -1
    s_add_u32 s54, s54, 24576
    v_readlane_b32 s90, v22, 20
    v_readlane_b32 s91, v22, 21
    v_readlane_b32 s92, v22, 22
    v_readlane_b32 s93, v22, 23
    s_mov_b32 s57, 524288
L_lw187:
    ds_read_b32 v13, v2 offset:68
    s_waitcnt lgkmcnt(0)
    v_readfirstlane_b32 s52, v13
    s_cmp_ge_u32 s52, 4
    s_cbranch_scc1 L_lwok187
    s_sub_u32 s57, s57, 1
    s_cbranch_scc1 L_lwok187
    s_sleep 4
    s_branch L_lw187
L_lwok187:
    s_mov_b32 s57, 524288
L_lw188:
    ds_read_b32 v13, v2 offset:52
    s_waitcnt lgkmcnt(0)
    v_readfirstlane_b32 s52, v13
    s_cmp_ge_u32 s52, 4
    s_cbranch_scc1 L_lwok188
    s_sub_u32 s57, s57, 1
    s_cbranch_scc1 L_lwok188
    s_sleep 4
    s_branch L_lw188
L_lwok188:
    s_mov_b32 exec_hi, 0xffff
    ds_read_b128 v[96:99], v12 offset:33024
    ds_read_b128 v[100:103], v12 offset:33792
    ds_read_b128 v[104:107], v12 offset:34560
    ds_read_b128 v[108:111], v12 offset:35328
    s_waitcnt lgkmcnt(3)
    v_mul_f32 v118, s90, v98
    v_mul_f32 v119, s90, v99
    v_mul_f32 v116, s90, v96
    v_mul_f32 v117, s90, v97
    s_waitcnt lgkmcnt(2)
    v_fmac_f32 v118, s91, v102
    v_fmac_f32 v119, s91, v103
    v_fmac_f32 v116, s91, v100
    v_fmac_f32 v117, s91, v101
    s_waitcnt lgkmcnt(1)
    v_fmac_f32 v118, s92, v106
    v_fmac_f32 v119, s92, v107
    v_fmac_f32 v116, s92, v104
    v_fmac_f32 v117, s92, v105
    s_waitcnt lgkmcnt(0)
    v_fmac_f32 v118, s93, v110
    v_fmac_f32 v119, s93, v111
    v_fmac_f32 v116, s93, v108
    v_fmac_f32 v117, s93, v109
    v_and_or_b32 v119, v119, -4, 2
    buffer_store_dwordx4 v[116:119], v15, s[40:43], s54 offen
    s_mov_b32 exec_hi, -1
    s_add_u32 s54, s54, 24576
    v_readlane_b32 s90, v22, 24
    v_readlane_b32 s91, v22, 25
    v_readlane_b32 s92, v22, 26
    v_readlane_b32 s93, v22, 27
    s_mov_b32 s57, 524288
L_lw189:
    ds_read_b32 v13, v2 offset:68
    s_waitcnt lgkmcnt(0)
    v_readfirstlane_b32 s52, v13
    s_cmp_ge_u32 s52, 5
    s_cbranch_scc1 L_lwok189
    s_sub_u32 s57, s57, 1
    s_cbranch_scc1 L_lwok189
    s_sleep 4
    s_branch L_lw189
L_lwok189:
    s_mov_b32 s57, 524288
L_lw190:
    ds_read_b32 v13, v2 offset:56
    s_waitcnt lgkmcnt(0)
    v_readfirstlane_b32 s52, v13
    s_cmp_ge_u32 s52, 4
    s_cbranch_scc1 L_lwok190
    s_sub_u32 s57, s57, 1
    s_cbranch_scc1 L_lwok190
    s_sleep 4
    s_branch L_lw190
L_lwok190:
    s_mov_b32 exec_hi, 0xffff
    ds_read_b128 v[96:99], v12 offset:36096
    ds_read_b128 v[100:103], v12 offset:36864
    ds_read_b128 v[104:107], v12 offset:37632
    ds_read_b128 v[108:111], v12 offset:38400
    s_waitcnt lgkmcnt(3)
    v_mul_f32 v114, s90, v98
    v_mul_f32 v115, s90, v99
    v_mul_f32 v112, s90, v96
    v_mul_f32 v113, s90, v97
    s_waitcnt lgkmcnt(2)
    v_fmac_f32 v114, s91, v102
    v_fmac_f32 v115, s91, v103
    v_fmac_f32 v112, s91, v100
    v_fmac_f32 v113, s91, v101
    s_waitcnt lgkmcnt(1)
    v_fmac_f32 v114, s92, v106
    v_fmac_f32 v115, s92, v107
    v_fmac_f32 v112, s92, v104
    v_fmac_f32 v113, s92, v105
    s_waitcnt lgkmcnt(0)
    v_fmac_f32 v114, s93, v110
    v_fmac_f32 v115, s93, v111
    v_fmac_f32 v112, s93, v108
    v_fmac_f32 v113, s93, v109
    v_and_or_b32 v115, v115, -4, 2
    buffer_store_dwordx4 v[112:115], v15, s[40:43], s54 offen
    s_mov_b32 exec_hi, -1
    s_add_u32 s54, s54, 24576
    v_readlane_b32 s90, v22, 28
    v_readlane_b32 s91, v22, 29
    v_readlane_b32 s92, v22, 30
    v_readlane_b32 s93, v22, 31
    s_mov_b32 s57, 524288
L_lw191:
    ds_read_b32 v13, v2 offset:68
    s_waitcnt lgkmcnt(0)
    v_readfirstlane_b32 s52, v13
    s_cmp_ge_u32 s52, 6
    s_cbranch_scc1 L_lwok191
    s_sub_u32 s57, s57, 1
    s_cbranch_scc1 L_lwok191
    s_sleep 4
    s_branch L_lw191
L_lwok191:
    ds_read_b32 v40, v24 offset:3072
    ds_read_b32 v41, v24 offset:3088
    ds_read_b32 v42, v24 offset:3104
    ds_read_b32 v43, v24 offset:3120
    ds_read_b32 v44, v24 offset:3136
    ds_read_b32 v45, v24 offset:3152
    ds_read_b32 v46, v24 offset:3168
    ds_read_b32 v47, v24 offset:3184
    s_mov_b32 s57, 524288
L_lw193:
    ds_read_b32 v13, v2 offset:60
    s_waitcnt lgkmcnt(0)
    v_readfirstlane_b32 s52, v13
    s_cmp_ge_u32 s52, 1
    s_cbranch_scc1 L_lwok193
    s_sub_u32 s57, s57, 1
    s_cbranch_scc1 L_lwok193
    s_sleep 1
    s_branch L_lw193
L_lwok193:
    s_mov_b32 exec_hi, 0xffff
    s_mov_b32 s57, 524288
L_sp192:
    ds_read_b32 v13, v2 offset:60
    ds_read_b128 v[96:99], v12 offset:39168
    ds_read_b128 v[100:103], v12 offset:39936
    ds_read_b128 v[104:107], v12 offset:40704
    ds_read_b128 v[108:111], v12 offset:41472
    s_sub_u32 s57, s57, 1
    s_cbranch_scc1 L_spo192
    s_waitcnt lgkmcnt(4)
    v_readfirstlane_b32 s52, v13
    s_cmp_ge_u32 s52, 4
    s_cbranch_scc0 L_sp192
L_spo192:
    s_waitcnt lgkmcnt(3)
    v_mul_f32 v118, s90, v98
    v_mul_f32 v119, s90, v99
    v_mul_f32 v116, s90, v96
    v_mul_f32 v117, s90, v97
    s_waitcnt lgkmcnt(2)
    v_fmac_f32 v118, s91, v102
    v_fmac_f32 v119, s91, v103
    v_fmac_f32 v116, s91, v100
    v_fmac_f32 v117, s91, v101
    s_waitcnt lgkmcnt(1)
    v_fmac_f32 v118, s92, v106
    v_fmac_f32 v119, s92, v107
    v_fmac_f32 v116, s92, v104
    v_fmac_f32 v117, s92, v105
    s_waitcnt lgkmcnt(0)
    v_fmac_f32 v118, s93, v110
    v_fmac_f32 v119, s93, v111
    v_fmac_f32 v116, s93, v108
    v_fmac_f32 v117, s93, v109
    v_and_or_b32 v119, v119, -4, 2
    buffer_store_dwordx4 v[116:119], v15, s[40:43], s54 offen
    s_mov_b32 exec_hi, -1
    s_mov_b32 s57, 65536
L_gb194:
    buffer_load_dwordx4 v[128:131], v12, s[40:43], s64 offen offset:0 nt
    buffer_load_dwordx4 v[132:135], v12, s[40:43], s64 offen offset:1024 nt
    buffer_load_dwordx4 v[136:139], v12, s[40:43], s64 offen offset:2048 nt
    buffer_load_dwordx4 v[140:143], v12, s[40:43], s64 offen offset:3072 nt
    buffer_load_dwordx4 v[144:147], v12, s[40:43], s65 offen offset:0 nt
    buffer_load_dwordx4 v[148:151], v12, s[40:43], s65 offen offset:1024 nt
    buffer_load_dwordx4 v[152:155], v12, s[40:43], s65 offen offset:2048 nt
    buffer_load_dwordx4 v[156:159], v12, s[40:43], s65 offen offset:3072 nt
    s_waitcnt vmcnt(4)
    v_bitop3_b32 v13, v131, v135, 2 bitop3:0x80
    v_bitop3_b32 v13, v139, v143, v13 bitop3:0x80
    v_cmp_eq_u32 vcc, 0, v13
    v_pk_mul_f32 v[32:33], v[40:41], v[128:129] op_sel_hi:[0,1]
    v_pk_mul_f32 v[34:35], v[40:41], v[130:131] op_sel_hi:[0,1]
    v_pk_fma_f32 v[32:33], v[40:41], v[132:133], v[32:33] op_sel:[1,0,0] op_sel_hi:[1,1,1]
    v_pk_fma_f32 v[34:35], v[40:41], v[134:135], v[34:35] op_sel:[1,0,0] op_sel_hi:[1,1,1]
    v_pk_fma_f32 v[32:33], v[42:43], v[136:137], v[32:33] op_sel_hi:[0,1,1]
    v_pk_fma_f32 v[34:35], v[42:43], v[138:139], v[34:35] op_sel_hi:[0,1,1]
    v_pk_fma_f32 v[32:33], v[42:43], v[140:141], v[32:33] op_sel:[1,0,0] op_sel_hi:[1,1,1]
    v_pk_fma_f32 v[34:35], v[42:43], v[142:143], v[34:35] op_sel:[1,0,0] op_sel_hi:[1,1,1]
    s_cbranch_vccz L_g1w194
    s_waitcnt vmcnt(0)
    v_bitop3_b32 v13, v147, v151, 2 bitop3:0x80
    v_bitop3_b32 v13, v155, v159, v13 bitop3:0x80
    v_cmp_eq_u32 vcc, 0, v13
    v_pk_mul_f32 v[36:37], v[44:45], v[144:145] op_sel_hi:[0,1]
    v_pk_mul_f32 v[38:39], v[44:45], v[146:147] op_sel_hi:[0,1]
    v_pk_fma_f32 v[36:37], v[44:45], v[148:149], v[36:37] op_sel:[1,0,0] op_sel_hi:[1,1,1]
    v_pk_fma_f32 v[38:39], v[44:45], v[150:151], v[38:39] op_sel:[1,0,0] op_sel_hi:[1,1,1]
    v_pk_fma_f32 v[36:37], v[46:47], v[152:153], v[36:37] op_sel_hi:[0,1,1]
    v_pk_fma_f32 v[38:39], v[46:47], v[154:155], v[38:39] op_sel_hi:[0,1,1]
    v_pk_fma_f32 v[36:37], v[46:47], v[156:157], v[36:37] op_sel:[1,0,0] op_sel_hi:[1,1,1]
    v_pk_fma_f32 v[38:39], v[46:47], v[158:159], v[38:39] op_sel:[1,0,0] op_sel_hi:[1,1,1]
    s_cbranch_vccz L_g0194
    s_sub_u32 s57, s57, 1
    s_cbranch_scc0 L_gb194
    s_branch L_gd194
L_g0194:
    buffer_load_dwordx4 v[128:131], v12, s[40:43], s64 offen offset:0 nt
    buffer_load_dwordx4 v[132:135], v12, s[40:43], s64 offen offset:1024 nt
    buffer_load_dwordx4 v[136:139], v12, s[40:43], s64 offen offset:2048 nt
    buffer_load_dwordx4 v[140:143], v12, s[40:43], s64 offen offset:3072 nt
    s_waitcnt vmcnt(0)
    v_bitop3_b32 v13, v131, v135, 2 bitop3:0x80
    v_bitop3_b32 v13, v139, v143, v13 bitop3:0x80
    v_cmp_eq_u32 vcc, 0, v13
    v_pk_mul_f32 v[32:33], v[40:41], v[128:129] op_sel_hi:[0,1]
    v_pk_mul_f32 v[34:35], v[40:41], v[130:131] op_sel_hi:[0,1]
    v_pk_fma_f32 v[32:33], v[40:41], v[132:133], v[32:33] op_sel:[1,0,0] op_sel_hi:[1,1,1]
    v_pk_fma_f32 v[34:35], v[40:41], v[134:135], v[34:35] op_sel:[1,0,0] op_sel_hi:[1,1,1]
    v_pk_fma_f32 v[32:33], v[42:43], v[136:137], v[32:33] op_sel_hi:[0,1,1]
    v_pk_fma_f32 v[34:35], v[42:43], v[138:139], v[34:35] op_sel_hi:[0,1,1]
    v_pk_fma_f32 v[32:33], v[42:43], v[140:141], v[32:33] op_sel:[1,0,0] op_sel_hi:[1,1,1]
    v_pk_fma_f32 v[34:35], v[42:43], v[142:143], v[34:35] op_sel:[1,0,0] op_sel_hi:[1,1,1]
    s_cbranch_vccz L_gd194
    s_sub_u32 s57, s57, 1
    s_cbranch_scc0 L_g0194
    s_branch L_gd194
L_g1194:
    buffer_load_dwordx4 v[144:147], v12, s[40:43], s65 offen offset:0 nt
    buffer_load_dwordx4 v[148:151], v12, s[40:43], s65 offen offset:1024 nt
    buffer_load_dwordx4 v[152:155], v12, s[40:43], s65 offen offset:2048 nt
    buffer_load_dwordx4 v[156:159], v12, s[40:43], s65 offen offset:3072 nt
L_g1w194:
    s_waitcnt vmcnt(0)
    v_bitop3_b32 v13, v147, v151, 2 bitop3:0x80
    v_bitop3_b32 v13, v155, v159, v13 bitop3:0x80
    v_cmp_eq_u32 vcc, 0, v13
    v_pk_mul_f32 v[36:37], v[44:45], v[144:145] op_sel_hi:[0,1]
    v_pk_mul_f32 v[38:39], v[44:45], v[146:147] op_sel_hi:[0,1]
    v_pk_fma_f32 v[36:37], v[44:45], v[148:149], v[36:37] op_sel:[1,0,0] op_sel_hi:[1,1,1]
    v_pk_fma_f32 v[38:39], v[44:45], v[150:151], v[38:39] op_sel:[1,0,0] op_sel_hi:[1,1,1]
    v_pk_fma_f32 v[36:37], v[46:47], v[152:153], v[36:37] op_sel_hi:[0,1,1]
    v_pk_fma_f32 v[38:39], v[46:47], v[154:155], v[38:39] op_sel_hi:[0,1,1]
    v_pk_fma_f32 v[36:37], v[46:47], v[156:157], v[36:37] op_sel:[1,0,0] op_sel_hi:[1,1,1]
    v_pk_fma_f32 v[38:39], v[46:47], v[158:159], v[38:39] op_sel:[1,0,0] op_sel_hi:[1,1,1]
    s_cbranch_vccz L_gd194
    s_sub_u32 s57, s57, 1
    s_cbranch_scc0 L_g1194
L_gd194:
    v_pk_add_f32 v[32:33], v[32:33], v[36:37]
    v_pk_add_f32 v[34:35], v[34:35], v[38:39]
    s_nop 1
    v_permlane32_swap_b32 v32, v34
    v_permlane32_swap_b32 v33, v35
    v_add_f32 v32, v32, v34
    v_add_f32 v33, v33, v35
    s_nop 1
    v_permlane16_swap_b32 v32, v33
    v_add_f32 v32, v32, v33
    v_cvt_pk_bf16_f32 v32, v32, v32
    ds_write_b16 v25, v32 offset:1984
    s_waitcnt lgkmcnt(0)
    s_branch L_bme178
L_bm178:
    v_readlane_b32 s90, v22, 0
    v_readlane_b32 s91, v22, 1
    v_readlane_b32 s92, v22, 2
    v_readlane_b32 s93, v22, 3
    s_mov_b32 s57, 524288
L_lw195:
    ds_read_b32 v13, v2 offset:32
    s_waitcnt lgkmcnt(0)
    v_readfirstlane_b32 s52, v13
    s_cmp_ge_u32 s52, 4
    s_cbranch_scc1 L_lwok195
    s_sub_u32 s57, s57, 1
    s_cbranch_scc1 L_lwok195
    s_sleep 4
    s_branch L_lw195
L_lwok195:
    s_mov_b32 exec_hi, 0xffff
    ds_read_b128 v[96:99], v12 offset:17664
    ds_read_b128 v[100:103], v12 offset:18432
    ds_read_b128 v[104:107], v12 offset:19200
    ds_read_b128 v[108:111], v12 offset:19968
    s_waitcnt lgkmcnt(3)
    v_mul_f32 v114, s90, v98
    v_mul_f32 v115, s90, v99
    v_mul_f32 v112, s90, v96
    v_mul_f32 v113, s90, v97
    s_waitcnt lgkmcnt(2)
    v_fmac_f32 v114, s91, v102
    v_fmac_f32 v115, s91, v103
    v_fmac_f32 v112, s91, v100
    v_fmac_f32 v113, s91, v101
    s_waitcnt lgkmcnt(1)
    v_fmac_f32 v114, s92, v106
    v_fmac_f32 v115, s92, v107
    v_fmac_f32 v112, s92, v104
    v_fmac_f32 v113, s92, v105
    s_waitcnt lgkmcnt(0)
    v_fmac_f32 v114, s93, v110
    v_fmac_f32 v115, s93, v111
    v_fmac_f32 v112, s93, v108
    v_fmac_f32 v113, s93, v109
    v_and_or_b32 v115, v115, -4, 1
    buffer_store_dwordx4 v[112:115], v15, s[40:43], s54 offen sc1
    s_mov_b32 exec_hi, -1
    s_add_u32 s54, s54, 24576
    v_readlane_b32 s90, v22, 4
    v_readlane_b32 s91, v22, 5
    v_readlane_b32 s92, v22, 6
    v_readlane_b32 s93, v22, 7
    s_mov_b32 s57, 524288
L_lw196:
    ds_read_b32 v13, v2 offset:36
    s_waitcnt lgkmcnt(0)
    v_readfirstlane_b32 s52, v13
    s_cmp_ge_u32 s52, 4
    s_cbranch_scc1 L_lwok196
    s_sub_u32 s57, s57, 1
    s_cbranch_scc1 L_lwok196
    s_sleep 4
    s_branch L_lw196
L_lwok196:
    s_mov_b32 exec_hi, 0xffff
    ds_read_b128 v[96:99], v12 offset:20736
    ds_read_b128 v[100:103], v12 offset:21504
    ds_read_b128 v[104:107], v12 offset:22272
    ds_read_b128 v[108:111], v12 offset:23040
    s_waitcnt lgkmcnt(3)
    v_mul_f32 v118, s90, v98
    v_mul_f32 v119, s90, v99
    v_mul_f32 v116, s90, v96
    v_mul_f32 v117, s90, v97
    s_waitcnt lgkmcnt(2)
    v_fmac_f32 v118, s91, v102
    v_fmac_f32 v119, s91, v103
    v_fmac_f32 v116, s91, v100
    v_fmac_f32 v117, s91, v101
    s_waitcnt lgkmcnt(1)
    v_fmac_f32 v118, s92, v106
    v_fmac_f32 v119, s92, v107
    v_fmac_f32 v116, s92, v104
    v_fmac_f32 v117, s92, v105
    s_waitcnt lgkmcnt(0)
    v_fmac_f32 v118, s93, v110
    v_fmac_f32 v119, s93, v111
    v_fmac_f32 v116, s93, v108
    v_fmac_f32 v117, s93, v109
    v_and_or_b32 v119, v119, -4, 1
    buffer_store_dwordx4 v[116:119], v15, s[40:43], s54 offen sc1
    s_mov_b32 exec_hi, -1
    s_add_u32 s54, s54, 24576
    v_readlane_b32 s90, v22, 8
    v_readlane_b32 s91, v22, 9
    v_readlane_b32 s92, v22, 10
    v_readlane_b32 s93, v22, 11
    s_mov_b32 s57, 524288
L_lw197:
    ds_read_b32 v13, v2 offset:68
    s_waitcnt lgkmcnt(0)
    v_readfirstlane_b32 s52, v13
    s_cmp_ge_u32 s52, 1
    s_cbranch_scc1 L_lwok197
    s_sub_u32 s57, s57, 1
    s_cbranch_scc1 L_lwok197
    s_sleep 4
    s_branch L_lw197
L_lwok197:
    s_mov_b32 s57, 524288
L_lw198:
    ds_read_b32 v13, v2 offset:40
    s_waitcnt lgkmcnt(0)
    v_readfirstlane_b32 s52, v13
    s_cmp_ge_u32 s52, 4
    s_cbranch_scc1 L_lwok198
    s_sub_u32 s57, s57, 1
    s_cbranch_scc1 L_lwok198
    s_sleep 4
    s_branch L_lw198
L_lwok198:
    s_mov_b32 exec_hi, 0xffff
    ds_read_b128 v[96:99], v12 offset:23808
    ds_read_b128 v[100:103], v12 offset:24576
    ds_read_b128 v[104:107], v12 offset:25344
    ds_read_b128 v[108:111], v12 offset:26112
    s_waitcnt lgkmcnt(3)
    v_mul_f32 v114, s90, v98
    v_mul_f32 v115, s90, v99
    v_mul_f32 v112, s90, v96
    v_mul_f32 v113, s90, v97
    s_waitcnt lgkmcnt(2)
    v_fmac_f32 v114, s91, v102
    v_fmac_f32 v115, s91, v103
    v_fmac_f32 v112, s91, v100
    v_fmac_f32 v113, s91, v101
    s_waitcnt lgkmcnt(1)
    v_fmac_f32 v114, s92, v106
    v_fmac_f32 v115, s92, v107
    v_fmac_f32 v112, s92, v104
    v_fmac_f32 v113, s92, v105
    s_waitcnt lgkmcnt(0)
    v_fmac_f32 v114, s93, v110
    v_fmac_f32 v115, s93, v111
    v_fmac_f32 v112, s93, v108
    v_fmac_f32 v113, s93, v109
    v_and_or_b32 v115, v115, -4, 1
    buffer_store_dwordx4 v[112:115], v15, s[40:43], s54 offen sc1
    s_mov_b32 exec_hi, -1
    s_add_u32 s54, s54, 24576
    v_readlane_b32 s90, v22, 12
    v_readlane_b32 s91, v22, 13
    v_readlane_b32 s92, v22, 14
    v_readlane_b32 s93, v22, 15
    s_mov_b32 s57, 524288
L_lw199:
    ds_read_b32 v13, v2 offset:68
    s_waitcnt lgkmcnt(0)
    v_readfirstlane_b32 s52, v13
    s_cmp_ge_u32 s52, 2
    s_cbranch_scc1 L_lwok199
    s_sub_u32 s57, s57, 1
    s_cbranch_scc1 L_lwok199
    s_sleep 4
    s_branch L_lw199
L_lwok199:
    s_mov_b32 s57, 524288
L_lw200:
    ds_read_b32 v13, v2 offset:44
    s_waitcnt lgkmcnt(0)
    v_readfirstlane_b32 s52, v13
    s_cmp_ge_u32 s52, 4
    s_cbranch_scc1 L_lwok200
    s_sub_u32 s57, s57, 1
    s_cbranch_scc1 L_lwok200
    s_sleep 4
    s_branch L_lw200
L_lwok200:
    s_mov_b32 exec_hi, 0xffff
    ds_read_b128 v[96:99], v12 offset:26880
    ds_read_b128 v[100:103], v12 offset:27648
    ds_read_b128 v[104:107], v12 offset:28416
    ds_read_b128 v[108:111], v12 offset:29184
    s_waitcnt lgkmcnt(3)
    v_mul_f32 v118, s90, v98
    v_mul_f32 v119, s90, v99
    v_mul_f32 v116, s90, v96
    v_mul_f32 v117, s90, v97
    s_waitcnt lgkmcnt(2)
    v_fmac_f32 v118, s91, v102
    v_fmac_f32 v119, s91, v103
    v_fmac_f32 v116, s91, v100
    v_fmac_f32 v117, s91, v101
    s_waitcnt lgkmcnt(1)
    v_fmac_f32 v118, s92, v106
    v_fmac_f32 v119, s92, v107
    v_fmac_f32 v116, s92, v104
    v_fmac_f32 v117, s92, v105
    s_waitcnt lgkmcnt(0)
    v_fmac_f32 v118, s93, v110
    v_fmac_f32 v119, s93, v111
    v_fmac_f32 v116, s93, v108
    v_fmac_f32 v117, s93, v109
    v_and_or_b32 v119, v119, -4, 1
    buffer_store_dwordx4 v[116:119], v15, s[40:43], s54 offen sc1
    s_mov_b32 exec_hi, -1
    s_sub_u32 s54, s54, 73728
    v_readlane_b32 s90, v22, 16
    v_readlane_b32 s91, v22, 17
    v_readlane_b32 s92, v22, 18
    v_readlane_b32 s93, v22, 19
    s_mov_b32 s57, 524288
L_lw201:
    ds_read_b32 v13, v2 offset:68
    s_waitcnt lgkmcnt(0)
    v_readfirstlane_b32 s52, v13
    s_cmp_ge_u32 s52, 3
    s_cbranch_scc1 L_lwok201
    s_sub_u32 s57, s57, 1
    s_cbranch_scc1 L_lwok201
    s_sleep 4
    s_branch L_lw201
L_lwok201:
    s_mov_b32 s57, 524288
L_lw202:
    ds_read_b32 v13, v2 offset:48
    s_waitcnt lgkmcnt(0)
    v_readfirstlane_b32 s52, v13
    s_cmp_ge_u32 s52, 4
    s_cbranch_scc1 L_lwok202
    s_sub_u32 s57, s57, 1
    s_cbranch_scc1 L_lwok202
    s_sleep 4
    s_branch L_lw202
L_lwok202:
    s_mov_b32 exec_hi, 0xffff
    ds_read_b128 v[96:99], v12 offset:29952
    ds_read_b128 v[100:103], v12 offset:30720
    ds_read_b128 v[104:107], v12 offset:31488
    ds_read_b128 v[108:111], v12 offset:32256
    s_waitcnt lgkmcnt(3)
    v_mul_f32 v114, s90, v98
    v_mul_f32 v115, s90, v99
    v_mul_f32 v112, s90, v96
    v_mul_f32 v113, s90, v97
    s_waitcnt lgkmcnt(2)
    v_fmac_f32 v114, s91, v102
    v_fmac_f32 v115, s91, v103
    v_fmac_f32 v112, s91, v100
    v_fmac_f32 v113, s91, v101
    s_waitcnt lgkmcnt(1)
    v_fmac_f32 v114, s92, v106
    v_fmac_f32 v115, s92, v107
    v_fmac_f32 v112, s92, v104
    v_fmac_f32 v113, s92, v105
    s_waitcnt lgkmcnt(0)
    v_fmac_f32 v114, s93, v110
    v_fmac_f32 v115, s93, v111
    v_fmac_f32 v112, s93, v108
    v_fmac_f32 v113, s93, v109
    v_and_or_b32 v115, v115, -4, 2
    buffer_store_dwordx4 v[112:115], v15, s[40:43], s54 offen sc1
    s_mov_b32 exec_hi, -1
    s_add_u32 s54, s54, 24576
    v_readlane_b32 s90, v22, 20
    v_readlane_b32 s91, v22, 21
    v_readlane_b32 s92, v22, 22
    v_readlane_b32 s93, v22, 23
    s_mov_b32 s57, 524288
L_lw203:
    ds_read_b32 v13, v2 offset:68
    s_waitcnt lgkmcnt(0)
    v_readfirstlane_b32 s52, v13
    s_cmp_ge_u32 s52, 4
    s_cbranch_scc1 L_lwok203
    s_sub_u32 s57, s57, 1
    s_cbranch_scc1 L_lwok203
    s_sleep 4
    s_branch L_lw203
L_lwok203:
    s_mov_b32 s57, 524288
L_lw204:
    ds_read_b32 v13, v2 offset:52
    s_waitcnt lgkmcnt(0)
    v_readfirstlane_b32 s52, v13
    s_cmp_ge_u32 s52, 4
    s_cbranch_scc1 L_lwok204
    s_sub_u32 s57, s57, 1
    s_cbranch_scc1 L_lwok204
    s_sleep 4
    s_branch L_lw204
L_lwok204:
    s_mov_b32 exec_hi, 0xffff
    ds_read_b128 v[96:99], v12 offset:33024
    ds_read_b128 v[100:103], v12 offset:33792
    ds_read_b128 v[104:107], v12 offset:34560
    ds_read_b128 v[108:111], v12 offset:35328
    s_waitcnt lgkmcnt(3)
    v_mul_f32 v118, s90, v98
    v_mul_f32 v119, s90, v99
    v_mul_f32 v116, s90, v96
    v_mul_f32 v117, s90, v97
    s_waitcnt lgkmcnt(2)
    v_fmac_f32 v118, s91, v102
    v_fmac_f32 v119, s91, v103
    v_fmac_f32 v116, s91, v100
    v_fmac_f32 v117, s91, v101
    s_waitcnt lgkmcnt(1)
    v_fmac_f32 v118, s92, v106
    v_fmac_f32 v119, s92, v107
    v_fmac_f32 v116, s92, v104
    v_fmac_f32 v117, s92, v105
    s_waitcnt lgkmcnt(0)
    v_fmac_f32 v118, s93, v110
    v_fmac_f32 v119, s93, v111
    v_fmac_f32 v116, s93, v108
    v_fmac_f32 v117, s93, v109
    v_and_or_b32 v119, v119, -4, 2
    buffer_store_dwordx4 v[116:119], v15, s[40:43], s54 offen sc1
    s_mov_b32 exec_hi, -1
    s_add_u32 s54, s54, 24576
    v_readlane_b32 s90, v22, 24
    v_readlane_b32 s91, v22, 25
    v_readlane_b32 s92, v22, 26
    v_readlane_b32 s93, v22, 27
    s_mov_b32 s57, 524288
L_lw205:
    ds_read_b32 v13, v2 offset:68
    s_waitcnt lgkmcnt(0)
    v_readfirstlane_b32 s52, v13
    s_cmp_ge_u32 s52, 5
    s_cbranch_scc1 L_lwok205
    s_sub_u32 s57, s57, 1
    s_cbranch_scc1 L_lwok205
    s_sleep 4
    s_branch L_lw205
L_lwok205:
    s_mov_b32 s57, 524288
L_lw206:
    ds_read_b32 v13, v2 offset:56
    s_waitcnt lgkmcnt(0)
    v_readfirstlane_b32 s52, v13
    s_cmp_ge_u32 s52, 4
    s_cbranch_scc1 L_lwok206
    s_sub_u32 s57, s57, 1
    s_cbranch_scc1 L_lwok206
    s_sleep 4
    s_branch L_lw206
L_lwok206:
    s_mov_b32 exec_hi, 0xffff
    ds_read_b128 v[96:99], v12 offset:36096
    ds_read_b128 v[100:103], v12 offset:36864
    ds_read_b128 v[104:107], v12 offset:37632
    ds_read_b128 v[108:111], v12 offset:38400
    s_waitcnt lgkmcnt(3)
    v_mul_f32 v114, s90, v98
    v_mul_f32 v115, s90, v99
    v_mul_f32 v112, s90, v96
    v_mul_f32 v113, s90, v97
    s_waitcnt lgkmcnt(2)
    v_fmac_f32 v114, s91, v102
    v_fmac_f32 v115, s91, v103
    v_fmac_f32 v112, s91, v100
    v_fmac_f32 v113, s91, v101
    s_waitcnt lgkmcnt(1)
    v_fmac_f32 v114, s92, v106
    v_fmac_f32 v115, s92, v107
    v_fmac_f32 v112, s92, v104
    v_fmac_f32 v113, s92, v105
    s_waitcnt lgkmcnt(0)
    v_fmac_f32 v114, s93, v110
    v_fmac_f32 v115, s93, v111
    v_fmac_f32 v112, s93, v108
    v_fmac_f32 v113, s93, v109
    v_and_or_b32 v115, v115, -4, 2
    buffer_store_dwordx4 v[112:115], v15, s[40:43], s54 offen sc1
    s_mov_b32 exec_hi, -1
    s_add_u32 s54, s54, 24576
    v_readlane_b32 s90, v22, 28
    v_readlane_b32 s91, v22, 29
    v_readlane_b32 s92, v22, 30
    v_readlane_b32 s93, v22, 31
    s_mov_b32 s57, 524288
L_lw207:
    ds_read_b32 v13, v2 offset:68
    s_waitcnt lgkmcnt(0)
    v_readfirstlane_b32 s52, v13
    s_cmp_ge_u32 s52, 6
    s_cbranch_scc1 L_lwok207
    s_sub_u32 s57, s57, 1
    s_cbranch_scc1 L_lwok207
    s_sleep 4
    s_branch L_lw207
L_lwok207:
    ds_read_b32 v40, v24 offset:3072
    ds_read_b32 v41, v24 offset:3088
    ds_read_b32 v42, v24 offset:3104
    ds_read_b32 v43, v24 offset:3120
    ds_read_b32 v44, v24 offset:3136
    ds_read_b32 v45, v24 offset:3152
    ds_read_b32 v46, v24 offset:3168
    ds_read_b32 v47, v24 offset:3184
    s_mov_b32 s57, 524288
L_lw209:
    ds_read_b32 v13, v2 offset:60
    s_waitcnt lgkmcnt(0)
    v_readfirstlane_b32 s52, v13
    s_cmp_ge_u32 s52, 1
    s_cbranch_scc1 L_lwok209
    s_sub_u32 s57, s57, 1
    s_cbranch_scc1 L_lwok209
    s_sleep 1
    s_branch L_lw209
L_lwok209:
    s_mov_b32 exec_hi, 0xffff
    s_mov_b32 s57, 524288
L_sp208:
    ds_read_b32 v13, v2 offset:60
    ds_read_b128 v[96:99], v12 offset:39168
    ds_read_b128 v[100:103], v12 offset:39936
    ds_read_b128 v[104:107], v12 offset:40704
    ds_read_b128 v[108:111], v12 offset:41472
    s_sub_u32 s57, s57, 1
    s_cbranch_scc1 L_spo208
    s_waitcnt lgkmcnt(4)
    v_readfirstlane_b32 s52, v13
    s_cmp_ge_u32 s52, 4
    s_cbranch_scc0 L_sp208
L_spo208:
    s_waitcnt lgkmcnt(3)
    v_mul_f32 v118, s90, v98
    v_mul_f32 v119, s90, v99
    v_mul_f32 v116, s90, v96
    v_mul_f32 v117, s90, v97
    s_waitcnt lgkmcnt(2)
    v_fmac_f32 v118, s91, v102
    v_fmac_f32 v119, s91, v103
    v_fmac_f32 v116, s91, v100
    v_fmac_f32 v117, s91, v101
    s_waitcnt lgkmcnt(1)
    v_fmac_f32 v118, s92, v106
    v_fmac_f32 v119, s92, v107
    v_fmac_f32 v116, s92, v104
    v_fmac_f32 v117, s92, v105
    s_waitcnt lgkmcnt(0)
    v_fmac_f32 v118, s93, v110
    v_fmac_f32 v119, s93, v111
    v_fmac_f32 v116, s93, v108
    v_fmac_f32 v117, s93, v109
    v_and_or_b32 v119, v119, -4, 2
    buffer_store_dwordx4 v[116:119], v15, s[40:43], s54 offen sc1
    s_mov_b32 exec_hi, -1
    s_mov_b32 s57, 65536
L_gb210:
    buffer_load_dwordx4 v[128:131], v12, s[40:43], s64 offen offset:0 sc1
    buffer_load_dwordx4 v[132:135], v12, s[40:43], s64 offen offset:1024 sc1
    buffer_load_dwordx4 v[136:139], v12, s[40:43], s64 offen offset:2048 sc1
    buffer_load_dwordx4 v[140:143], v12, s[40:43], s64 offen offset:3072 sc1
    buffer_load_dwordx4 v[144:147], v12, s[40:43], s65 offen offset:0 sc1
    buffer_load_dwordx4 v[148:151], v12, s[40:43], s65 offen offset:1024 sc1
    buffer_load_dwordx4 v[152:155], v12, s[40:43], s65 offen offset:2048 sc1
    buffer_load_dwordx4 v[156:159], v12, s[40:43], s65 offen offset:3072 sc1
    s_waitcnt vmcnt(4)
    v_bitop3_b32 v13, v131, v135, 2 bitop3:0x80
    v_bitop3_b32 v13, v139, v143, v13 bitop3:0x80
    v_cmp_eq_u32 vcc, 0, v13
    v_pk_mul_f32 v[32:33], v[40:41], v[128:129] op_sel_hi:[0,1]
    v_pk_mul_f32 v[34:35], v[40:41], v[130:131] op_sel_hi:[0,1]
    v_pk_fma_f32 v[32:33], v[40:41], v[132:133], v[32:33] op_sel:[1,0,0] op_sel_hi:[1,1,1]
    v_pk_fma_f32 v[34:35], v[40:41], v[134:135], v[34:35] op_sel:[1,0,0] op_sel_hi:[1,1,1]
    v_pk_fma_f32 v[32:33], v[42:43], v[136:137], v[32:33] op_sel_hi:[0,1,1]
    v_pk_fma_f32 v[34:35], v[42:43], v[138:139], v[34:35] op_sel_hi:[0,1,1]
    v_pk_fma_f32 v[32:33], v[42:43], v[140:141], v[32:33] op_sel:[1,0,0] op_sel_hi:[1,1,1]
    v_pk_fma_f32 v[34:35], v[42:43], v[142:143], v[34:35] op_sel:[1,0,0] op_sel_hi:[1,1,1]
    s_cbranch_vccz L_g1w210
    s_waitcnt vmcnt(0)
    v_bitop3_b32 v13, v147, v151, 2 bitop3:0x80
    v_bitop3_b32 v13, v155, v159, v13 bitop3:0x80
    v_cmp_eq_u32 vcc, 0, v13
    v_pk_mul_f32 v[36:37], v[44:45], v[144:145] op_sel_hi:[0,1]
    v_pk_mul_f32 v[38:39], v[44:45], v[146:147] op_sel_hi:[0,1]
    v_pk_fma_f32 v[36:37], v[44:45], v[148:149], v[36:37] op_sel:[1,0,0] op_sel_hi:[1,1,1]
    v_pk_fma_f32 v[38:39], v[44:45], v[150:151], v[38:39] op_sel:[1,0,0] op_sel_hi:[1,1,1]
    v_pk_fma_f32 v[36:37], v[46:47], v[152:153], v[36:37] op_sel_hi:[0,1,1]
    v_pk_fma_f32 v[38:39], v[46:47], v[154:155], v[38:39] op_sel_hi:[0,1,1]
    v_pk_fma_f32 v[36:37], v[46:47], v[156:157], v[36:37] op_sel:[1,0,0] op_sel_hi:[1,1,1]
    v_pk_fma_f32 v[38:39], v[46:47], v[158:159], v[38:39] op_sel:[1,0,0] op_sel_hi:[1,1,1]
    s_cbranch_vccz L_g0210
    s_sub_u32 s57, s57, 1
    s_cbranch_scc0 L_gb210
    s_branch L_gd210
L_g0210:
    buffer_load_dwordx4 v[128:131], v12, s[40:43], s64 offen offset:0 sc1
    buffer_load_dwordx4 v[132:135], v12, s[40:43], s64 offen offset:1024 sc1
    buffer_load_dwordx4 v[136:139], v12, s[40:43], s64 offen offset:2048 sc1
    buffer_load_dwordx4 v[140:143], v12, s[40:43], s64 offen offset:3072 sc1
    s_waitcnt vmcnt(0)
    v_bitop3_b32 v13, v131, v135, 2 bitop3:0x80
    v_bitop3_b32 v13, v139, v143, v13 bitop3:0x80
    v_cmp_eq_u32 vcc, 0, v13
    v_pk_mul_f32 v[32:33], v[40:41], v[128:129] op_sel_hi:[0,1]
    v_pk_mul_f32 v[34:35], v[40:41], v[130:131] op_sel_hi:[0,1]
    v_pk_fma_f32 v[32:33], v[40:41], v[132:133], v[32:33] op_sel:[1,0,0] op_sel_hi:[1,1,1]
    v_pk_fma_f32 v[34:35], v[40:41], v[134:135], v[34:35] op_sel:[1,0,0] op_sel_hi:[1,1,1]
    v_pk_fma_f32 v[32:33], v[42:43], v[136:137], v[32:33] op_sel_hi:[0,1,1]
    v_pk_fma_f32 v[34:35], v[42:43], v[138:139], v[34:35] op_sel_hi:[0,1,1]
    v_pk_fma_f32 v[32:33], v[42:43], v[140:141], v[32:33] op_sel:[1,0,0] op_sel_hi:[1,1,1]
    v_pk_fma_f32 v[34:35], v[42:43], v[142:143], v[34:35] op_sel:[1,0,0] op_sel_hi:[1,1,1]
    s_cbranch_vccz L_gd210
    s_sub_u32 s57, s57, 1
    s_cbranch_scc0 L_g0210
    s_branch L_gd210
L_g1210:
    buffer_load_dwordx4 v[144:147], v12, s[40:43], s65 offen offset:0 sc1
    buffer_load_dwordx4 v[148:151], v12, s[40:43], s65 offen offset:1024 sc1
    buffer_load_dwordx4 v[152:155], v12, s[40:43], s65 offen offset:2048 sc1
    buffer_load_dwordx4 v[156:159], v12, s[40:43], s65 offen offset:3072 sc1
L_g1w210:
    s_waitcnt vmcnt(0)
    v_bitop3_b32 v13, v147, v151, 2 bitop3:0x80
    v_bitop3_b32 v13, v155, v159, v13 bitop3:0x80
    v_cmp_eq_u32 vcc, 0, v13
    v_pk_mul_f32 v[36:37], v[44:45], v[144:145] op_sel_hi:[0,1]
    v_pk_mul_f32 v[38:39], v[44:45], v[146:147] op_sel_hi:[0,1]
    v_pk_fma_f32 v[36:37], v[44:45], v[148:149], v[36:37] op_sel:[1,0,0] op_sel_hi:[1,1,1]
    v_pk_fma_f32 v[38:39], v[44:45], v[150:151], v[38:39] op_sel:[1,0,0] op_sel_hi:[1,1,1]
    v_pk_fma_f32 v[36:37], v[46:47], v[152:153], v[36:37] op_sel_hi:[0,1,1]
    v_pk_fma_f32 v[38:39], v[46:47], v[154:155], v[38:39] op_sel_hi:[0,1,1]
    v_pk_fma_f32 v[36:37], v[46:47], v[156:157], v[36:37] op_sel:[1,0,0] op_sel_hi:[1,1,1]
    v_pk_fma_f32 v[38:39], v[46:47], v[158:159], v[38:39] op_sel:[1,0,0] op_sel_hi:[1,1,1]
    s_cbranch_vccz L_gd210
    s_sub_u32 s57, s57, 1
    s_cbranch_scc0 L_g1210
L_gd210:
    v_pk_add_f32 v[32:33], v[32:33], v[36:37]
    v_pk_add_f32 v[34:35], v[34:35], v[38:39]
    s_nop 1
    v_permlane32_swap_b32 v32, v34
    v_permlane32_swap_b32 v33, v35
    v_add_f32 v32, v32, v34
    v_add_f32 v33, v33, v35
    s_nop 1
    v_permlane16_swap_b32 v32, v33
    v_add_f32 v32, v32, v33
    v_cvt_pk_bf16_f32 v32, v32, v32
    ds_write_b16 v25, v32 offset:1984
    s_waitcnt lgkmcnt(0)
L_bme178:
    s_barrier
    s_endpgm
L_a2:
    s_mov_b32 s57, 524288
L_lw211:
    ds_read_b32 v13, v2 offset:12
    s_waitcnt lgkmcnt(0)
    v_readfirstlane_b32 s67, v13
    s_cmp_ge_u32 s67, 1024
    s_cbranch_scc1 L_lwok211
    s_sub_u32 s57, s57, 1
    s_cbranch_scc1 L_lwok211
    s_sleep 8
    s_branch L_lw211
L_lwok211:
    s_and_b32 s67, s67, 0xff
    s_mov_b32 s57, 524288
L_lw212:
    ds_read_b32 v13, v2 offset:20
    s_waitcnt lgkmcnt(0)
    v_readfirstlane_b32 s52, v13
    s_cmp_ge_u32 s52, 4
    s_cbranch_scc1 L_lwok212
    s_sub_u32 s57, s57, 1
    s_cbranch_scc1 L_lwok212
    s_sleep 8
    s_branch L_lw212
L_lwok212:
    s_lshl_b32 s55, s30, 12
    s_add_u32 s55, s55, 131072
    s_cmp_eq_u32 s67, 0
    s_cbranch_scc0 L_bm213
    s_mov_b32 s57, 65536
L_poll214:
    buffer_load_dwordx4 v[96:99], v12, s[40:43], s55 offen offset:0 nt
    buffer_load_dwordx4 v[100:103], v12, s[40:43], s55 offen offset:1024 nt
    buffer_load_dwordx4 v[104:107], v12, s[40:43], s55 offen offset:2048 nt
    buffer_load_dwordx4 v[108:111], v12, s[40:43], s55 offen offset:3072 nt
    s_waitcnt vmcnt(0)
    v_xor_b32 v13, s50, v98
    v_bitop3_b32 v13, v99, s50, v13 bitop3:0xbe
    v_bitop3_b32 v13, v102, s50, v13 bitop3:0xbe
    v_bitop3_b32 v13, v103, s50, v13 bitop3:0xbe
    v_bitop3_b32 v13, v106, s50, v13 bitop3:0xbe
    v_bitop3_b32 v13, v107, s50, v13 bitop3:0xbe
    v_bitop3_b32 v13, v110, s50, v13 bitop3:0xbe
    v_bitop3_b32 v13, v111, s50, v13 bitop3:0xbe
    v_cmp_ne_u32 vcc, 0, v13
    s_nop 4
    s_cbranch_vccz L_pok214
    s_sub_u32 s57, s57, 1
    s_cbranch_scc1 L_pok214
    s_sleep 8
    s_branch L_poll214
L_pok214:
    s_branch L_bme213
L_bm213:
    s_mov_b32 s57, 65536
L_poll215:
    buffer_load_dwordx4 v[96:99], v12, s[40:43], s55 offen offset:0 sc1
    buffer_load_dwordx4 v[100:103], v12, s[40:43], s55 offen offset:1024 sc1
    buffer_load_dwordx4 v[104:107], v12, s[40:43], s55 offen offset:2048 sc1
    buffer_load_dwordx4 v[108:111], v12, s[40:43], s55 offen offset:3072 sc1
    s_waitcnt vmcnt(0)
    v_xor_b32 v13, s50, v98
    v_bitop3_b32 v13, v99, s50, v13 bitop3:0xbe
    v_bitop3_b32 v13, v102, s50, v13 bitop3:0xbe
    v_bitop3_b32 v13, v103, s50, v13 bitop3:0xbe
    v_bitop3_b32 v13, v106, s50, v13 bitop3:0xbe
    v_bitop3_b32 v13, v107, s50, v13 bitop3:0xbe
    v_bitop3_b32 v13, v110, s50, v13 bitop3:0xbe
    v_bitop3_b32 v13, v111, s50, v13 bitop3:0xbe
    v_cmp_ne_u32 vcc, 0, v13
    s_nop 4
    s_cbranch_vccz L_pok215
    s_sub_u32 s57, s57, 1
    s_cbranch_scc1 L_pok215
    s_sleep 8
    s_branch L_poll215
L_pok215:
L_bme213:
    v_lshlrev_b32 v9, 2, v0
    v_mov_b32 v36, v96
    s_nop 1
    v_max_f32_dpp v36, v36, v36 row_ror:1 row_mask:0xf bank_mask:0xf
    s_nop 1
    v_max_f32_dpp v36, v36, v36 row_ror:2 row_mask:0xf bank_mask:0xf
    s_nop 1
    v_max_f32_dpp v36, v36, v36 row_ror:4 row_mask:0xf bank_mask:0xf
    s_nop 1
    v_max_f32_dpp v36, v36, v36 row_ror:8 row_mask:0xf bank_mask:0xf
    v_mov_b32 v37, v36
    s_nop 1
    v_permlane16_swap_b32 v37, v36
    s_nop 1
    v_max_f32 v36, v36, v37
    v_sub_f32 v96, v96, v36
    v_exp_f32 v96, v96
    s_nop 0
    v_mul_f32 v97, v97, v96
    s_nop 1
    v_add_f32_dpp v97, v97, v97 row_ror:1 row_mask:0xf bank_mask:0xf
    s_nop 1
    v_add_f32_dpp v97, v97, v97 row_ror:2 row_mask:0xf bank_mask:0xf
    s_nop 1
    v_add_f32_dpp v97, v97, v97 row_ror:4 row_mask:0xf bank_mask:0xf
    s_nop 1
    v_add_f32_dpp v97, v97, v97 row_ror:8 row_mask:0xf bank_mask:0xf
    v_mov_b32 v37, v97
    s_nop 1
    v_permlane16_swap_b32 v37, v97
    s_nop 1
    v_add_f32 v97, v97, v37
    v_rcp_f32 v97, v97
    s_nop 0
    v_mul_f32 v96, v96, v97
    ds_write_b32 v9, v96 offset:2176
    v_mov_b32 v36, v100
    s_nop 1
    v_max_f32_dpp v36, v36, v36 row_ror:1 row_mask:0xf bank_mask:0xf
    s_nop 1
    v_max_f32_dpp v36, v36, v36 row_ror:2 row_mask:0xf bank_mask:0xf
    s_nop 1
    v_max_f32_dpp v36, v36, v36 row_ror:4 row_mask:0xf bank_mask:0xf
    s_nop 1
    v_max_f32_dpp v36, v36, v36 row_ror:8 row_mask:0xf bank_mask:0xf
    v_mov_b32 v37, v36
    s_nop 1
    v_permlane16_swap_b32 v37, v36
    s_nop 1
    v_max_f32 v36, v36, v37
    v_sub_f32 v100, v100, v36
    v_exp_f32 v100, v100
    s_nop 0
    v_mul_f32 v101, v101, v100
    s_nop 1
    v_add_f32_dpp v101, v101, v101 row_ror:1 row_mask:0xf bank_mask:0xf
    s_nop 1
    v_add_f32_dpp v101, v101, v101 row_ror:2 row_mask:0xf bank_mask:0xf
    s_nop 1
    v_add_f32_dpp v101, v101, v101 row_ror:4 row_mask:0xf bank_mask:0xf
    s_nop 1
    v_add_f32_dpp v101, v101, v101 row_ror:8 row_mask:0xf bank_mask:0xf
    v_mov_b32 v37, v101
    s_nop 1
    v_permlane16_swap_b32 v37, v101
    s_nop 1
    v_add_f32 v101, v101, v37
    v_rcp_f32 v101, v101
    s_nop 0
    v_mul_f32 v100, v100, v101
    ds_write_b32 v9, v100 offset:2432
    v_mov_b32 v36, v104
    s_nop 1
    v_max_f32_dpp v36, v36, v36 row_ror:1 row_mask:0xf bank_mask:0xf
    s_nop 1
    v_max_f32_dpp v36, v36, v36 row_ror:2 row_mask:0xf bank_mask:0xf
    s_nop 1
    v_max_f32_dpp v36, v36, v36 row_ror:4 row_mask:0xf bank_mask:0xf
    s_nop 1
    v_max_f32_dpp v36, v36, v36 row_ror:8 row_mask:0xf bank_mask:0xf
    v_mov_b32 v37, v36
    s_nop 1
    v_permlane16_swap_b32 v37, v36
    s_nop 1
    v_max_f32 v36, v36, v37
    v_sub_f32 v104, v104, v36
    v_exp_f32 v104, v104
    s_nop 0
    v_mul_f32 v105, v105, v104
    s_nop 1
    v_add_f32_dpp v105, v105, v105 row_ror:1 row_mask:0xf bank_mask:0xf
    s_nop 1
    v_add_f32_dpp v105, v105, v105 row_ror:2 row_mask:0xf bank_mask:0xf
    s_nop 1
    v_add_f32_dpp v105, v105, v105 row_ror:4 row_mask:0xf bank_mask:0xf
    s_nop 1
    v_add_f32_dpp v105, v105, v105 row_ror:8 row_mask:0xf bank_mask:0xf
    v_mov_b32 v37, v105
    s_nop 1
    v_permlane16_swap_b32 v37, v105
    s_nop 1
    v_add_f32 v105, v105, v37
    v_rcp_f32 v105, v105
    s_nop 0
    v_mul_f32 v104, v104, v105
    ds_write_b32 v9, v104 offset:2688
    v_mov_b32 v36, v108
    s_nop 1
    v_max_f32_dpp v36, v36, v36 row_ror:1 row_mask:0xf bank_mask:0xf
    s_nop 1
    v_max_f32_dpp v36, v36, v36 row_ror:2 row_mask:0xf bank_mask:0xf
    s_nop 1
    v_max_f32_dpp v36, v36, v36 row_ror:4 row_mask:0xf bank_mask:0xf
    s_nop 1
    v_max_f32_dpp v36, v36, v36 row_ror:8 row_mask:0xf bank_mask:0xf
    v_mov_b32 v37, v36
    s_nop 1
    v_permlane16_swap_b32 v37, v36
    s_nop 1
    v_max_f32 v36, v36, v37
    v_sub_f32 v108, v108, v36
    v_exp_f32 v108, v108
    s_nop 0
    v_mul_f32 v109, v109, v108
    s_nop 1
    v_add_f32_dpp v109, v109, v109 row_ror:1 row_mask:0xf bank_mask:0xf
    s_nop 1
    v_add_f32_dpp v109, v109, v109 row_ror:2 row_mask:0xf bank_mask:0xf
    s_nop 1
    v_add_f32_dpp v109, v109, v109 row_ror:4 row_mask:0xf bank_mask:0xf
    s_nop 1
    v_add_f32_dpp v109, v109, v109 row_ror:8 row_mask:0xf bank_mask:0xf
    v_mov_b32 v37, v109
    s_nop 1
    v_permlane16_swap_b32 v37, v109
    s_nop 1
    v_add_f32 v109, v109, v37
    v_rcp_f32 v109, v109
    s_nop 0
    v_mul_f32 v108, v108, v109
    ds_write_b32 v9, v108 offset:2944
    ds_write_b32 v2, v3 offset:24
    v_lshrrev_b32 v8, 4, v0
    v_lshlrev_b32 v24, 2, v8
    s_mul_i32 s54, s30, 12
    s_add_u32 s54, s54, s48
    s_lshl_b32 s54, s54, 13
    s_add_u32 s54, s54, 1048576
    s_add_u32 s55, s54, 4096
    v_and_b32 v9, 8, v0
    v_lshl_add_u32 v8, v9, 2, v8
    v_and_b32 v9, 3, v0
    v_lshl_add_u32 v8, v9, 3, v8
    v_and_b32 v9, 4, v0
    v_add_lshl_u32 v25, v8, v9, 1
    v_mov_b32 v26, 0xffffff00
    s_cmp_eq_u32 s67, 0
    s_cbranch_scc0 L_bm216
    ds_read_b32 v40, v24 offset:2176
    ds_read_b32 v41, v24 offset:2192
    ds_read_b32 v42, v24 offset:2208
    ds_read_b32 v43, v24 offset:2224
    ds_read_b32 v44, v24 offset:2240
    ds_read_b32 v45, v24 offset:2256
    ds_read_b32 v46, v24 offset:2272
    ds_read_b32 v47, v24 offset:2288
    s_mov_b32 s57, 524288
L_lw218:
    ds_read_b32 v13, v2 offset:32
    s_waitcnt lgkmcnt(0)
    v_readfirstlane_b32 s52, v13
    s_cmp_ge_u32 s52, 4
    s_cbranch_scc1 L_lwok218
    s_sub_u32 s57, s57, 1
    s_cbranch_scc1 L_lwok218
    s_sleep 2
    s_branch L_lw218
L_lwok218:
    s_mov_b32 s57, 65536
L_og217:
    buffer_load_dwordx4 v[96:99], v12, s[40:43], s54 offen offset:0 nt
    buffer_load_dwordx4 v[100:103], v12, s[40:43], s54 offen offset:1024 nt
    buffer_load_dwordx4 v[104:107], v12, s[40:43], s54 offen offset:2048 nt
    buffer_load_dwordx4 v[108:111], v12, s[40:43], s54 offen offset:3072 nt
    buffer_load_dwordx4 v[112:115], v12, s[40:43], s55 offen offset:0 nt
    buffer_load_dwordx4 v[116:119], v12, s[40:43], s55 offen offset:1024 nt
    buffer_load_dwordx4 v[120:123], v12, s[40:43], s55 offen offset:2048 nt
    buffer_load_dwordx4 v[124:127], v12, s[40:43], s55 offen offset:3072 nt
    s_waitcnt vmcnt(0)
    v_bitop3_b32 v13, v99, v103, 1 bitop3:0x80
    v_bitop3_b32 v13, v107, v111, v13 bitop3:0x80
    v_bitop3_b32 v13, v115, v119, v13 bitop3:0x80
    v_bitop3_b32 v13, v123, v127, v13 bitop3:0x80
    v_cmp_eq_u32 vcc, 0, v13
    v_mul_f32 v32, v40, v96
    v_mul_f32 v36, v44, v112
    v_mul_f32 v33, v40, v97
    v_mul_f32 v37, v44, v113
    s_nop 0
    s_cbranch_vccz L_og217_ok0
    s_sleep 8
    s_sub_u32 s57, s57, 1
    s_cbranch_scc0 L_og217
L_og217_ok0:
    v_pk_mul_f32 v[34:35], v[40:41], v[98:99] op_sel_hi:[0,1]
    v_pk_mul_f32 v[38:39], v[44:45], v[114:115] op_sel_hi:[0,1]
    v_pk_fma_f32 v[32:33], v[40:41], v[100:101], v[32:33] op_sel:[1,0,0] op_sel_hi:[1,1,1]
    v_pk_fma_f32 v[34:35], v[40:41], v[102:103], v[34:35] op_sel:[1,0,0] op_sel_hi:[1,1,1]
    v_pk_fma_f32 v[36:37], v[44:45], v[116:117], v[36:37] op_sel:[1,0,0] op_sel_hi:[1,1,1]
    v_pk_fma_f32 v[38:39], v[44:45], v[118:119], v[38:39] op_sel:[1,0,0] op_sel_hi:[1,1,1]
    v_pk_fma_f32 v[32:33], v[42:43], v[104:105], v[32:33] op_sel_hi:[0,1,1]
    v_pk_fma_f32 v[34:35], v[42:43], v[106:107], v[34:35] op_sel_hi:[0,1,1]
    v_pk_fma_f32 v[36:37], v[46:47], v[120:121], v[36:37] op_sel_hi:[0,1,1]
    v_pk_fma_f32 v[38:39], v[46:47], v[122:123], v[38:39] op_sel_hi:[0,1,1]
    v_pk_fma_f32 v[32:33], v[42:43], v[108:109], v[32:33] op_sel:[1,0,0] op_sel_hi:[1,1,1]
    v_pk_fma_f32 v[34:35], v[42:43], v[110:111], v[34:35] op_sel:[1,0,0] op_sel_hi:[1,1,1]
    v_pk_fma_f32 v[36:37], v[46:47], v[124:125], v[36:37] op_sel:[1,0,0] op_sel_hi:[1,1,1]
    v_pk_fma_f32 v[38:39], v[46:47], v[126:127], v[38:39] op_sel:[1,0,0] op_sel_hi:[1,1,1]
    v_pk_add_f32 v[32:33], v[32:33], v[36:37]
    v_pk_add_f32 v[34:35], v[34:35], v[38:39]
    s_nop 1
    v_permlane32_swap_b32 v32, v34
    v_permlane32_swap_b32 v33, v35
    v_add_f32 v32, v32, v34
    v_add_f32 v33, v33, v35
    s_nop 1
    v_permlane16_swap_b32 v32, v33
    v_add_f32 v32, v32, v33
    v_cvt_pk_bf16_f32 v32, v32, v32
    ds_write_b16 v25, v32 offset:1024
    s_mov_b64 exec, 1
    ds_add_u32 v2, v3 offset:68
    s_mov_b64 exec, -1
    s_add_u32 s54, s54, 24576
    s_add_u32 s55, s55, 24576
    ds_read_b32 v40, v24 offset:2304
    ds_read_b32 v41, v24 offset:2320
    ds_read_b32 v42, v24 offset:2336
    ds_read_b32 v43, v24 offset:2352
    ds_read_b32 v44, v24 offset:2368
    ds_read_b32 v45, v24 offset:2384
    ds_read_b32 v46, v24 offset:2400
    ds_read_b32 v47, v24 offset:2416
    s_mov_b32 s57, 524288
L_lw220:
    ds_read_b32 v13, v2 offset:36
    s_waitcnt lgkmcnt(0)
    v_readfirstlane_b32 s52, v13
    s_cmp_ge_u32 s52, 4
    s_cbranch_scc1 L_lwok220
    s_sub_u32 s57, s57, 1
    s_cbranch_scc1 L_lwok220
    s_sleep 2
    s_branch L_lw220
L_lwok220:
    s_mov_b32 s57, 65536
L_og219:
    buffer_load_dwordx4 v[96:99], v12, s[40:43], s54 offen offset:0 nt
    buffer_load_dwordx4 v[100:103], v12, s[40:43], s54 offen offset:1024 nt
    buffer_load_dwordx4 v[104:107], v12, s[40:43], s54 offen offset:2048 nt
    buffer_load_dwordx4 v[108:111], v12, s[40:43], s54 offen offset:3072 nt
    buffer_load_dwordx4 v[112:115], v12, s[40:43], s55 offen offset:0 nt
    buffer_load_dwordx4 v[116:119], v12, s[40:43], s55 offen offset:1024 nt
    buffer_load_dwordx4 v[120:123], v12, s[40:43], s55 offen offset:2048 nt
    buffer_load_dwordx4 v[124:127], v12, s[40:43], s55 offen offset:3072 nt
    s_waitcnt vmcnt(0)
    v_bitop3_b32 v13, v99, v103, 1 bitop3:0x80
    v_bitop3_b32 v13, v107, v111, v13 bitop3:0x80
    v_bitop3_b32 v13, v115, v119, v13 bitop3:0x80
    v_bitop3_b32 v13, v123, v127, v13 bitop3:0x80
    v_cmp_eq_u32 vcc, 0, v13
    v_mul_f32 v32, v40, v96
    v_mul_f32 v36, v44, v112
    v_mul_f32 v33, v40, v97
    v_mul_f32 v37, v44, v113
    s_nop 0
    s_cbranch_vccz L_og219_ok0
    s_sleep 8
    s_sub_u32 s57, s57, 1
    s_cbranch_scc0 L_og219
L_og219_ok0:
    v_pk_mul_f32 v[34:35], v[40:41], v[98:99] op_sel_hi:[0,1]
    v_pk_mul_f32 v[38:39], v[44:45], v[114:115] op_sel_hi:[0,1]
    v_pk_fma_f32 v[32:33], v[40:41], v[100:101], v[32:33] op_sel:[1,0,0] op_sel_hi:[1,1,1]
    v_pk_fma_f32 v[34:35], v[40:41], v[102:103], v[34:35] op_sel:[1,0,0] op_sel_hi:[1,1,1]
    v_pk_fma_f32 v[36:37], v[44:45], v[116:117], v[36:37] op_sel:[1,0,0] op_sel_hi:[1,1,1]
    v_pk_fma_f32 v[38:39], v[44:45], v[118:119], v[38:39] op_sel:[1,0,0] op_sel_hi:[1,1,1]
    v_pk_fma_f32 v[32:33], v[42:43], v[104:105], v[32:33] op_sel_hi:[0,1,1]
    v_pk_fma_f32 v[34:35], v[42:43], v[106:107], v[34:35] op_sel_hi:[0,1,1]
    v_pk_fma_f32 v[36:37], v[46:47], v[120:121], v[36:37] op_sel_hi:[0,1,1]
    v_pk_fma_f32 v[38:39], v[46:47], v[122:123], v[38:39] op_sel_hi:[0,1,1]
    v_pk_fma_f32 v[32:33], v[42:43], v[108:109], v[32:33] op_sel:[1,0,0] op_sel_hi:[1,1,1]
    v_pk_fma_f32 v[34:35], v[42:43], v[110:111], v[34:35] op_sel:[1,0,0] op_sel_hi:[1,1,1]
    v_pk_fma_f32 v[36:37], v[46:47], v[124:125], v[36:37] op_sel:[1,0,0] op_sel_hi:[1,1,1]
    v_pk_fma_f32 v[38:39], v[46:47], v[126:127], v[38:39] op_sel:[1,0,0] op_sel_hi:[1,1,1]
    v_pk_add_f32 v[32:33], v[32:33], v[36:37]
    v_pk_add_f32 v[34:35], v[34:35], v[38:39]
    s_nop 1
    v_permlane32_swap_b32 v32, v34
    v_permlane32_swap_b32 v33, v35
    v_add_f32 v32, v32, v34
    v_add_f32 v33, v33, v35
    s_nop 1
    v_permlane16_swap_b32 v32, v33
    v_add_f32 v32, v32, v33
    v_cvt_pk_bf16_f32 v32, v32, v32
    ds_write_b16 v25, v32 offset:1152
    s_mov_b64 exec, 1
    ds_add_u32 v2, v3 offset:68
    s_mov_b64 exec, -1
    s_add_u32 s54, s54, 24576
    s_add_u32 s55, s55, 24576
    ds_read_b32 v40, v24 offset:2432
    ds_read_b32 v41, v24 offset:2448
    ds_read_b32 v42, v24 offset:2464
    ds_read_b32 v43, v24 offset:2480
    ds_read_b32 v44, v24 offset:2496
    ds_read_b32 v45, v24 offset:2512
    ds_read_b32 v46, v24 offset:2528
    ds_read_b32 v47, v24 offset:2544
    s_mov_b32 s57, 524288
L_lw222:
    ds_read_b32 v13, v2 offset:40
    s_waitcnt lgkmcnt(0)
    v_readfirstlane_b32 s52, v13
    s_cmp_ge_u32 s52, 4
    s_cbranch_scc1 L_lwok222
    s_sub_u32 s57, s57, 1
    s_cbranch_scc1 L_lwok222
    s_sleep 2
    s_branch L_lw222
L_lwok222:
    s_mov_b32 s57, 65536
L_og221:
    buffer_load_dwordx4 v[96:99], v12, s[40:43], s54 offen offset:0 nt
    buffer_load_dwordx4 v[100:103], v12, s[40:43], s54 offen offset:1024 nt
    buffer_load_dwordx4 v[104:107], v12, s[40:43], s54 offen offset:2048 nt
    buffer_load_dwordx4 v[108:111], v12, s[40:43], s54 offen offset:3072 nt
    buffer_load_dwordx4 v[112:115], v12, s[40:43], s55 offen offset:0 nt
    buffer_load_dwordx4 v[116:119], v12, s[40:43], s55 offen offset:1024 nt
    buffer_load_dwordx4 v[120:123], v12, s[40:43], s55 offen offset:2048 nt
    buffer_load_dwordx4 v[124:127], v12, s[40:43], s55 offen offset:3072 nt
    s_waitcnt vmcnt(0)
    v_bitop3_b32 v13, v99, v103, 1 bitop3:0x80
    v_bitop3_b32 v13, v107, v111, v13 bitop3:0x80
    v_bitop3_b32 v13, v115, v119, v13 bitop3:0x80
    v_bitop3_b32 v13, v123, v127, v13 bitop3:0x80
    v_cmp_eq_u32 vcc, 0, v13
    v_mul_f32 v32, v40, v96
    v_mul_f32 v36, v44, v112
    v_mul_f32 v33, v40, v97
    v_mul_f32 v37, v44, v113
    s_nop 0
    s_cbranch_vccz L_og221_ok0
    s_sleep 8
    s_sub_u32 s57, s57, 1
    s_cbranch_scc0 L_og221
L_og221_ok0:
    v_pk_mul_f32 v[34:35], v[40:41], v[98:99] op_sel_hi:[0,1]
    v_pk_mul_f32 v[38:39], v[44:45], v[114:115] op_sel_hi:[0,1]
    v_pk_fma_f32 v[32:33], v[40:41], v[100:101], v[32:33] op_sel:[1,0,0] op_sel_hi:[1,1,1]
    v_pk_fma_f32 v[34:35], v[40:41], v[102:103], v[34:35] op_sel:[1,0,0] op_sel_hi:[1,1,1]
    v_pk_fma_f32 v[36:37], v[44:45], v[116:117], v[36:37] op_sel:[1,0,0] op_sel_hi:[1,1,1]
    v_pk_fma_f32 v[38:39], v[44:45], v[118:119], v[38:39] op_sel:[1,0,0] op_sel_hi:[1,1,1]
    v_pk_fma_f32 v[32:33], v[42:43], v[104:105], v[32:33] op_sel_hi:[0,1,1]
    v_pk_fma_f32 v[34:35], v[42:43], v[106:107], v[34:35] op_sel_hi:[0,1,1]
    v_pk_fma_f32 v[36:37], v[46:47], v[120:121], v[36:37] op_sel_hi:[0,1,1]
    v_pk_fma_f32 v[38:39], v[46:47], v[122:123], v[38:39] op_sel_hi:[0,1,1]
    v_pk_fma_f32 v[32:33], v[42:43], v[108:109], v[32:33] op_sel:[1,0,0] op_sel_hi:[1,1,1]
    v_pk_fma_f32 v[34:35], v[42:43], v[110:111], v[34:35] op_sel:[1,0,0] op_sel_hi:[1,1,1]
    v_pk_fma_f32 v[36:37], v[46:47], v[124:125], v[36:37] op_sel:[1,0,0] op_sel_hi:[1,1,1]
    v_pk_fma_f32 v[38:39], v[46:47], v[126:127], v[38:39] op_sel:[1,0,0] op_sel_hi:[1,1,1]
    v_pk_add_f32 v[32:33], v[32:33], v[36:37]
    v_pk_add_f32 v[34:35], v[34:35], v[38:39]
    s_nop 1
    v_permlane32_swap_b32 v32, v34
    v_permlane32_swap_b32 v33, v35
    v_add_f32 v32, v32, v34
    v_add_f32 v33, v33, v35
    s_nop 1
    v_permlane16_swap_b32 v32, v33
    v_add_f32 v32, v32, v33
    v_cvt_pk_bf16_f32 v32, v32, v32
    ds_write_b16 v25, v32 offset:1280
    s_mov_b64 exec, 1
    ds_add_u32 v2, v3 offset:68
    s_mov_b64 exec, -1
    s_add_u32 s54, s54, 24576
    s_add_u32 s55, s55, 24576
    ds_read_b32 v40, v24 offset:2560
    ds_read_b32 v41, v24 offset:2576
    ds_read_b32 v42, v24 offset:2592
    ds_read_b32 v43, v24 offset:2608
    ds_read_b32 v44, v24 offset:2624
    ds_read_b32 v45, v24 offset:2640
    ds_read_b32 v46, v24 offset:2656
    ds_read_b32 v47, v24 offset:2672
    s_mov_b32 s57, 524288
L_lw224:
    ds_read_b32 v13, v2 offset:44
    s_waitcnt lgkmcnt(0)
    v_readfirstlane_b32 s52, v13
    s_cmp_ge_u32 s52, 4
    s_cbranch_scc1 L_lwok224
    s_sub_u32 s57, s57, 1
    s_cbranch_scc1 L_lwok224
    s_sleep 2
    s_branch L_lw224
L_lwok224:
    s_mov_b32 s57, 65536
L_og223:
    buffer_load_dwordx4 v[96:99], v12, s[40:43], s54 offen offset:0 nt
    buffer_load_dwordx4 v[100:103], v12, s[40:43], s54 offen offset:1024 nt
    buffer_load_dwordx4 v[104:107], v12, s[40:43], s54 offen offset:2048 nt
    buffer_load_dwordx4 v[108:111], v12, s[40:43], s54 offen offset:3072 nt
    buffer_load_dwordx4 v[112:115], v12, s[40:43], s55 offen offset:0 nt
    buffer_load_dwordx4 v[116:119], v12, s[40:43], s55 offen offset:1024 nt
    buffer_load_dwordx4 v[120:123], v12, s[40:43], s55 offen offset:2048 nt
    buffer_load_dwordx4 v[124:127], v12, s[40:43], s55 offen offset:3072 nt
    s_waitcnt vmcnt(0)
    v_bitop3_b32 v13, v99, v103, 1 bitop3:0x80
    v_bitop3_b32 v13, v107, v111, v13 bitop3:0x80
    v_bitop3_b32 v13, v115, v119, v13 bitop3:0x80
    v_bitop3_b32 v13, v123, v127, v13 bitop3:0x80
    v_cmp_eq_u32 vcc, 0, v13
    v_mul_f32 v32, v40, v96
    v_mul_f32 v36, v44, v112
    v_mul_f32 v33, v40, v97
    v_mul_f32 v37, v44, v113
    s_nop 0
    s_cbranch_vccz L_og223_ok0
    s_sleep 8
    s_sub_u32 s57, s57, 1
    s_cbranch_scc0 L_og223
L_og223_ok0:
    v_pk_mul_f32 v[34:35], v[40:41], v[98:99] op_sel_hi:[0,1]
    v_pk_mul_f32 v[38:39], v[44:45], v[114:115] op_sel_hi:[0,1]
    v_pk_fma_f32 v[32:33], v[40:41], v[100:101], v[32:33] op_sel:[1,0,0] op_sel_hi:[1,1,1]
    v_pk_fma_f32 v[34:35], v[40:41], v[102:103], v[34:35] op_sel:[1,0,0] op_sel_hi:[1,1,1]
    v_pk_fma_f32 v[36:37], v[44:45], v[116:117], v[36:37] op_sel:[1,0,0] op_sel_hi:[1,1,1]
    v_pk_fma_f32 v[38:39], v[44:45], v[118:119], v[38:39] op_sel:[1,0,0] op_sel_hi:[1,1,1]
    v_pk_fma_f32 v[32:33], v[42:43], v[104:105], v[32:33] op_sel_hi:[0,1,1]
    v_pk_fma_f32 v[34:35], v[42:43], v[106:107], v[34:35] op_sel_hi:[0,1,1]
    v_pk_fma_f32 v[36:37], v[46:47], v[120:121], v[36:37] op_sel_hi:[0,1,1]
    v_pk_fma_f32 v[38:39], v[46:47], v[122:123], v[38:39] op_sel_hi:[0,1,1]
    v_pk_fma_f32 v[32:33], v[42:43], v[108:109], v[32:33] op_sel:[1,0,0] op_sel_hi:[1,1,1]
    v_pk_fma_f32 v[34:35], v[42:43], v[110:111], v[34:35] op_sel:[1,0,0] op_sel_hi:[1,1,1]
    v_pk_fma_f32 v[36:37], v[46:47], v[124:125], v[36:37] op_sel:[1,0,0] op_sel_hi:[1,1,1]
    v_pk_fma_f32 v[38:39], v[46:47], v[126:127], v[38:39] op_sel:[1,0,0] op_sel_hi:[1,1,1]
    v_pk_add_f32 v[32:33], v[32:33], v[36:37]
    v_pk_add_f32 v[34:35], v[34:35], v[38:39]
    s_nop 1
    v_permlane32_swap_b32 v32, v34
    v_permlane32_swap_b32 v33, v35
    v_add_f32 v32, v32, v34
    v_add_f32 v33, v33, v35
    s_nop 1
    v_permlane16_swap_b32 v32, v33
    v_add_f32 v32, v32, v33
    v_cvt_pk_bf16_f32 v32, v32, v32
    ds_write_b16 v25, v32 offset:1408
    s_mov_b64 exec, 1
    ds_add_u32 v2, v3 offset:68
    s_mov_b64 exec, -1
    s_sub_u32 s54, s54, 73728
    s_sub_u32 s55, s55, 73728
    ds_read_b32 v40, v24 offset:2688
    ds_read_b32 v41, v24 offset:2704
    ds_read_b32 v42, v24 offset:2720
    ds_read_b32 v43, v24 offset:2736
    ds_read_b32 v44, v24 offset:2752
    ds_read_b32 v45, v24 offset:2768
    ds_read_b32 v46, v24 offset:2784
    ds_read_b32 v47, v24 offset:2800
    s_mov_b32 s57, 524288
L_lw226:
    ds_read_b32 v13, v2 offset:48
    s_waitcnt lgkmcnt(0)
    v_readfirstlane_b32 s52, v13
    s_cmp_ge_u32 s52, 4
    s_cbranch_scc1 L_lwok226
    s_sub_u32 s57, s57, 1
    s_cbranch_scc1 L_lwok226
    s_sleep 2
    s_branch L_lw226
L_lwok226:
    s_mov_b32 s57, 65536
L_og225:
    buffer_load_dwordx4 v[96:99], v12, s[40:43], s54 offen offset:0 nt
    buffer_load_dwordx4 v[100:103], v12, s[40:43], s54 offen offset:1024 nt
    buffer_load_dwordx4 v[104:107], v12, s[40:43], s54 offen offset:2048 nt
    buffer_load_dwordx4 v[108:111], v12, s[40:43], s54 offen offset:3072 nt
    buffer_load_dwordx4 v[112:115], v12, s[40:43], s55 offen offset:0 nt
    buffer_load_dwordx4 v[116:119], v12, s[40:43], s55 offen offset:1024 nt
    buffer_load_dwordx4 v[120:123], v12, s[40:43], s55 offen offset:2048 nt
    buffer_load_dwordx4 v[124:127], v12, s[40:43], s55 offen offset:3072 nt
    s_waitcnt vmcnt(0)
    v_bitop3_b32 v13, v99, v103, 2 bitop3:0x80
    v_bitop3_b32 v13, v107, v111, v13 bitop3:0x80
    v_bitop3_b32 v13, v115, v119, v13 bitop3:0x80
    v_bitop3_b32 v13, v123, v127, v13 bitop3:0x80
    v_cmp_eq_u32 vcc, 0, v13
    v_mul_f32 v32, v40, v96
    v_mul_f32 v36, v44, v112
    v_mul_f32 v33, v40, v97
    v_mul_f32 v37, v44, v113
    s_nop 0
    s_cbranch_vccz L_og225_ok0
    s_sleep 8
    s_sub_u32 s57, s57, 1
    s_cbranch_scc0 L_og225
L_og225_ok0:
    v_pk_mul_f32 v[34:35], v[40:41], v[98:99] op_sel_hi:[0,1]
    v_pk_mul_f32 v[38:39], v[44:45], v[114:115] op_sel_hi:[0,1]
    v_pk_fma_f32 v[32:33], v[40:41], v[100:101], v[32:33] op_sel:[1,0,0] op_sel_hi:[1,1,1]
    v_pk_fma_f32 v[34:35], v[40:41], v[102:103], v[34:35] op_sel:[1,0,0] op_sel_hi:[1,1,1]
    v_pk_fma_f32 v[36:37], v[44:45], v[116:117], v[36:37] op_sel:[1,0,0] op_sel_hi:[1,1,1]
    v_pk_fma_f32 v[38:39], v[44:45], v[118:119], v[38:39] op_sel:[1,0,0] op_sel_hi:[1,1,1]
    v_pk_fma_f32 v[32:33], v[42:43], v[104:105], v[32:33] op_sel_hi:[0,1,1]
    v_pk_fma_f32 v[34:35], v[42:43], v[106:107], v[34:35] op_sel_hi:[0,1,1]
    v_pk_fma_f32 v[36:37], v[46:47], v[120:121], v[36:37] op_sel_hi:[0,1,1]
    v_pk_fma_f32 v[38:39], v[46:47], v[122:123], v[38:39] op_sel_hi:[0,1,1]
    v_pk_fma_f32 v[32:33], v[42:43], v[108:109], v[32:33] op_sel:[1,0,0] op_sel_hi:[1,1,1]
    v_pk_fma_f32 v[34:35], v[42:43], v[110:111], v[34:35] op_sel:[1,0,0] op_sel_hi:[1,1,1]
    v_pk_fma_f32 v[36:37], v[46:47], v[124:125], v[36:37] op_sel:[1,0,0] op_sel_hi:[1,1,1]
    v_pk_fma_f32 v[38:39], v[46:47], v[126:127], v[38:39] op_sel:[1,0,0] op_sel_hi:[1,1,1]
    v_pk_add_f32 v[32:33], v[32:33], v[36:37]
    v_pk_add_f32 v[34:35], v[34:35], v[38:39]
    s_nop 1
    v_permlane32_swap_b32 v32, v34
    v_permlane32_swap_b32 v33, v35
    v_add_f32 v32, v32, v34
    v_add_f32 v33, v33, v35
    s_nop 1
    v_permlane16_swap_b32 v32, v33
    v_add_f32 v32, v32, v33
    v_cvt_pk_bf16_f32 v32, v32, v32
    ds_write_b16 v25, v32 offset:1600
    s_mov_b64 exec, 1
    ds_add_u32 v2, v3 offset:68
    s_mov_b64 exec, -1
    s_add_u32 s54, s54, 24576
    s_add_u32 s55, s55, 24576
    ds_read_b32 v40, v24 offset:2816
    ds_read_b32 v41, v24 offset:2832
    ds_read_b32 v42, v24 offset:2848
    ds_read_b32 v43, v24 offset:2864
    ds_read_b32 v44, v24 offset:2880
    ds_read_b32 v45, v24 offset:2896
    ds_read_b32 v46, v24 offset:2912
    ds_read_b32 v47, v24 offset:2928
    s_mov_b32 s57, 524288
L_lw228:
    ds_read_b32 v13, v2 offset:52
    s_waitcnt lgkmcnt(0)
    v_readfirstlane_b32 s52, v13
    s_cmp_ge_u32 s52, 4
    s_cbranch_scc1 L_lwok228
    s_sub_u32 s57, s57, 1
    s_cbranch_scc1 L_lwok228
    s_sleep 2
    s_branch L_lw228
L_lwok228:
    s_mov_b32 s57, 65536
L_og227:
    buffer_load_dwordx4 v[96:99], v12, s[40:43], s54 offen offset:0 nt
    buffer_load_dwordx4 v[100:103], v12, s[40:43], s54 offen offset:1024 nt
    buffer_load_dwordx4 v[104:107], v12, s[40:43], s54 offen offset:2048 nt
    buffer_load_dwordx4 v[108:111], v12, s[40:43], s54 offen offset:3072 nt
    buffer_load_dwordx4 v[112:115], v12, s[40:43], s55 offen offset:0 nt
    buffer_load_dwordx4 v[116:119], v12, s[40:43], s55 offen offset:1024 nt
    buffer_load_dwordx4 v[120:123], v12, s[40:43], s55 offen offset:2048 nt
    buffer_load_dwordx4 v[124:127], v12, s[40:43], s55 offen offset:3072 nt
    s_waitcnt vmcnt(0)
    v_bitop3_b32 v13, v99, v103, 2 bitop3:0x80
    v_bitop3_b32 v13, v107, v111, v13 bitop3:0x80
    v_bitop3_b32 v13, v115, v119, v13 bitop3:0x80
    v_bitop3_b32 v13, v123, v127, v13 bitop3:0x80
    v_cmp_eq_u32 vcc, 0, v13
    v_mul_f32 v32, v40, v96
    v_mul_f32 v36, v44, v112
    v_mul_f32 v33, v40, v97
    v_mul_f32 v37, v44, v113
    s_nop 0
    s_cbranch_vccz L_og227_ok0
    s_sleep 8
    s_sub_u32 s57, s57, 1
    s_cbranch_scc0 L_og227
L_og227_ok0:
    v_pk_mul_f32 v[34:35], v[40:41], v[98:99] op_sel_hi:[0,1]
    v_pk_mul_f32 v[38:39], v[44:45], v[114:115] op_sel_hi:[0,1]
    v_pk_fma_f32 v[32:33], v[40:41], v[100:101], v[32:33] op_sel:[1,0,0] op_sel_hi:[1,1,1]
    v_pk_fma_f32 v[34:35], v[40:41], v[102:103], v[34:35] op_sel:[1,0,0] op_sel_hi:[1,1,1]
    v_pk_fma_f32 v[36:37], v[44:45], v[116:117], v[36:37] op_sel:[1,0,0] op_sel_hi:[1,1,1]
    v_pk_fma_f32 v[38:39], v[44:45], v[118:119], v[38:39] op_sel:[1,0,0] op_sel_hi:[1,1,1]
    v_pk_fma_f32 v[32:33], v[42:43], v[104:105], v[32:33] op_sel_hi:[0,1,1]
    v_pk_fma_f32 v[34:35], v[42:43], v[106:107], v[34:35] op_sel_hi:[0,1,1]
    v_pk_fma_f32 v[36:37], v[46:47], v[120:121], v[36:37] op_sel_hi:[0,1,1]
    v_pk_fma_f32 v[38:39], v[46:47], v[122:123], v[38:39] op_sel_hi:[0,1,1]
    v_pk_fma_f32 v[32:33], v[42:43], v[108:109], v[32:33] op_sel:[1,0,0] op_sel_hi:[1,1,1]
    v_pk_fma_f32 v[34:35], v[42:43], v[110:111], v[34:35] op_sel:[1,0,0] op_sel_hi:[1,1,1]
    v_pk_fma_f32 v[36:37], v[46:47], v[124:125], v[36:37] op_sel:[1,0,0] op_sel_hi:[1,1,1]
    v_pk_fma_f32 v[38:39], v[46:47], v[126:127], v[38:39] op_sel:[1,0,0] op_sel_hi:[1,1,1]
    v_pk_add_f32 v[32:33], v[32:33], v[36:37]
    v_pk_add_f32 v[34:35], v[34:35], v[38:39]
    s_nop 1
    v_permlane32_swap_b32 v32, v34
    v_permlane32_swap_b32 v33, v35
    v_add_f32 v32, v32, v34
    v_add_f32 v33, v33, v35
    s_nop 1
    v_permlane16_swap_b32 v32, v33
    v_add_f32 v32, v32, v33
    v_cvt_pk_bf16_f32 v32, v32, v32
    ds_write_b16 v25, v32 offset:1728
    s_mov_b64 exec, 1
    ds_add_u32 v2, v3 offset:68
    s_mov_b64 exec, -1
    s_add_u32 s54, s54, 24576
    s_add_u32 s55, s55, 24576
    ds_read_b32 v40, v24 offset:2944
    ds_read_b32 v41, v24 offset:2960
    ds_read_b32 v42, v24 offset:2976
    ds_read_b32 v43, v24 offset:2992
    ds_read_b32 v44, v24 offset:3008
    ds_read_b32 v45, v24 offset:3024
    ds_read_b32 v46, v24 offset:3040
    ds_read_b32 v47, v24 offset:3056
    s_mov_b32 s57, 524288
L_lw230:
    ds_read_b32 v13, v2 offset:56
    s_waitcnt lgkmcnt(0)
    v_readfirstlane_b32 s52, v13
    s_cmp_ge_u32 s52, 4
    s_cbranch_scc1 L_lwok230
    s_sub_u32 s57, s57, 1
    s_cbranch_scc1 L_lwok230
    s_sleep 2
    s_branch L_lw230
L_lwok230:
    s_mov_b32 s57, 65536
L_og229:
    buffer_load_dwordx4 v[96:99], v12, s[40:43], s54 offen offset:0 nt
    buffer_load_dwordx4 v[100:103], v12, s[40:43], s54 offen offset:1024 nt
    buffer_load_dwordx4 v[104:107], v12, s[40:43], s54 offen offset:2048 nt
    buffer_load_dwordx4 v[108:111], v12, s[40:43], s54 offen offset:3072 nt
    buffer_load_dwordx4 v[112:115], v12, s[40:43], s55 offen offset:0 nt
    buffer_load_dwordx4 v[116:119], v12, s[40:43], s55 offen offset:1024 nt
    buffer_load_dwordx4 v[120:123], v12, s[40:43], s55 offen offset:2048 nt
    buffer_load_dwordx4 v[124:127], v12, s[40:43], s55 offen offset:3072 nt
    s_waitcnt vmcnt(0)
    v_bitop3_b32 v13, v99, v103, 2 bitop3:0x80
    v_bitop3_b32 v13, v107, v111, v13 bitop3:0x80
    v_bitop3_b32 v13, v115, v119, v13 bitop3:0x80
    v_bitop3_b32 v13, v123, v127, v13 bitop3:0x80
    v_cmp_eq_u32 vcc, 0, v13
    v_mul_f32 v32, v40, v96
    v_mul_f32 v36, v44, v112
    v_mul_f32 v33, v40, v97
    v_mul_f32 v37, v44, v113
    s_nop 0
    s_cbranch_vccz L_og229_ok0
    s_sleep 8
    s_sub_u32 s57, s57, 1
    s_cbranch_scc0 L_og229
L_og229_ok0:
    v_pk_mul_f32 v[34:35], v[40:41], v[98:99] op_sel_hi:[0,1]
    v_pk_mul_f32 v[38:39], v[44:45], v[114:115] op_sel_hi:[0,1]
    v_pk_fma_f32 v[32:33], v[40:41], v[100:101], v[32:33] op_sel:[1,0,0] op_sel_hi:[1,1,1]
    v_pk_fma_f32 v[34:35], v[40:41], v[102:103], v[34:35] op_sel:[1,0,0] op_sel_hi:[1,1,1]
    v_pk_fma_f32 v[36:37], v[44:45], v[116:117], v[36:37] op_sel:[1,0,0] op_sel_hi:[1,1,1]
    v_pk_fma_f32 v[38:39], v[44:45], v[118:119], v[38:39] op_sel:[1,0,0] op_sel_hi:[1,1,1]
    v_pk_fma_f32 v[32:33], v[42:43], v[104:105], v[32:33] op_sel_hi:[0,1,1]
    v_pk_fma_f32 v[34:35], v[42:43], v[106:107], v[34:35] op_sel_hi:[0,1,1]
    v_pk_fma_f32 v[36:37], v[46:47], v[120:121], v[36:37] op_sel_hi:[0,1,1]
    v_pk_fma_f32 v[38:39], v[46:47], v[122:123], v[38:39] op_sel_hi:[0,1,1]
    v_pk_fma_f32 v[32:33], v[42:43], v[108:109], v[32:33] op_sel:[1,0,0] op_sel_hi:[1,1,1]
    v_pk_fma_f32 v[34:35], v[42:43], v[110:111], v[34:35] op_sel:[1,0,0] op_sel_hi:[1,1,1]
    v_pk_fma_f32 v[36:37], v[46:47], v[124:125], v[36:37] op_sel:[1,0,0] op_sel_hi:[1,1,1]
    v_pk_fma_f32 v[38:39], v[46:47], v[126:127], v[38:39] op_sel:[1,0,0] op_sel_hi:[1,1,1]
    v_pk_add_f32 v[32:33], v[32:33], v[36:37]
    v_pk_add_f32 v[34:35], v[34:35], v[38:39]
    s_nop 1
    v_permlane32_swap_b32 v32, v34
    v_permlane32_swap_b32 v33, v35
    v_add_f32 v32, v32, v34
    v_add_f32 v33, v33, v35
    s_nop 1
    v_permlane16_swap_b32 v32, v33
    v_add_f32 v32, v32, v33
    v_cvt_pk_bf16_f32 v32, v32, v32
    ds_write_b16 v25, v32 offset:1856
    s_mov_b64 exec, 1
    ds_add_u32 v2, v3 offset:68
    s_mov_b64 exec, -1
    s_add_u32 s54, s54, 24576
    s_add_u32 s55, s55, 24576
    s_branch L_bme216
L_bm216:
    ds_read_b32 v40, v24 offset:2176
    ds_read_b32 v41, v24 offset:2192
    ds_read_b32 v42, v24 offset:2208
    ds_read_b32 v43, v24 offset:2224
    ds_read_b32 v44, v24 offset:2240
    ds_read_b32 v45, v24 offset:2256
    ds_read_b32 v46, v24 offset:2272
    ds_read_b32 v47, v24 offset:2288
    s_mov_b32 s57, 524288
L_lw232:
    ds_read_b32 v13, v2 offset:32
    s_waitcnt lgkmcnt(0)
    v_readfirstlane_b32 s52, v13
    s_cmp_ge_u32 s52, 4
    s_cbranch_scc1 L_lwok232
    s_sub_u32 s57, s57, 1
    s_cbranch_scc1 L_lwok232
    s_sleep 2
    s_branch L_lw232
L_lwok232:
    s_mov_b32 s57, 65536
L_og231:
    buffer_load_dwordx4 v[96:99], v12, s[40:43], s54 offen offset:0 sc1
    buffer_load_dwordx4 v[100:103], v12, s[40:43], s54 offen offset:1024 sc1
    buffer_load_dwordx4 v[104:107], v12, s[40:43], s54 offen offset:2048 sc1
    buffer_load_dwordx4 v[108:111], v12, s[40:43], s54 offen offset:3072 sc1
    buffer_load_dwordx4 v[112:115], v12, s[40:43], s55 offen offset:0 sc1
    buffer_load_dwordx4 v[116:119], v12, s[40:43], s55 offen offset:1024 sc1
    buffer_load_dwordx4 v[120:123], v12, s[40:43], s55 offen offset:2048 sc1
    buffer_load_dwordx4 v[124:127], v12, s[40:43], s55 offen offset:3072 sc1
    s_waitcnt vmcnt(0)
    v_bitop3_b32 v13, v99, v103, 1 bitop3:0x80
    v_bitop3_b32 v13, v107, v111, v13 bitop3:0x80
    v_bitop3_b32 v13, v115, v119, v13 bitop3:0x80
    v_bitop3_b32 v13, v123, v127, v13 bitop3:0x80
    v_cmp_eq_u32 vcc, 0, v13
    v_mul_f32 v32, v40, v96
    v_mul_f32 v36, v44, v112
    v_mul_f32 v33, v40, v97
    v_mul_f32 v37, v44, v113
    s_nop 0
    s_cbranch_vccz L_og231_ok0
    s_sleep 8
    s_sub_u32 s57, s57, 1
    s_cbranch_scc0 L_og231
L_og231_ok0:
    v_pk_mul_f32 v[34:35], v[40:41], v[98:99] op_sel_hi:[0,1]
    v_pk_mul_f32 v[38:39], v[44:45], v[114:115] op_sel_hi:[0,1]
    v_pk_fma_f32 v[32:33], v[40:41], v[100:101], v[32:33] op_sel:[1,0,0] op_sel_hi:[1,1,1]
    v_pk_fma_f32 v[34:35], v[40:41], v[102:103], v[34:35] op_sel:[1,0,0] op_sel_hi:[1,1,1]
    v_pk_fma_f32 v[36:37], v[44:45], v[116:117], v[36:37] op_sel:[1,0,0] op_sel_hi:[1,1,1]
    v_pk_fma_f32 v[38:39], v[44:45], v[118:119], v[38:39] op_sel:[1,0,0] op_sel_hi:[1,1,1]
    v_pk_fma_f32 v[32:33], v[42:43], v[104:105], v[32:33] op_sel_hi:[0,1,1]
    v_pk_fma_f32 v[34:35], v[42:43], v[106:107], v[34:35] op_sel_hi:[0,1,1]
    v_pk_fma_f32 v[36:37], v[46:47], v[120:121], v[36:37] op_sel_hi:[0,1,1]
    v_pk_fma_f32 v[38:39], v[46:47], v[122:123], v[38:39] op_sel_hi:[0,1,1]
    v_pk_fma_f32 v[32:33], v[42:43], v[108:109], v[32:33] op_sel:[1,0,0] op_sel_hi:[1,1,1]
    v_pk_fma_f32 v[34:35], v[42:43], v[110:111], v[34:35] op_sel:[1,0,0] op_sel_hi:[1,1,1]
    v_pk_fma_f32 v[36:37], v[46:47], v[124:125], v[36:37] op_sel:[1,0,0] op_sel_hi:[1,1,1]
    v_pk_fma_f32 v[38:39], v[46:47], v[126:127], v[38:39] op_sel:[1,0,0] op_sel_hi:[1,1,1]
    v_pk_add_f32 v[32:33], v[32:33], v[36:37]
    v_pk_add_f32 v[34:35], v[34:35], v[38:39]
    s_nop 1
    v_permlane32_swap_b32 v32, v34
    v_permlane32_swap_b32 v33, v35
    v_add_f32 v32, v32, v34
    v_add_f32 v33, v33, v35
    s_nop 1
    v_permlane16_swap_b32 v32, v33
    v_add_f32 v32, v32, v33
    v_cvt_pk_bf16_f32 v32, v32, v32
    ds_write_b16 v25, v32 offset:1024
    s_mov_b64 exec, 1
    ds_add_u32 v2, v3 offset:68
    s_mov_b64 exec, -1
    s_add_u32 s54, s54, 24576
    s_add_u32 s55, s55, 24576
    ds_read_b32 v40, v24 offset:2304
    ds_read_b32 v41, v24 offset:2320
    ds_read_b32 v42, v24 offset:2336
    ds_read_b32 v43, v24 offset:2352
    ds_read_b32 v44, v24 offset:2368
    ds_read_b32 v45, v24 offset:2384
    ds_read_b32 v46, v24 offset:2400
    ds_read_b32 v47, v24 offset:2416
    s_mov_b32 s57, 524288
L_lw234:
    ds_read_b32 v13, v2 offset:36
    s_waitcnt lgkmcnt(0)
    v_readfirstlane_b32 s52, v13
    s_cmp_ge_u32 s52, 4
    s_cbranch_scc1 L_lwok234
    s_sub_u32 s57, s57, 1
    s_cbranch_scc1 L_lwok234
    s_sleep 2
    s_branch L_lw234
L_lwok234:
    s_mov_b32 s57, 65536
L_og233:
    buffer_load_dwordx4 v[96:99], v12, s[40:43], s54 offen offset:0 sc1
    buffer_load_dwordx4 v[100:103], v12, s[40:43], s54 offen offset:1024 sc1
    buffer_load_dwordx4 v[104:107], v12, s[40:43], s54 offen offset:2048 sc1
    buffer_load_dwordx4 v[108:111], v12, s[40:43], s54 offen offset:3072 sc1
    buffer_load_dwordx4 v[112:115], v12, s[40:43], s55 offen offset:0 sc1
    buffer_load_dwordx4 v[116:119], v12, s[40:43], s55 offen offset:1024 sc1
    buffer_load_dwordx4 v[120:123], v12, s[40:43], s55 offen offset:2048 sc1
    buffer_load_dwordx4 v[124:127], v12, s[40:43], s55 offen offset:3072 sc1
    s_waitcnt vmcnt(0)
    v_bitop3_b32 v13, v99, v103, 1 bitop3:0x80
    v_bitop3_b32 v13, v107, v111, v13 bitop3:0x80
    v_bitop3_b32 v13, v115, v119, v13 bitop3:0x80
    v_bitop3_b32 v13, v123, v127, v13 bitop3:0x80
    v_cmp_eq_u32 vcc, 0, v13
    v_mul_f32 v32, v40, v96
    v_mul_f32 v36, v44, v112
    v_mul_f32 v33, v40, v97
    v_mul_f32 v37, v44, v113
    s_nop 0
    s_cbranch_vccz L_og233_ok0
    s_sleep 8
    s_sub_u32 s57, s57, 1
    s_cbranch_scc0 L_og233
L_og233_ok0:
    v_pk_mul_f32 v[34:35], v[40:41], v[98:99] op_sel_hi:[0,1]
    v_pk_mul_f32 v[38:39], v[44:45], v[114:115] op_sel_hi:[0,1]
    v_pk_fma_f32 v[32:33], v[40:41], v[100:101], v[32:33] op_sel:[1,0,0] op_sel_hi:[1,1,1]
    v_pk_fma_f32 v[34:35], v[40:41], v[102:103], v[34:35] op_sel:[1,0,0] op_sel_hi:[1,1,1]
    v_pk_fma_f32 v[36:37], v[44:45], v[116:117], v[36:37] op_sel:[1,0,0] op_sel_hi:[1,1,1]
    v_pk_fma_f32 v[38:39], v[44:45], v[118:119], v[38:39] op_sel:[1,0,0] op_sel_hi:[1,1,1]
    v_pk_fma_f32 v[32:33], v[42:43], v[104:105], v[32:33] op_sel_hi:[0,1,1]
    v_pk_fma_f32 v[34:35], v[42:43], v[106:107], v[34:35] op_sel_hi:[0,1,1]
    v_pk_fma_f32 v[36:37], v[46:47], v[120:121], v[36:37] op_sel_hi:[0,1,1]
    v_pk_fma_f32 v[38:39], v[46:47], v[122:123], v[38:39] op_sel_hi:[0,1,1]
    v_pk_fma_f32 v[32:33], v[42:43], v[108:109], v[32:33] op_sel:[1,0,0] op_sel_hi:[1,1,1]
    v_pk_fma_f32 v[34:35], v[42:43], v[110:111], v[34:35] op_sel:[1,0,0] op_sel_hi:[1,1,1]
    v_pk_fma_f32 v[36:37], v[46:47], v[124:125], v[36:37] op_sel:[1,0,0] op_sel_hi:[1,1,1]
    v_pk_fma_f32 v[38:39], v[46:47], v[126:127], v[38:39] op_sel:[1,0,0] op_sel_hi:[1,1,1]
    v_pk_add_f32 v[32:33], v[32:33], v[36:37]
    v_pk_add_f32 v[34:35], v[34:35], v[38:39]
    s_nop 1
    v_permlane32_swap_b32 v32, v34
    v_permlane32_swap_b32 v33, v35
    v_add_f32 v32, v32, v34
    v_add_f32 v33, v33, v35
    s_nop 1
    v_permlane16_swap_b32 v32, v33
    v_add_f32 v32, v32, v33
    v_cvt_pk_bf16_f32 v32, v32, v32
    ds_write_b16 v25, v32 offset:1152
    s_mov_b64 exec, 1
    ds_add_u32 v2, v3 offset:68
    s_mov_b64 exec, -1
    s_add_u32 s54, s54, 24576
    s_add_u32 s55, s55, 24576
    ds_read_b32 v40, v24 offset:2432
    ds_read_b32 v41, v24 offset:2448
    ds_read_b32 v42, v24 offset:2464
    ds_read_b32 v43, v24 offset:2480
    ds_read_b32 v44, v24 offset:2496
    ds_read_b32 v45, v24 offset:2512
    ds_read_b32 v46, v24 offset:2528
    ds_read_b32 v47, v24 offset:2544
    s_mov_b32 s57, 524288
L_lw236:
    ds_read_b32 v13, v2 offset:40
    s_waitcnt lgkmcnt(0)
    v_readfirstlane_b32 s52, v13
    s_cmp_ge_u32 s52, 4
    s_cbranch_scc1 L_lwok236
    s_sub_u32 s57, s57, 1
    s_cbranch_scc1 L_lwok236
    s_sleep 2
    s_branch L_lw236
L_lwok236:
    s_mov_b32 s57, 65536
L_og235:
    buffer_load_dwordx4 v[96:99], v12, s[40:43], s54 offen offset:0 sc1
    buffer_load_dwordx4 v[100:103], v12, s[40:43], s54 offen offset:1024 sc1
    buffer_load_dwordx4 v[104:107], v12, s[40:43], s54 offen offset:2048 sc1
    buffer_load_dwordx4 v[108:111], v12, s[40:43], s54 offen offset:3072 sc1
    buffer_load_dwordx4 v[112:115], v12, s[40:43], s55 offen offset:0 sc1
    buffer_load_dwordx4 v[116:119], v12, s[40:43], s55 offen offset:1024 sc1
    buffer_load_dwordx4 v[120:123], v12, s[40:43], s55 offen offset:2048 sc1
    buffer_load_dwordx4 v[124:127], v12, s[40:43], s55 offen offset:3072 sc1
    s_waitcnt vmcnt(0)
    v_bitop3_b32 v13, v99, v103, 1 bitop3:0x80
    v_bitop3_b32 v13, v107, v111, v13 bitop3:0x80
    v_bitop3_b32 v13, v115, v119, v13 bitop3:0x80
    v_bitop3_b32 v13, v123, v127, v13 bitop3:0x80
    v_cmp_eq_u32 vcc, 0, v13
    v_mul_f32 v32, v40, v96
    v_mul_f32 v36, v44, v112
    v_mul_f32 v33, v40, v97
    v_mul_f32 v37, v44, v113
    s_nop 0
    s_cbranch_vccz L_og235_ok0
    s_sleep 8
    s_sub_u32 s57, s57, 1
    s_cbranch_scc0 L_og235
L_og235_ok0:
    v_pk_mul_f32 v[34:35], v[40:41], v[98:99] op_sel_hi:[0,1]
    v_pk_mul_f32 v[38:39], v[44:45], v[114:115] op_sel_hi:[0,1]
    v_pk_fma_f32 v[32:33], v[40:41], v[100:101], v[32:33] op_sel:[1,0,0] op_sel_hi:[1,1,1]
    v_pk_fma_f32 v[34:35], v[40:41], v[102:103], v[34:35] op_sel:[1,0,0] op_sel_hi:[1,1,1]
    v_pk_fma_f32 v[36:37], v[44:45], v[116:117], v[36:37] op_sel:[1,0,0] op_sel_hi:[1,1,1]
    v_pk_fma_f32 v[38:39], v[44:45], v[118:119], v[38:39] op_sel:[1,0,0] op_sel_hi:[1,1,1]
    v_pk_fma_f32 v[32:33], v[42:43], v[104:105], v[32:33] op_sel_hi:[0,1,1]
    v_pk_fma_f32 v[34:35], v[42:43], v[106:107], v[34:35] op_sel_hi:[0,1,1]
    v_pk_fma_f32 v[36:37], v[46:47], v[120:121], v[36:37] op_sel_hi:[0,1,1]
    v_pk_fma_f32 v[38:39], v[46:47], v[122:123], v[38:39] op_sel_hi:[0,1,1]
    v_pk_fma_f32 v[32:33], v[42:43], v[108:109], v[32:33] op_sel:[1,0,0] op_sel_hi:[1,1,1]
    v_pk_fma_f32 v[34:35], v[42:43], v[110:111], v[34:35] op_sel:[1,0,0] op_sel_hi:[1,1,1]
    v_pk_fma_f32 v[36:37], v[46:47], v[124:125], v[36:37] op_sel:[1,0,0] op_sel_hi:[1,1,1]
    v_pk_fma_f32 v[38:39], v[46:47], v[126:127], v[38:39] op_sel:[1,0,0] op_sel_hi:[1,1,1]
    v_pk_add_f32 v[32:33], v[32:33], v[36:37]
    v_pk_add_f32 v[34:35], v[34:35], v[38:39]
    s_nop 1
    v_permlane32_swap_b32 v32, v34
    v_permlane32_swap_b32 v33, v35
    v_add_f32 v32, v32, v34
    v_add_f32 v33, v33, v35
    s_nop 1
    v_permlane16_swap_b32 v32, v33
    v_add_f32 v32, v32, v33
    v_cvt_pk_bf16_f32 v32, v32, v32
    ds_write_b16 v25, v32 offset:1280
    s_mov_b64 exec, 1
    ds_add_u32 v2, v3 offset:68
    s_mov_b64 exec, -1
    s_add_u32 s54, s54, 24576
    s_add_u32 s55, s55, 24576
    ds_read_b32 v40, v24 offset:2560
    ds_read_b32 v41, v24 offset:2576
    ds_read_b32 v42, v24 offset:2592
    ds_read_b32 v43, v24 offset:2608
    ds_read_b32 v44, v24 offset:2624
    ds_read_b32 v45, v24 offset:2640
    ds_read_b32 v46, v24 offset:2656
    ds_read_b32 v47, v24 offset:2672
    s_mov_b32 s57, 524288
L_lw238:
    ds_read_b32 v13, v2 offset:44
    s_waitcnt lgkmcnt(0)
    v_readfirstlane_b32 s52, v13
    s_cmp_ge_u32 s52, 4
    s_cbranch_scc1 L_lwok238
    s_sub_u32 s57, s57, 1
    s_cbranch_scc1 L_lwok238
    s_sleep 2
    s_branch L_lw238
L_lwok238:
    s_mov_b32 s57, 65536
L_og237:
    buffer_load_dwordx4 v[96:99], v12, s[40:43], s54 offen offset:0 sc1
    buffer_load_dwordx4 v[100:103], v12, s[40:43], s54 offen offset:1024 sc1
    buffer_load_dwordx4 v[104:107], v12, s[40:43], s54 offen offset:2048 sc1
    buffer_load_dwordx4 v[108:111], v12, s[40:43], s54 offen offset:3072 sc1
    buffer_load_dwordx4 v[112:115], v12, s[40:43], s55 offen offset:0 sc1
    buffer_load_dwordx4 v[116:119], v12, s[40:43], s55 offen offset:1024 sc1
    buffer_load_dwordx4 v[120:123], v12, s[40:43], s55 offen offset:2048 sc1
    buffer_load_dwordx4 v[124:127], v12, s[40:43], s55 offen offset:3072 sc1
    s_waitcnt vmcnt(0)
    v_bitop3_b32 v13, v99, v103, 1 bitop3:0x80
    v_bitop3_b32 v13, v107, v111, v13 bitop3:0x80
    v_bitop3_b32 v13, v115, v119, v13 bitop3:0x80
    v_bitop3_b32 v13, v123, v127, v13 bitop3:0x80
    v_cmp_eq_u32 vcc, 0, v13
    v_mul_f32 v32, v40, v96
    v_mul_f32 v36, v44, v112
    v_mul_f32 v33, v40, v97
    v_mul_f32 v37, v44, v113
    s_nop 0
    s_cbranch_vccz L_og237_ok0
    s_sleep 8
    s_sub_u32 s57, s57, 1
    s_cbranch_scc0 L_og237
L_og237_ok0:
    v_pk_mul_f32 v[34:35], v[40:41], v[98:99] op_sel_hi:[0,1]
    v_pk_mul_f32 v[38:39], v[44:45], v[114:115] op_sel_hi:[0,1]
    v_pk_fma_f32 v[32:33], v[40:41], v[100:101], v[32:33] op_sel:[1,0,0] op_sel_hi:[1,1,1]
    v_pk_fma_f32 v[34:35], v[40:41], v[102:103], v[34:35] op_sel:[1,0,0] op_sel_hi:[1,1,1]
    v_pk_fma_f32 v[36:37], v[44:45], v[116:117], v[36:37] op_sel:[1,0,0] op_sel_hi:[1,1,1]
    v_pk_fma_f32 v[38:39], v[44:45], v[118:119], v[38:39] op_sel:[1,0,0] op_sel_hi:[1,1,1]
    v_pk_fma_f32 v[32:33], v[42:43], v[104:105], v[32:33] op_sel_hi:[0,1,1]
    v_pk_fma_f32 v[34:35], v[42:43], v[106:107], v[34:35] op_sel_hi:[0,1,1]
    v_pk_fma_f32 v[36:37], v[46:47], v[120:121], v[36:37] op_sel_hi:[0,1,1]
    v_pk_fma_f32 v[38:39], v[46:47], v[122:123], v[38:39] op_sel_hi:[0,1,1]
    v_pk_fma_f32 v[32:33], v[42:43], v[108:109], v[32:33] op_sel:[1,0,0] op_sel_hi:[1,1,1]
    v_pk_fma_f32 v[34:35], v[42:43], v[110:111], v[34:35] op_sel:[1,0,0] op_sel_hi:[1,1,1]
    v_pk_fma_f32 v[36:37], v[46:47], v[124:125], v[36:37] op_sel:[1,0,0] op_sel_hi:[1,1,1]
    v_pk_fma_f32 v[38:39], v[46:47], v[126:127], v[38:39] op_sel:[1,0,0] op_sel_hi:[1,1,1]
    v_pk_add_f32 v[32:33], v[32:33], v[36:37]
    v_pk_add_f32 v[34:35], v[34:35], v[38:39]
    s_nop 1
    v_permlane32_swap_b32 v32, v34
    v_permlane32_swap_b32 v33, v35
    v_add_f32 v32, v32, v34
    v_add_f32 v33, v33, v35
    s_nop 1
    v_permlane16_swap_b32 v32, v33
    v_add_f32 v32, v32, v33
    v_cvt_pk_bf16_f32 v32, v32, v32
    ds_write_b16 v25, v32 offset:1408
    s_mov_b64 exec, 1
    ds_add_u32 v2, v3 offset:68
    s_mov_b64 exec, -1
    s_sub_u32 s54, s54, 73728
    s_sub_u32 s55, s55, 73728
    ds_read_b32 v40, v24 offset:2688
    ds_read_b32 v41, v24 offset:2704
    ds_read_b32 v42, v24 offset:2720
    ds_read_b32 v43, v24 offset:2736
    ds_read_b32 v44, v24 offset:2752
    ds_read_b32 v45, v24 offset:2768
    ds_read_b32 v46, v24 offset:2784
    ds_read_b32 v47, v24 offset:2800
    s_mov_b32 s57, 524288
L_lw240:
    ds_read_b32 v13, v2 offset:48
    s_waitcnt lgkmcnt(0)
    v_readfirstlane_b32 s52, v13
    s_cmp_ge_u32 s52, 4
    s_cbranch_scc1 L_lwok240
    s_sub_u32 s57, s57, 1
    s_cbranch_scc1 L_lwok240
    s_sleep 2
    s_branch L_lw240
L_lwok240:
    s_mov_b32 s57, 65536
L_og239:
    buffer_load_dwordx4 v[96:99], v12, s[40:43], s54 offen offset:0 sc1
    buffer_load_dwordx4 v[100:103], v12, s[40:43], s54 offen offset:1024 sc1
    buffer_load_dwordx4 v[104:107], v12, s[40:43], s54 offen offset:2048 sc1
    buffer_load_dwordx4 v[108:111], v12, s[40:43], s54 offen offset:3072 sc1
    buffer_load_dwordx4 v[112:115], v12, s[40:43], s55 offen offset:0 sc1
    buffer_load_dwordx4 v[116:119], v12, s[40:43], s55 offen offset:1024 sc1
    buffer_load_dwordx4 v[120:123], v12, s[40:43], s55 offen offset:2048 sc1
    buffer_load_dwordx4 v[124:127], v12, s[40:43], s55 offen offset:3072 sc1
    s_waitcnt vmcnt(0)
    v_bitop3_b32 v13, v99, v103, 2 bitop3:0x80
    v_bitop3_b32 v13, v107, v111, v13 bitop3:0x80
    v_bitop3_b32 v13, v115, v119, v13 bitop3:0x80
    v_bitop3_b32 v13, v123, v127, v13 bitop3:0x80
    v_cmp_eq_u32 vcc, 0, v13
    v_mul_f32 v32, v40, v96
    v_mul_f32 v36, v44, v112
    v_mul_f32 v33, v40, v97
    v_mul_f32 v37, v44, v113
    s_nop 0
    s_cbranch_vccz L_og239_ok0
    s_sleep 8
    s_sub_u32 s57, s57, 1
    s_cbranch_scc0 L_og239
L_og239_ok0:
    v_pk_mul_f32 v[34:35], v[40:41], v[98:99] op_sel_hi:[0,1]
    v_pk_mul_f32 v[38:39], v[44:45], v[114:115] op_sel_hi:[0,1]
    v_pk_fma_f32 v[32:33], v[40:41], v[100:101], v[32:33] op_sel:[1,0,0] op_sel_hi:[1,1,1]
    v_pk_fma_f32 v[34:35], v[40:41], v[102:103], v[34:35] op_sel:[1,0,0] op_sel_hi:[1,1,1]
    v_pk_fma_f32 v[36:37], v[44:45], v[116:117], v[36:37] op_sel:[1,0,0] op_sel_hi:[1,1,1]
    v_pk_fma_f32 v[38:39], v[44:45], v[118:119], v[38:39] op_sel:[1,0,0] op_sel_hi:[1,1,1]
    v_pk_fma_f32 v[32:33], v[42:43], v[104:105], v[32:33] op_sel_hi:[0,1,1]
    v_pk_fma_f32 v[34:35], v[42:43], v[106:107], v[34:35] op_sel_hi:[0,1,1]
    v_pk_fma_f32 v[36:37], v[46:47], v[120:121], v[36:37] op_sel_hi:[0,1,1]
    v_pk_fma_f32 v[38:39], v[46:47], v[122:123], v[38:39] op_sel_hi:[0,1,1]
    v_pk_fma_f32 v[32:33], v[42:43], v[108:109], v[32:33] op_sel:[1,0,0] op_sel_hi:[1,1,1]
    v_pk_fma_f32 v[34:35], v[42:43], v[110:111], v[34:35] op_sel:[1,0,0] op_sel_hi:[1,1,1]
    v_pk_fma_f32 v[36:37], v[46:47], v[124:125], v[36:37] op_sel:[1,0,0] op_sel_hi:[1,1,1]
    v_pk_fma_f32 v[38:39], v[46:47], v[126:127], v[38:39] op_sel:[1,0,0] op_sel_hi:[1,1,1]
    v_pk_add_f32 v[32:33], v[32:33], v[36:37]
    v_pk_add_f32 v[34:35], v[34:35], v[38:39]
    s_nop 1
    v_permlane32_swap_b32 v32, v34
    v_permlane32_swap_b32 v33, v35
    v_add_f32 v32, v32, v34
    v_add_f32 v33, v33, v35
    s_nop 1
    v_permlane16_swap_b32 v32, v33
    v_add_f32 v32, v32, v33
    v_cvt_pk_bf16_f32 v32, v32, v32
    ds_write_b16 v25, v32 offset:1600
    s_mov_b64 exec, 1
    ds_add_u32 v2, v3 offset:68
    s_mov_b64 exec, -1
    s_add_u32 s54, s54, 24576
    s_add_u32 s55, s55, 24576
    ds_read_b32 v40, v24 offset:2816
    ds_read_b32 v41, v24 offset:2832
    ds_read_b32 v42, v24 offset:2848
    ds_read_b32 v43, v24 offset:2864
    ds_read_b32 v44, v24 offset:2880
    ds_read_b32 v45, v24 offset:2896
    ds_read_b32 v46, v24 offset:2912
    ds_read_b32 v47, v24 offset:2928
    s_mov_b32 s57, 524288
L_lw242:
    ds_read_b32 v13, v2 offset:52
    s_waitcnt lgkmcnt(0)
    v_readfirstlane_b32 s52, v13
    s_cmp_ge_u32 s52, 4
    s_cbranch_scc1 L_lwok242
    s_sub_u32 s57, s57, 1
    s_cbranch_scc1 L_lwok242
    s_sleep 2
    s_branch L_lw242
L_lwok242:
    s_mov_b32 s57, 65536
L_og241:
    buffer_load_dwordx4 v[96:99], v12, s[40:43], s54 offen offset:0 sc1
    buffer_load_dwordx4 v[100:103], v12, s[40:43], s54 offen offset:1024 sc1
    buffer_load_dwordx4 v[104:107], v12, s[40:43], s54 offen offset:2048 sc1
    buffer_load_dwordx4 v[108:111], v12, s[40:43], s54 offen offset:3072 sc1
    buffer_load_dwordx4 v[112:115], v12, s[40:43], s55 offen offset:0 sc1
    buffer_load_dwordx4 v[116:119], v12, s[40:43], s55 offen offset:1024 sc1
    buffer_load_dwordx4 v[120:123], v12, s[40:43], s55 offen offset:2048 sc1
    buffer_load_dwordx4 v[124:127], v12, s[40:43], s55 offen offset:3072 sc1
    s_waitcnt vmcnt(0)
    v_bitop3_b32 v13, v99, v103, 2 bitop3:0x80
    v_bitop3_b32 v13, v107, v111, v13 bitop3:0x80
    v_bitop3_b32 v13, v115, v119, v13 bitop3:0x80
    v_bitop3_b32 v13, v123, v127, v13 bitop3:0x80
    v_cmp_eq_u32 vcc, 0, v13
    v_mul_f32 v32, v40, v96
    v_mul_f32 v36, v44, v112
    v_mul_f32 v33, v40, v97
    v_mul_f32 v37, v44, v113
    s_nop 0
    s_cbranch_vccz L_og241_ok0
    s_sleep 8
    s_sub_u32 s57, s57, 1
    s_cbranch_scc0 L_og241
L_og241_ok0:
    v_pk_mul_f32 v[34:35], v[40:41], v[98:99] op_sel_hi:[0,1]
    v_pk_mul_f32 v[38:39], v[44:45], v[114:115] op_sel_hi:[0,1]
    v_pk_fma_f32 v[32:33], v[40:41], v[100:101], v[32:33] op_sel:[1,0,0] op_sel_hi:[1,1,1]
    v_pk_fma_f32 v[34:35], v[40:41], v[102:103], v[34:35] op_sel:[1,0,0] op_sel_hi:[1,1,1]
    v_pk_fma_f32 v[36:37], v[44:45], v[116:117], v[36:37] op_sel:[1,0,0] op_sel_hi:[1,1,1]
    v_pk_fma_f32 v[38:39], v[44:45], v[118:119], v[38:39] op_sel:[1,0,0] op_sel_hi:[1,1,1]
    v_pk_fma_f32 v[32:33], v[42:43], v[104:105], v[32:33] op_sel_hi:[0,1,1]
    v_pk_fma_f32 v[34:35], v[42:43], v[106:107], v[34:35] op_sel_hi:[0,1,1]
    v_pk_fma_f32 v[36:37], v[46:47], v[120:121], v[36:37] op_sel_hi:[0,1,1]
    v_pk_fma_f32 v[38:39], v[46:47], v[122:123], v[38:39] op_sel_hi:[0,1,1]
    v_pk_fma_f32 v[32:33], v[42:43], v[108:109], v[32:33] op_sel:[1,0,0] op_sel_hi:[1,1,1]
    v_pk_fma_f32 v[34:35], v[42:43], v[110:111], v[34:35] op_sel:[1,0,0] op_sel_hi:[1,1,1]
    v_pk_fma_f32 v[36:37], v[46:47], v[124:125], v[36:37] op_sel:[1,0,0] op_sel_hi:[1,1,1]
    v_pk_fma_f32 v[38:39], v[46:47], v[126:127], v[38:39] op_sel:[1,0,0] op_sel_hi:[1,1,1]
    v_pk_add_f32 v[32:33], v[32:33], v[36:37]
    v_pk_add_f32 v[34:35], v[34:35], v[38:39]
    s_nop 1
    v_permlane32_swap_b32 v32, v34
    v_permlane32_swap_b32 v33, v35
    v_add_f32 v32, v32, v34
    v_add_f32 v33, v33, v35
    s_nop 1
    v_permlane16_swap_b32 v32, v33
    v_add_f32 v32, v32, v33
    v_cvt_pk_bf16_f32 v32, v32, v32
    ds_write_b16 v25, v32 offset:1728
    s_mov_b64 exec, 1
    ds_add_u32 v2, v3 offset:68
    s_mov_b64 exec, -1
    s_add_u32 s54, s54, 24576
    s_add_u32 s55, s55, 24576
    ds_read_b32 v40, v24 offset:2944
    ds_read_b32 v41, v24 offset:2960
    ds_read_b32 v42, v24 offset:2976
    ds_read_b32 v43, v24 offset:2992
    ds_read_b32 v44, v24 offset:3008
    ds_read_b32 v45, v24 offset:3024
    ds_read_b32 v46, v24 offset:3040
    ds_read_b32 v47, v24 offset:3056
    s_mov_b32 s57, 524288
L_lw244:
    ds_read_b32 v13, v2 offset:56
    s_waitcnt lgkmcnt(0)
    v_readfirstlane_b32 s52, v13
    s_cmp_ge_u32 s52, 4
    s_cbranch_scc1 L_lwok244
    s_sub_u32 s57, s57, 1
    s_cbranch_scc1 L_lwok244
    s_sleep 2
    s_branch L_lw244
L_lwok244:
    s_mov_b32 s57, 65536
L_og243:
    buffer_load_dwordx4 v[96:99], v12, s[40:43], s54 offen offset:0 sc1
    buffer_load_dwordx4 v[100:103], v12, s[40:43], s54 offen offset:1024 sc1
    buffer_load_dwordx4 v[104:107], v12, s[40:43], s54 offen offset:2048 sc1
    buffer_load_dwordx4 v[108:111], v12, s[40:43], s54 offen offset:3072 sc1
    buffer_load_dwordx4 v[112:115], v12, s[40:43], s55 offen offset:0 sc1
    buffer_load_dwordx4 v[116:119], v12, s[40:43], s55 offen offset:1024 sc1
    buffer_load_dwordx4 v[120:123], v12, s[40:43], s55 offen offset:2048 sc1
    buffer_load_dwordx4 v[124:127], v12, s[40:43], s55 offen offset:3072 sc1
    s_waitcnt vmcnt(0)
    v_bitop3_b32 v13, v99, v103, 2 bitop3:0x80
    v_bitop3_b32 v13, v107, v111, v13 bitop3:0x80
    v_bitop3_b32 v13, v115, v119, v13 bitop3:0x80
    v_bitop3_b32 v13, v123, v127, v13 bitop3:0x80
    v_cmp_eq_u32 vcc, 0, v13
    v_mul_f32 v32, v40, v96
    v_mul_f32 v36, v44, v112
    v_mul_f32 v33, v40, v97
    v_mul_f32 v37, v44, v113
    s_nop 0
    s_cbranch_vccz L_og243_ok0
    s_sleep 8
    s_sub_u32 s57, s57, 1
    s_cbranch_scc0 L_og243
L_og243_ok0:
    v_pk_mul_f32 v[34:35], v[40:41], v[98:99] op_sel_hi:[0,1]
    v_pk_mul_f32 v[38:39], v[44:45], v[114:115] op_sel_hi:[0,1]
    v_pk_fma_f32 v[32:33], v[40:41], v[100:101], v[32:33] op_sel:[1,0,0] op_sel_hi:[1,1,1]
    v_pk_fma_f32 v[34:35], v[40:41], v[102:103], v[34:35] op_sel:[1,0,0] op_sel_hi:[1,1,1]
    v_pk_fma_f32 v[36:37], v[44:45], v[116:117], v[36:37] op_sel:[1,0,0] op_sel_hi:[1,1,1]
    v_pk_fma_f32 v[38:39], v[44:45], v[118:119], v[38:39] op_sel:[1,0,0] op_sel_hi:[1,1,1]
    v_pk_fma_f32 v[32:33], v[42:43], v[104:105], v[32:33] op_sel_hi:[0,1,1]
    v_pk_fma_f32 v[34:35], v[42:43], v[106:107], v[34:35] op_sel_hi:[0,1,1]
    v_pk_fma_f32 v[36:37], v[46:47], v[120:121], v[36:37] op_sel_hi:[0,1,1]
    v_pk_fma_f32 v[38:39], v[46:47], v[122:123], v[38:39] op_sel_hi:[0,1,1]
    v_pk_fma_f32 v[32:33], v[42:43], v[108:109], v[32:33] op_sel:[1,0,0] op_sel_hi:[1,1,1]
    v_pk_fma_f32 v[34:35], v[42:43], v[110:111], v[34:35] op_sel:[1,0,0] op_sel_hi:[1,1,1]
    v_pk_fma_f32 v[36:37], v[46:47], v[124:125], v[36:37] op_sel:[1,0,0] op_sel_hi:[1,1,1]
    v_pk_fma_f32 v[38:39], v[46:47], v[126:127], v[38:39] op_sel:[1,0,0] op_sel_hi:[1,1,1]
    v_pk_add_f32 v[32:33], v[32:33], v[36:37]
    v_pk_add_f32 v[34:35], v[34:35], v[38:39]
    s_nop 1
    v_permlane32_swap_b32 v32, v34
    v_permlane32_swap_b32 v33, v35
    v_add_f32 v32, v32, v34
    v_add_f32 v33, v33, v35
    s_nop 1
    v_permlane16_swap_b32 v32, v33
    v_add_f32 v32, v32, v33
    v_cvt_pk_bf16_f32 v32, v32, v32
    ds_write_b16 v25, v32 offset:1856
    s_mov_b64 exec, 1
    ds_add_u32 v2, v3 offset:68
    s_mov_b64 exec, -1
    s_add_u32 s54, s54, 24576
    s_add_u32 s55, s55, 24576
L_bme216:
    s_waitcnt lgkmcnt(0)
    s_barrier
    s_endpgm
L_a3:
    s_cmp_lt_u32 s49, 10
    s_cbranch_scc0 L_exit
    v_and_b32 v7, 7, v0
    v_and_b32 v8, 6, v6
    v_xor_b32 v7, v7, v8
    v_lshlrev_b32 v7, 4, v7
    s_lshl_b32 s62, s49, 7
    s_mov_b32 s57, 524288
L_lw245:
    ds_read_b32 v13, v2 offset:72
    s_waitcnt lgkmcnt(0)
    v_readfirstlane_b32 s52, v13
    s_cmp_ge_u32 s52, 4
    s_cbranch_scc1 L_lwok245
    s_sub_u32 s57, s57, 1
    s_cbranch_scc1 L_lwok245
    s_sleep 2
    s_branch L_lw245
L_lwok245:
    v_lshrrev_b32 v8, 2, v0
    v_lshlrev_b32 v8, 7, v8
    v_and_b32 v9, 3, v0
    v_lshl_add_u32 v8, v9, 3, v8
    v_and_b32 v9, 3, v6
    v_xor_b32 v10, 0, v9
    v_lshl_add_u32 v16, v10, 5, v8
    v_xor_b32 v10, 1, v9
    v_lshl_add_u32 v17, v10, 5, v8
    v_xor_b32 v10, 2, v9
    v_lshl_add_u32 v18, v10, 5, v8
    v_xor_b32 v10, 3, v9
    v_lshl_add_u32 v19, v10, 5, v8
    v_and_b32 v9, 1, v0
    v_lshlrev_b32 v9, 11, v9
    v_lshrrev_b32 v10, 4, v0
    v_lshl_add_u32 v9, v10, 3, v9
    s_lshl_b32 s52, s48, 7
    v_add_u32 v9, s52, v9
    v_and_b32 v11, 32, v0
    v_lshl_add_u32 v10, v11, 6, v31
    v_add_u32 v10, s52, v10
    ds_read_b32 v61, v10 offset:4864
    s_mov_b32 s53, 0x3fb8aa3b
    s_waitcnt vmcnt(0) lgkmcnt(0)
    v_lshlrev_b32 v62, 16, v61
    v_lshlrev_b32 v64, 16, v180
    v_add_f32 v62, v62, v64
    v_cvt_pk_bf16_f32 v62, 0, v62
    v_mul_f32 v64, -|v62|, s53
    v_exp_f32 v64, v64
    s_nop 0
    v_cvt_pk_bf16_f32 v64, 0, v64
    v_add_f32 v65, 1.0, v64
    v_log_f32 v65, v65
    v_mov_b32 v66, 0x3eaaaaab
    v_fmac_f32 v66, 0xbe800000, v64
    v_mul_f32 v65, 0x3f317218, v65
    v_fma_f32 v66, v66, v64, -0.5
    v_fma_f32 v66, v66, v64, 1.0
    v_mul_f32 v66, v66, v64
    v_cmp_gt_f32 vcc, 0x3d000000, v64
    s_nop 1
    v_cndmask_b32 v65, v65, v66, vcc
    v_cvt_pk_bf16_f32 v65, 0, v65
    v_max_f32 v66, 0, v62
    v_add_f32 v65, v65, v66
    v_cvt_pk_bf16_f32 v65, 0, v65
    v_mul_f32 v64, 0xc038aa3b, v65
    v_exp_f32 v64, v64
    v_mul_f32 v67, v65, v65
    v_add_f32 v66, 1.0, v64
    v_rcp_f32 v66, v66
    v_sub_f32 v64, 1.0, v64
    v_mul_f32 v64, v64, v66
    v_mov_b32 v66, 0xbeaaaaab
    v_fmac_f32 v66, 0x3e088889, v67
    v_fma_f32 v66, v66, v67, 1.0
    v_mul_f32 v66, v66, v65
    v_cmp_gt_f32 vcc, 0x3d800000, v65
    s_nop 1
    v_cndmask_b32 v64, v64, v66, vcc
    v_cvt_pk_bf16_f32 v64, 0, v64
    v_mul_f32 v62, v62, v64
    v_and_b32 v63, 0xffff0000, v61
    v_and_b32 v64, 0xffff0000, v180
    v_add_f32 v63, v63, v64
    v_cvt_pk_bf16_f32 v63, 0, v63
    v_mul_f32 v64, -|v63|, s53
    v_exp_f32 v64, v64
    s_nop 0
    v_cvt_pk_bf16_f32 v64, 0, v64
    v_add_f32 v65, 1.0, v64
    v_log_f32 v65, v65
    v_mov_b32 v66, 0x3eaaaaab
    v_fmac_f32 v66, 0xbe800000, v64
    v_mul_f32 v65, 0x3f317218, v65
    v_fma_f32 v66, v66, v64, -0.5
    v_fma_f32 v66, v66, v64, 1.0
    v_mul_f32 v66, v66, v64
    v_cmp_gt_f32 vcc, 0x3d000000, v64
    s_nop 1
    v_cndmask_b32 v65, v65, v66, vcc
    v_cvt_pk_bf16_f32 v65, 0, v65
    v_max_f32 v66, 0, v63
    v_add_f32 v65, v65, v66
    v_cvt_pk_bf16_f32 v65, 0, v65
    v_mul_f32 v64, 0xc038aa3b, v65
    v_exp_f32 v64, v64
    v_mul_f32 v67, v65, v65
    v_add_f32 v66, 1.0, v64
    v_rcp_f32 v66, v66
    v_sub_f32 v64, 1.0, v64
    v_mul_f32 v64, v64, v66
    v_mov_b32 v66, 0xbeaaaaab
    v_fmac_f32 v66, 0x3e088889, v67
    v_fma_f32 v66, v66, v67, 1.0
    v_mul_f32 v66, v66, v65
    v_cmp_gt_f32 vcc, 0x3d800000, v65
    s_nop 1
    v_cndmask_b32 v64, v64, v66, vcc
    v_cvt_pk_bf16_f32 v64, 0, v64
    v_mul_f32 v63, v63, v64
    v_cvt_pk_bf16_f32 v61, v62, v63
    ds_write_b32 v10, v61 offset:4864
    ds_read_b64 v[48:49], v9 offset:4864
    ds_read_b64 v[50:51], v9 offset:4896
    ds_read_b64 v[52:53], v9 offset:4928
    ds_read_b64 v[54:55], v9 offset:4960
    ds_read_b64_tr_b16 v[56:57], v16 offset:9472
    ds_read_b64_tr_b16 v[58:59], v16 offset:11520
    ds_read_b64_tr_b16 v[60:61], v16 offset:13568
    ds_read_b64_tr_b16 v[62:63], v16 offset:15616
    s_waitcnt lgkmcnt(0)
    v_mfma_f32_16x16x32_bf16 v[128:131], v[48:51], v[56:59], 0
    v_mfma_f32_16x16x32_bf16 v[128:131], v[52:55], v[60:63], v[128:131]
    s_nop 3
    ds_read_b64_tr_b16 v[56:57], v17 offset:9472
    ds_read_b64_tr_b16 v[58:59], v17 offset:11520
    ds_read_b64_tr_b16 v[60:61], v17 offset:13568
    ds_read_b64_tr_b16 v[62:63], v17 offset:15616
    s_waitcnt lgkmcnt(0)
    v_mfma_f32_16x16x32_bf16 v[132:135], v[48:51], v[56:59], 0
    v_mfma_f32_16x16x32_bf16 v[132:135], v[52:55], v[60:63], v[132:135]
    s_nop 3
    ds_read_b64_tr_b16 v[56:57], v18 offset:9472
    ds_read_b64_tr_b16 v[58:59], v18 offset:11520
    ds_read_b64_tr_b16 v[60:61], v18 offset:13568
    ds_read_b64_tr_b16 v[62:63], v18 offset:15616
    s_waitcnt lgkmcnt(0)
    v_mfma_f32_16x16x32_bf16 v[136:139], v[48:51], v[56:59], 0
    v_mfma_f32_16x16x32_bf16 v[136:139], v[52:55], v[60:63], v[136:139]
    s_nop 3
    ds_read_b64_tr_b16 v[56:57], v19 offset:9472
    ds_read_b64_tr_b16 v[58:59], v19 offset:11520
    ds_read_b64_tr_b16 v[60:61], v19 offset:13568
    ds_read_b64_tr_b16 v[62:63], v19 offset:15616
    s_waitcnt lgkmcnt(0)
    v_mfma_f32_16x16x32_bf16 v[140:143], v[48:51], v[56:59], 0
    v_mfma_f32_16x16x32_bf16 v[140:143], v[52:55], v[60:63], v[140:143]
    s_nop 3
    s_and_b32 s64, s50, 0xff
    s_bfe_u32 s65, s50, 0x80008
    s_mov_b32 s52, 0xffffff00
    v_mov_b32 v4, s64
    v_mov_b32 v5, s65
    v_lshlrev_b32 v9, 3, v0
    s_nop 3
    s_mov_b64 exec, 0xffff
    v_add_u32 v128, 0x80, v128
    v_and_or_b32 v128, v128, s52, v4
    v_add_u32 v129, 0x80, v129
    v_and_or_b32 v129, v129, s52, v5
    ds_write_b64 v9, v[128:129] offset:512
    v_add_u32 v132, 0x80, v132
    v_and_or_b32 v132, v132, s52, v4
    v_add_u32 v133, 0x80, v133
    v_and_or_b32 v133, v133, s52, v5
    ds_write_b64 v9, v[132:133] offset:640
    v_add_u32 v136, 0x80, v136
    v_and_or_b32 v136, v136, s52, v4
    v_add_u32 v137, 0x80, v137
    v_and_or_b32 v137, v137, s52, v5
    ds_write_b64 v9, v[136:137] offset:768
    v_add_u32 v140, 0x80, v140
    v_and_or_b32 v140, v140, s52, v4
    v_add_u32 v141, 0x80, v141
    v_and_or_b32 v141, v141, s52, v5
    ds_write_b64 v9, v[140:141] offset:896
    s_mov_b64 exec, -1
    s_cmp_eq_u32 s48, 0
    s_cbranch_scc0 L_nogate
    v_mov_b32 v40, 0
    v_mov_b32 v41, 0
    v_lshlrev_b32 v43, 16, v170
    v_and_b32 v44, 0xffff0000, v170
    v_lshlrev_b32 v45, 16, v160
    v_and_b32 v46, 0xffff0000, v160
    v_mul_f32 v45, v45, v43
    v_mul_f32 v46, v46, v44
    v_cvt_pk_bf16_f32 v45, 0, v45
    v_cvt_pk_bf16_f32 v46, 0, v46
    v_add_f32 v40, v40, v45
    v_add_f32 v41, v41, v46
    v_lshlrev_b32 v43, 16, v171
    v_and_b32 v44, 0xffff0000, v171
    v_lshlrev_b32 v45, 16, v161
    v_and_b32 v46, 0xffff0000, v161
    v_mul_f32 v45, v45, v43
    v_mul_f32 v46, v46, v44
    v_cvt_pk_bf16_f32 v45, 0, v45
    v_cvt_pk_bf16_f32 v46, 0, v46
    v_add_f32 v40, v40, v45
    v_add_f32 v41, v41, v46
    v_lshlrev_b32 v43, 16, v172
    v_and_b32 v44, 0xffff0000, v172
    v_lshlrev_b32 v45, 16, v162
    v_and_b32 v46, 0xffff0000, v162
    v_mul_f32 v45, v45, v43
    v_mul_f32 v46, v46, v44
    v_cvt_pk_bf16_f32 v45, 0, v45
    v_cvt_pk_bf16_f32 v46, 0, v46
    v_add_f32 v40, v40, v45
    v_add_f32 v41, v41, v46
    v_lshlrev_b32 v43, 16, v173
    v_and_b32 v44, 0xffff0000, v173
    v_lshlrev_b32 v45, 16, v163
    v_and_b32 v46, 0xffff0000, v163
    v_mul_f32 v45, v45, v43
    v_mul_f32 v46, v46, v44
    v_cvt_pk_bf16_f32 v45, 0, v45
    v_cvt_pk_bf16_f32 v46, 0, v46
    v_add_f32 v40, v40, v45
    v_add_f32 v41, v41, v46
    v_lshlrev_b32 v43, 16, v174
    v_and_b32 v44, 0xffff0000, v174
    v_lshlrev_b32 v45, 16, v164
    v_and_b32 v46, 0xffff0000, v164
    v_mul_f32 v45, v45, v43
    v_mul_f32 v46, v46, v44
    v_cvt_pk_bf16_f32 v45, 0, v45
    v_cvt_pk_bf16_f32 v46, 0, v46
    v_add_f32 v40, v40, v45
    v_add_f32 v41, v41, v46
    v_lshlrev_b32 v43, 16, v175
    v_and_b32 v44, 0xffff0000, v175
    v_lshlrev_b32 v45, 16, v165
    v_and_b32 v46, 0xffff0000, v165
    v_mul_f32 v45, v45, v43
    v_mul_f32 v46, v46, v44
    v_cvt_pk_bf16_f32 v45, 0, v45
    v_cvt_pk_bf16_f32 v46, 0, v46
    v_add_f32 v40, v40, v45
    v_add_f32 v41, v41, v46
    v_lshlrev_b32 v43, 16, v176
    v_and_b32 v44, 0xffff0000, v176
    v_lshlrev_b32 v45, 16, v166
    v_and_b32 v46, 0xffff0000, v166
    v_mul_f32 v45, v45, v43
    v_mul_f32 v46, v46, v44
    v_cvt_pk_bf16_f32 v45, 0, v45
    v_cvt_pk_bf16_f32 v46, 0, v46
    v_add_f32 v40, v40, v45
    v_add_f32 v41, v41, v46
    v_lshlrev_b32 v43, 16, v177
    v_and_b32 v44, 0xffff0000, v177
    v_lshlrev_b32 v45, 16, v167
    v_and_b32 v46, 0xffff0000, v167
    v_mul_f32 v45, v45, v43
    v_mul_f32 v46, v46, v44
    v_cvt_pk_bf16_f32 v45, 0, v45
    v_cvt_pk_bf16_f32 v46, 0, v46
    v_add_f32 v40, v40, v45
    v_add_f32 v41, v41, v46
    v_lshlrev_b32 v43, 16, v178
    v_and_b32 v44, 0xffff0000, v178
    v_lshlrev_b32 v45, 16, v168
    v_and_b32 v46, 0xffff0000, v168
    v_mul_f32 v45, v45, v43
    v_mul_f32 v46, v46, v44
    v_cvt_pk_bf16_f32 v45, 0, v45
    v_cvt_pk_bf16_f32 v46, 0, v46
    v_add_f32 v40, v40, v45
    v_add_f32 v41, v41, v46
    v_lshlrev_b32 v43, 16, v179
    v_and_b32 v44, 0xffff0000, v179
    v_lshlrev_b32 v45, 16, v169
    v_and_b32 v46, 0xffff0000, v169
    v_mul_f32 v45, v45, v43
    v_mul_f32 v46, v46, v44
    v_cvt_pk_bf16_f32 v45, 0, v45
    v_cvt_pk_bf16_f32 v46, 0, v46
    v_add_f32 v40, v40, v45
    v_add_f32 v41, v41, v46
    v_add_f32 v40, v40, v41
    s_nop 1
    v_add_f32_dpp v40, v40, v40 row_ror:1 row_mask:0xf bank_mask:0xf
    s_nop 1
    v_add_f32_dpp v40, v40, v40 row_ror:2 row_mask:0xf bank_mask:0xf
    s_nop 1
    v_add_f32_dpp v40, v40, v40 row_ror:4 row_mask:0xf bank_mask:0xf
    s_nop 1
    v_add_f32_dpp v40, v40, v40 row_ror:8 row_mask:0xf bank_mask:0xf
    v_mov_b32 v41, v40
    s_nop 1
    v_permlane16_swap_b32 v41, v40
    s_nop 1
    v_add_f32 v40, v40, v41
    v_cvt_pk_bf16_f32 v40, 0, v40
    v_mul_f32 v40, 0xbfb8aa3b, v40
    v_exp_f32 v40, v40
    s_nop 0
    v_add_f32 v40, 1.0, v40
    v_rcp_f32 v40, v40
    s_nop 0
    v_cvt_pk_bf16_f32 v40, 0, v40
    v_sub_f32 v41, 1.0, v40
    v_cvt_pk_bf16_f32 v41, 0, v41
    s_mov_b32 s60, 0xffff0000
    s_mov_b32 s61, 0xffff0000
    v_cndmask_b32 v42, v40, v41, s[60:61]
L_nogate:
    s_lshl3_add_u32 s53, s49, s30
    s_mul_i32 s87, s53, 3072
    s_add_u32 s87, s87, 524288
    s_lshl_b32 s88, s53, 4
    v_lshrrev_b32 v8, 5, v0
    v_mul_u32_u24 v8, 1280, v8
    v_and_b32 v9, 7, v0
    v_lshl_add_u32 v8, v9, 1, v8
    v_mov_b32 v43, 0xffffff00
    s_mov_b32 s32, s24
    s_mov_b32 s33, s25
    s_mov_b32 s34, 2560
    s_mov_b32 s35, 0x20000
    s_mov_b32 s44, s12
    s_mov_b32 s45, s13
    s_mov_b32 s46, 7864320
    s_mov_b32 s47, 0x20000
    v_mul_u32_u24 v6, 10240, v6
    v_add_u32 v6, v6, v7
    s_mul_i32 s55, s48, 81920
    s_add_u32 s55, s55, s62
    s_add_u32 s90, s30, 0
    s_and_b32 s90, s90, 7
    s_mul_i32 s90, s90, 245760
    s_add_u32 s90, s90, s55
    s_add_u32 s91, s30, 1
    s_and_b32 s91, s91, 7
    s_add_u32 s91, s91, 8
    s_mul_i32 s91, s91, 245760
    s_add_u32 s91, s91, s55
    s_add_u32 s92, s30, 2
    s_and_b32 s92, s92, 7
    s_add_u32 s92, s92, 16
    s_mul_i32 s92, s92, 245760
    s_add_u32 s92, s92, s55
    s_add_u32 s93, s30, 3
    s_and_b32 s93, s93, 7
    s_add_u32 s93, s93, 24
    s_mul_i32 s93, s93, 245760
    s_add_u32 s93, s93, s55
    v_mov_b32 v14, 2
    s_mov_b32 s57, 524288
L_lw246:
    ds_read_b32 v13, v2 offset:64
    s_waitcnt lgkmcnt(0)
    v_readfirstlane_b32 s52, v13
    s_cmp_ge_u32 s52, 4
    s_cbranch_scc1 L_lwok246
    s_sub_u32 s57, s57, 1
    s_cbranch_scc1 L_lwok246
    s_sleep 2
    s_branch L_lw246
L_lwok246:
    s_mov_b32 m0, 54528
    s_add_u32 s54, s91, 5120
    buffer_load_dwordx4 v6, s[44:47], s54 offen nt lds
    s_mov_b32 m0, 55552
    s_add_u32 s54, s91, 6400
    buffer_load_dwordx4 v6, s[44:47], s54 offen nt lds
    s_mov_b32 m0, 56576
    s_add_u32 s54, s91, 7680
    buffer_load_dwordx4 v6, s[44:47], s54 offen nt lds
    s_mov_b32 m0, 57600
    s_add_u32 s54, s91, 8960
    buffer_load_dwordx4 v6, s[44:47], s54 offen nt lds
    s_mov_b32 m0, 58624
    s_add_u32 s54, s92, 0
    buffer_load_dwordx4 v6, s[44:47], s54 offen nt lds
    s_mov_b32 m0, 59648
    s_add_u32 s54, s92, 1280
    buffer_load_dwordx4 v6, s[44:47], s54 offen nt lds
    s_mov_b32 m0, 60672
    s_add_u32 s54, s92, 2560
    buffer_load_dwordx4 v6, s[44:47], s54 offen nt lds
    s_mov_b32 m0, 61696
    s_add_u32 s54, s92, 3840
    buffer_load_dwordx4 v6, s[44:47], s54 offen nt lds
    s_mov_b32 m0, 62720
    s_add_u32 s54, s92, 5120
    buffer_load_dwordx4 v6, s[44:47], s54 offen nt lds
    s_mov_b32 m0, 63744
    s_add_u32 s54, s92, 6400
    buffer_load_dwordx4 v6, s[44:47], s54 offen nt lds
    s_mov_b32 m0, 64768
    s_add_u32 s54, s92, 7680
    buffer_load_dwordx4 v6, s[44:47], s54 offen nt lds
    s_mov_b32 m0, 65792
    s_add_u32 s54, s92, 8960
    buffer_load_dwordx4 v6, s[44:47], s54 offen nt lds
    s_mov_b32 m0, 66816
    s_add_u32 s54, s93, 0
    buffer_load_dwordx4 v6, s[44:47], s54 offen nt lds
    s_mov_b32 m0, 67840
    s_add_u32 s54, s93, 1280
    buffer_load_dwordx4 v6, s[44:47], s54 offen nt lds
    s_mov_b32 m0, 68864
    s_add_u32 s54, s93, 2560
    buffer_load_dwordx4 v6, s[44:47], s54 offen nt lds
    s_mov_b32 m0, 69888
    s_add_u32 s54, s93, 3840
    buffer_load_dwordx4 v6, s[44:47], s54 offen nt lds
    s_mov_b32 m0, 70912
    s_add_u32 s54, s93, 5120
    buffer_load_dwordx4 v6, s[44:47], s54 offen nt lds
    s_mov_b32 m0, 71936
    s_add_u32 s54, s93, 6400
    buffer_load_dwordx4 v6, s[44:47], s54 offen nt lds
    s_mov_b32 m0, 72960
    s_add_u32 s54, s93, 7680
    buffer_load_dwordx4 v6, s[44:47], s54 offen nt lds
    s_mov_b32 m0, 73984
    s_add_u32 s54, s93, 8960
    buffer_load_dwordx4 v6, s[44:47], s54 offen nt lds
    s_waitcnt vmcnt(16)
    ds_write_b32 v2, v3 offset:28
    s_waitcnt vmcnt(0)
    ds_write_b32 v2, v14 offset:28
    s_mov_b32 s57, 65536
    s_cmp_eq_u32 s48, 0
    s_barrier
    s_cbranch_scc1 L_cons
    s_endpgm
L_cons:
    s_mov_b32 s57, 524288
L_lw247:
    ds_read_b32 v13, v2 offset:64
    s_waitcnt lgkmcnt(0)
    v_readfirstlane_b32 s52, v13
    s_cmp_ge_u32 s52, 8
    s_cbranch_scc1 L_lwok247
    s_sub_u32 s57, s57, 1
    s_cbranch_scc1 L_lwok247
    s_branch L_lw247
L_lwok247:
    s_mov_b32 s57, 65536
    buffer_load_dwordx4 v[104:107], v12, s[40:43], s87 offen offset:0 sc1
    buffer_load_dwordx4 v[108:111], v12, s[40:43], s87 offen offset:1024 sc1
    buffer_load_dwordx4 v[112:115], v12, s[40:43], s87 offen offset:2048 sc1
L_yp:
    buffer_load_dwordx4 v[116:119], v12, s[40:43], s87 offen offset:0 sc1
    buffer_load_dwordx4 v[120:123], v12, s[40:43], s87 offen offset:1024 sc1
    buffer_load_dwordx4 v[124:127], v12, s[40:43], s87 offen offset:2048 sc1
    s_waitcnt vmcnt(3)
    v_xor_b32 v14, s64, v106
    v_bitop3_b32 v14, v110, s64, v14 bitop3:0xbe
    v_bitop3_b32 v14, v114, s64, v14 bitop3:0xbe
    v_bitop3_b32 v14, v107, s65, v14 bitop3:0xbe
    v_bitop3_b32 v14, v111, s65, v14 bitop3:0xbe
    v_bitop3_b32 v14, v115, s65, v14 bitop3:0xbe
    v_and_b32 v14, 0xff, v14
    v_cmp_ne_u32 vcc, 0, v14
    v_and_b32 v106, v43, v106
    v_and_b32 v107, v43, v107
    v_and_b32 v110, v43, v110
    v_and_b32 v111, v43, v111
    v_and_b32 v114, v43, v114
    v_and_b32 v115, v43, v115
    v_pk_add_f32 v[96:97], v[104:105], v[108:109]
    v_pk_add_f32 v[98:99], v[106:107], v[110:111]
    v_pk_add_f32 v[96:97], v[96:97], v[112:113]
    v_pk_add_f32 v[98:99], v[98:99], v[114:115]
    s_cbranch_vccz L_ypok
    buffer_load_dwordx4 v[104:107], v12, s[40:43], s87 offen offset:0 sc1
    buffer_load_dwordx4 v[108:111], v12, s[40:43], s87 offen offset:1024 sc1
    buffer_load_dwordx4 v[112:115], v12, s[40:43], s87 offen offset:2048 sc1
    s_waitcnt vmcnt(3)
    v_xor_b32 v14, s64, v118
    v_bitop3_b32 v14, v122, s64, v14 bitop3:0xbe
    v_bitop3_b32 v14, v126, s64, v14 bitop3:0xbe
    v_bitop3_b32 v14, v119, s65, v14 bitop3:0xbe
    v_bitop3_b32 v14, v123, s65, v14 bitop3:0xbe
    v_bitop3_b32 v14, v127, s65, v14 bitop3:0xbe
    v_and_b32 v14, 0xff, v14
    v_cmp_ne_u32 vcc, 0, v14
    v_and_b32 v118, v43, v118
    v_and_b32 v119, v43, v119
    v_and_b32 v122, v43, v122
    v_and_b32 v123, v43, v123
    v_and_b32 v126, v43, v126
    v_and_b32 v127, v43, v127
    v_pk_add_f32 v[96:97], v[116:117], v[120:121]
    v_pk_add_f32 v[98:99], v[118:119], v[122:123]
    v_pk_add_f32 v[96:97], v[96:97], v[124:125]
    v_pk_add_f32 v[98:99], v[98:99], v[126:127]
    s_cbranch_vccz L_ypok
    s_sub_u32 s57, s57, 1
    s_cbranch_scc0 L_yp
L_ypok:
    s_nop 0
    v_permlane32_swap_b32 v96, v97
    v_permlane32_swap_b32 v98, v99
    v_add_f32 v96, v96, v97
    v_add_f32 v98, v98, v99
    s_nop 1
    v_permlane16_swap_b32 v96, v98
    v_add_f32 v96, v96, v98
    s_nop 1
    v_add_f32_dpp v96, v96, v96 row_ror:8 row_mask:0xf bank_mask:0xf
    v_cvt_pk_bf16_f32 v96, 0, v96
    v_mul_f32 v96, v42, v96
    v_cvt_pk_bf16_f32 v97, 0, v96
    v_cvt_pk_bf16_f32 v96, 0, v96
    s_nop 1
    v_permlane16_swap_b32 v97, v96
    v_add_f32 v96, v96, v97
    v_cvt_pk_bf16_f32 v96, v96, v96
    s_mov_b32 exec_lo, 0xff
    s_mov_b32 exec_hi, 0xff
    buffer_store_short v96, v8, s[32:35], s88 offen
    s_or_b32 s53, s49, s30
    s_cbranch_scc1 L_noep
    s_mov_b64 exec, 1
    v_mov_b32 v2, 0
    v_mov_b32 v3, s50
    buffer_store_dword v3, v2, s[40:43], 0 offen
L_noep:
L_exit:
    s_endpgm
L_str:
    s_barrier
    v_lshrrev_b32 v1, 3, v0
    v_mul_u32_u24 v1, 384, v1
    v_lshlrev_b32 v253, 4, v253
    s_mul_i32 s52, s31, 12288
    v_add3_u32 v1, v1, v253, s52
    v_and_b32 v0, 63, v0
    v_cmp_eq_u32 vcc, 1, v0
    v_lshlrev_b32 v12, 2, v0
    v_mov_b32 v2, 0
    v_mov_b32 v3, 1
    v_cndmask_b32 v14, 0, 5, vcc
    s_mov_b32 s32, s6
    s_mov_b32 s33, s7
    s_mov_b32 s34, 100663296
    s_mov_b32 s35, 0x20000
    s_mov_b32 s40, s28
    s_mov_b32 s41, s29
    s_mov_b32 s42, 402653184
    s_mov_b32 s43, 0x20000
    s_add_u32 s86, s30, 0
    s_and_b32 s86, s86, 7
    s_mul_i32 s86, s86, 1572864
    s_add_u32 s87, s30, 1
    s_and_b32 s87, s87, 7
    s_add_u32 s87, s87, 8
    s_mul_i32 s87, s87, 1572864
    s_add_u32 s88, s30, 2
    s_and_b32 s88, s88, 7
    s_add_u32 s88, s88, 16
    s_mul_i32 s88, s88, 1572864
    s_add_u32 s89, s30, 3
    s_and_b32 s89, s89, 7
    s_add_u32 s89, s89, 24
    s_mul_i32 s89, s89, 1572864
    s_add_u32 s56, s89, 50331648
    s_add_u32 s48, s31, 30
    s_and_b32 s48, s48, 31
    s_mul_i32 s49, s48, 43
    s_lshr_b32 s49, s49, 7
    s_mul_i32 s52, s49, 3
    s_sub_u32 s48, s48, s52
    v_mul_u32_u24 v11, 1280, v6
    v_add_u32 v11, v11, v7
    s_mul_i32 s53, s30, 3
    s_add_u32 s53, s53, s48
    s_lshl2_add_u32 s53, s53, s3
    s_mul_i32 s53, s53, 20480
    s_lshl_b32 s52, s49, 7
    s_add_u32 s65, s53, s52
    v_mul_u32_u24 v13, 10240, v6
    v_add_u32 v13, v13, v7
    s_mul_i32 s58, s48, 81920
    s_add_u32 s58, s58, s52
    s_mul_i32 s52, s3, 1280
    s_add_u32 s58, s58, s52
    s_mov_b32 s36, s20
    s_mov_b32 s37, s21
    s_mov_b32 s38, 1966080
    s_mov_b32 s39, 0x20000
    s_cmp_lt_u32 s49, 10
    s_cselect_b32 s38, s38, 0
    s_lshl_b32 s52, s3, 2
    v_mov_b32 v4, s52
    v_mov_b32 v28, 0
    v_mov_b32 v29, 0
    v_mov_b32 v30, 0
    v_mov_b32 v31, 0
    v_mov_b32 v32, 0
    v_mov_b32 v33, 0
    v_mov_b32 v34, 0
    v_mov_b32 v35, 0
    v_mov_b32 v36, 0
    v_mov_b32 v37, 0
    v_mov_b32 v38, 0
    v_mov_b32 v39, 0
    v_mov_b32 v40, 0
    v_mov_b32 v41, 0
    v_mov_b32 v42, 0
    v_mov_b32 v43, 0
    v_mov_b32 v44, 0
    v_mov_b32 v45, 0
    v_mov_b32 v46, 0
    v_mov_b32 v47, 0
    v_mov_b32 v48, 0
    v_mov_b32 v49, 0
    v_mov_b32 v50, 0
    v_mov_b32 v51, 0
    v_mov_b32 v52, 0
    v_mov_b32 v53, 0
    v_mov_b32 v54, 0
    v_mov_b32 v55, 0
    v_mov_b32 v56, 0
    v_mov_b32 v57, 0
    v_mov_b32 v58, 0
    v_mov_b32 v59, 0
    v_mov_b32 v252, 0x3fb8aa3b
    s_mul_i32 s52, s3, 768
    v_lshl_add_u32 v254, v0, 2, s52
    s_mov_b32 s69, 0
    s_mov_b32 s68, 5
    s_waitcnt vmcnt(9)
    s_waitcnt vmcnt(8)
    s_waitcnt vmcnt(7)
    s_lshl_b32 m0, s3, 11
    s_add_u32 m0, m0, 9472
    s_add_u32 s55, s65, 0
    buffer_load_dwordx4 v11, s[36:39], s55 offen nt lds
    s_waitcnt vmcnt(7)
    s_lshl_b32 m0, s3, 11
    s_add_u32 m0, m0, 10496
    s_add_u32 s55, s65, 10240
    buffer_load_dwordx4 v11, s[36:39], s55 offen nt lds
    s_mov_b32 s36, s8
    s_mov_b32 s37, s9
    s_mov_b32 s38, 100663296
    s_mov_b32 s39, 0x20000
    s_waitcnt vmcnt(7)
    s_mov_b32 s44, s12
    s_mov_b32 s45, s13
    s_mov_b32 s46, 7864320
    s_mov_b32 s47, 0x20000
    s_cmp_lt_u32 s49, 10
    s_cselect_b32 s46, s46, 0
    s_lshl_b32 m0, s3, 10
    s_add_u32 m0, m0, 42240
    s_mul_i32 s55, s86, 5
    s_lshr_b32 s55, s55, 5
    s_add_u32 s55, s55, s58
    buffer_load_dwordx4 v13, s[44:47], s55 offen nt lds
    s_waitcnt vmcnt(7)
    s_lshl_b32 m0, s3, 10
    s_add_u32 m0, m0, 46336
    s_mul_i32 s55, s86, 5
    s_lshr_b32 s55, s55, 5
    s_add_u32 s55, s55, s58
    s_add_u32 s55, s55, 5120
    buffer_load_dwordx4 v13, s[44:47], s55 offen nt lds
    s_waitcnt vmcnt(7)
    s_lshl_b32 m0, s3, 10
    s_add_u32 m0, m0, 50432
    s_mul_i32 s55, s87, 5
    s_lshr_b32 s55, s55, 5
    s_add_u32 s55, s55, s58
    buffer_load_dwordx4 v13, s[44:47], s55 offen nt lds
    s_waitcnt vmcnt(7)
    buffer_load_dwordx4 v[84:87], v1, s[32:35], s56 offen offset:0 nt
    s_waitcnt vmcnt(7)
    buffer_load_dwordx4 v[88:91], v1, s[32:35], s56 offen offset:128 nt
    s_waitcnt vmcnt(7)
    buffer_load_dwordx4 v[92:95], v1, s[32:35], s56 offen offset:256 nt
    s_add_u32 s56, s89, 50724864
    ds_write_b32 v4, v3 offset:80
    s_waitcnt vmcnt(7)
    s_waitcnt vmcnt(6)
    buffer_load_dwordx4 v[96:99], v1, s[32:35], s56 offen offset:0 nt
    s_waitcnt vmcnt(6)
    buffer_load_dwordx4 v[100:103], v1, s[32:35], s56 offen offset:128 nt
    s_waitcnt vmcnt(6)
    buffer_load_dwordx4 v[104:107], v1, s[32:35], s56 offen offset:256 nt
    s_add_u32 s56, s89, 51118080
    s_waitcnt vmcnt(6)
    buffer_load_dwordx4 v[108:111], v1, s[32:35], s56 offen offset:0 nt
    s_mov_b64 exec, 1
    ds_add_u32 v2, v3 offset:72
    s_mov_b64 exec, -1
    s_waitcnt vmcnt(6)
    buffer_load_dwordx4 v[112:115], v1, s[32:35], s56 offen offset:128 nt
    s_waitcnt vmcnt(6)
    s_waitcnt vmcnt(5)
    buffer_load_dwordx4 v[116:119], v1, s[32:35], s56 offen offset:256 nt
    s_add_u32 s56, s89, 51511296
    s_waitcnt vmcnt(5)
    buffer_load_dwordx4 v[120:123], v1, s[32:35], s56 offen offset:0 nt
    s_waitcnt vmcnt(5)
    buffer_load_dwordx4 v[124:127], v1, s[32:35], s56 offen offset:128 nt
    s_waitcnt vmcnt(5)
    buffer_load_dwordx4 v[128:131], v1, s[32:35], s56 offen offset:256 nt
    s_add_u32 s56, s88, 50331648
    s_waitcnt vmcnt(5)
    buffer_load_dwordx4 v[132:135], v1, s[32:35], s56 offen offset:0 nt
    s_waitcnt vmcnt(5)
    buffer_load_dwordx4 v[136:139], v1, s[32:35], s56 offen offset:128 nt
    s_waitcnt vmcnt(5)
    buffer_load_dwordx4 v[140:143], v1, s[32:35], s56 offen offset:256 nt
    s_add_u32 s56, s88, 50724864
    s_waitcnt vmcnt(5)
    buffer_load_dwordx4 v[144:147], v1, s[32:35], s56 offen offset:0 nt
    s_waitcnt vmcnt(5)
    buffer_load_dwordx4 v[148:151], v1, s[32:35], s56 offen offset:128 nt
    s_waitcnt vmcnt(5)
    buffer_load_dwordx4 v[152:155], v1, s[32:35], s56 offen offset:256 nt
    s_add_u32 s56, s88, 51118080
    s_waitcnt vmcnt(5)
    buffer_load_dwordx4 v[156:159], v1, s[32:35], s56 offen offset:0 nt
    s_waitcnt vmcnt(5)
    buffer_load_dwordx4 v[160:163], v1, s[32:35], s56 offen offset:128 nt
    s_waitcnt vmcnt(5)
    buffer_load_dwordx4 v[164:167], v1, s[32:35], s56 offen offset:256 nt
    s_add_u32 s56, s88, 51511296
    s_waitcnt vmcnt(5)
    buffer_load_dwordx4 v[168:171], v1, s[32:35], s56 offen offset:0 nt
    s_waitcnt vmcnt(5)
    buffer_load_dwordx4 v[172:175], v1, s[32:35], s56 offen offset:128 nt
    s_waitcnt vmcnt(5)
    buffer_load_dwordx4 v[176:179], v1, s[32:35], s56 offen offset:256 nt
    s_add_u32 s56, s87, 50331648
    s_waitcnt vmcnt(5)
    buffer_load_dwordx4 v[180:183], v1, s[32:35], s56 offen offset:0 nt
    s_waitcnt vmcnt(5)
    buffer_load_dwordx4 v[184:187], v1, s[32:35], s56 offen offset:128 nt
    s_waitcnt vmcnt(5)
    buffer_load_dwordx4 v[188:191], v1, s[32:35], s56 offen offset:256 nt
    s_add_u32 s56, s87, 50724864
    s_waitcnt vmcnt(5)
    buffer_load_dwordx4 v[192:195], v1, s[32:35], s56 offen offset:0 nt
    s_waitcnt vmcnt(5)
    buffer_load_dwordx4 v[196:199], v1, s[32:35], s56 offen offset:128 nt
    s_waitcnt vmcnt(5)
    buffer_load_dwordx4 v[200:203], v1, s[32:35], s56 offen offset:256 nt
    s_add_u32 s56, s87, 51118080
    s_waitcnt vmcnt(5)
    buffer_load_dwordx4 v[204:207], v1, s[32:35], s56 offen offset:0 nt
    s_waitcnt vmcnt(5)
    buffer_load_dwordx4 v[208:211], v1, s[32:35], s56 offen offset:128 nt
    s_waitcnt vmcnt(5)
    buffer_load_dwordx4 v[212:215], v1, s[32:35], s56 offen offset:256 nt
    s_add_u32 s56, s87, 51511296
    s_waitcnt vmcnt(5)
    buffer_load_dwordx4 v[216:219], v1, s[32:35], s56 offen offset:0 nt
    s_waitcnt vmcnt(5)
    buffer_load_dwordx4 v[220:223], v1, s[32:35], s56 offen offset:128 nt
    s_waitcnt vmcnt(5)
    buffer_load_dwordx4 v[224:227], v1, s[32:35], s56 offen offset:256 nt
    s_add_u32 s56, s86, 50331648
    s_waitcnt vmcnt(5)
    buffer_load_dwordx4 v[228:231], v1, s[32:35], s56 offen offset:0 nt
    s_waitcnt vmcnt(5)
    buffer_load_dwordx4 v[232:235], v1, s[32:35], s56 offen offset:128 nt
    s_waitcnt vmcnt(5)
    buffer_load_dwordx4 v[236:239], v1, s[32:35], s56 offen offset:256 nt
    s_add_u32 s56, s86, 50724864
    s_mov_b64 exec, 1
    ds_add_u32 v2, v3 offset:0
    s_mov_b64 exec, -1
    s_waitcnt vmcnt(5)
    buffer_load_dwordx4 v[240:243], v1, s[32:35], s56 offen offset:0 nt
    s_waitcnt vmcnt(5)
    buffer_load_dwordx4 v[244:247], v1, s[32:35], s56 offen offset:128 nt
    s_mov_b32 s57, 524288
L_lw1:
    ds_read_b32 v6, v2 offset:12
    s_waitcnt lgkmcnt(0)
    v_readfirstlane_b32 s67, v6
    s_cmp_ge_u32 s67, 1024
    s_cbranch_scc1 L_lwok1
    s_sub_u32 s57, s57, 1
    s_cbranch_scc1 L_lwok1
    s_sleep 1
    s_branch L_lw1
L_lwok1:
    s_and_b32 s67, s67, 0xff
    ds_read_b128 v[16:19], v253 offset:6528
    ds_read_b128 v[20:23], v253 offset:6656
    ds_read_b128 v[24:27], v253 offset:6784
    s_waitcnt lgkmcnt(0)
    v_dot2c_f32_bf16 v56, v84, v16
    v_dot2c_f32_bf16 v56, v85, v17
    v_dot2c_f32_bf16 v56, v86, v18
    v_dot2c_f32_bf16 v56, v87, v19
    v_dot2c_f32_bf16 v56, v88, v20
    v_dot2c_f32_bf16 v56, v89, v21
    v_dot2c_f32_bf16 v56, v90, v22
    v_dot2c_f32_bf16 v56, v91, v23
    v_dot2c_f32_bf16 v56, v92, v24
    v_dot2c_f32_bf16 v56, v93, v25
    v_dot2c_f32_bf16 v56, v94, v26
    v_dot2c_f32_bf16 v56, v95, v27
    s_nop 2
    v_add_f32_dpp v56, v56, v56 quad_perm:[1,0,3,2] row_mask:0xf bank_mask:0xf
    s_nop 1
    v_add_f32_dpp v56, v56, v56 quad_perm:[2,3,0,1] row_mask:0xf bank_mask:0xf
    s_nop 1
    v_add_f32_dpp v56, v56, v56 row_half_mirror row_mask:0xf bank_mask:0xf
    v_cvt_pk_bf16_f32 v56, 0, v56
    v_mul_f32 v56, 0x3d93cd3a, v56
    v_cvt_pk_bf16_f32 v56, 0, v56
    s_waitcnt vmcnt(5)
    buffer_load_dwordx4 v[248:251], v1, s[32:35], s56 offen offset:256 nt
    s_add_u32 s56, s86, 51118080
    ds_read_b32 v5, v2 offset:4
    v_dot2c_f32_bf16 v57, v96, v16
    v_dot2c_f32_bf16 v57, v97, v17
    v_dot2c_f32_bf16 v57, v98, v18
    v_dot2c_f32_bf16 v57, v99, v19
    v_dot2c_f32_bf16 v57, v100, v20
    v_dot2c_f32_bf16 v57, v101, v21
    v_dot2c_f32_bf16 v57, v102, v22
    v_dot2c_f32_bf16 v57, v103, v23
    v_dot2c_f32_bf16 v57, v104, v24
    v_dot2c_f32_bf16 v57, v105, v25
    v_dot2c_f32_bf16 v57, v106, v26
    v_dot2c_f32_bf16 v57, v107, v27
    s_nop 2
    v_add_f32_dpp v57, v57, v57 quad_perm:[1,0,3,2] row_mask:0xf bank_mask:0xf
    s_nop 1
    v_add_f32_dpp v57, v57, v57 quad_perm:[2,3,0,1] row_mask:0xf bank_mask:0xf
    s_nop 1
    v_add_f32_dpp v57, v57, v57 row_half_mirror row_mask:0xf bank_mask:0xf
    v_cvt_pk_bf16_f32 v57, 0, v57
    v_mul_f32 v57, 0x3d93cd3a, v57
    v_cvt_pk_bf16_f32 v57, 0, v57
    s_waitcnt lgkmcnt(0)
    v_readfirstlane_b32 s68, v5
    s_add_u32 s68, s68, s69
    s_cmp_gt_i32 s68, 5
    s_cbranch_scc1 L_dw2_6
    s_cmp_gt_i32 s68, 4
    s_cbranch_scc1 L_dw2_5
    s_waitcnt vmcnt(3)
L_dw2_5:
    s_waitcnt vmcnt(4)
L_dw2_6:
    s_waitcnt vmcnt(5)
    buffer_load_dwordx4 v[84:87], v1, s[32:35], s56 offen offset:0 nt
    buffer_load_dwordx4 v[88:91], v1, s[32:35], s56 offen offset:128 nt
    s_mov_b64 exec, 1
    ds_add_rtn_u32 v4, v2, v3 offset:8
    s_mov_b64 exec, -1
    v_dot2c_f32_bf16 v58, v108, v16
    v_dot2c_f32_bf16 v58, v109, v17
    v_dot2c_f32_bf16 v58, v110, v18
    v_dot2c_f32_bf16 v58, v111, v19
    v_dot2c_f32_bf16 v58, v112, v20
    v_dot2c_f32_bf16 v58, v113, v21
    v_dot2c_f32_bf16 v58, v114, v22
    v_dot2c_f32_bf16 v58, v115, v23
    v_dot2c_f32_bf16 v58, v116, v24
    v_dot2c_f32_bf16 v58, v117, v25
    v_dot2c_f32_bf16 v58, v118, v26
    v_dot2c_f32_bf16 v58, v119, v27
    s_nop 2
    v_add_f32_dpp v58, v58, v58 quad_perm:[1,0,3,2] row_mask:0xf bank_mask:0xf
    s_nop 1
    v_add_f32_dpp v58, v58, v58 quad_perm:[2,3,0,1] row_mask:0xf bank_mask:0xf
    s_nop 1
    v_add_f32_dpp v58, v58, v58 row_half_mirror row_mask:0xf bank_mask:0xf
    v_cvt_pk_bf16_f32 v58, 0, v58
    v_mul_f32 v58, 0x3d93cd3a, v58
    v_cvt_pk_bf16_f32 v58, 0, v58
    s_waitcnt lgkmcnt(0)
    v_readfirstlane_b32 s52, v4
    s_sub_u32 s68, s68, s69
    s_and_b32 s52, s52, 3
    s_lshl_b32 s52, s52, 3
    s_mov_b32 s69, 0x1000000
    s_lshr_b32 s69, s69, s52
    s_sext_i32_i8 s69, s69
    s_add_u32 s68, s68, s69
    s_cmp_gt_i32 s68, 6
    s_cbranch_scc1 L_dw3_7
    s_cmp_gt_i32 s68, 5
    s_cbranch_scc1 L_dw3_6
    s_cmp_gt_i32 s68, 4
    s_cbranch_scc1 L_dw3_5
    s_waitcnt vmcnt(3)
L_dw3_5:
    s_waitcnt vmcnt(4)
L_dw3_6:
    s_waitcnt vmcnt(5)
L_dw3_7:
    s_waitcnt vmcnt(6)
    buffer_load_dwordx4 v[92:95], v1, s[32:35], s56 offen offset:256 nt
    s_add_u32 s56, s86, 51511296
    buffer_load_dwordx4 v[96:99], v1, s[32:35], s56 offen offset:0 nt
    v_dot2c_f32_bf16 v59, v120, v16
    v_dot2c_f32_bf16 v59, v121, v17
    v_dot2c_f32_bf16 v59, v122, v18
    v_dot2c_f32_bf16 v59, v123, v19
    v_dot2c_f32_bf16 v59, v124, v20
    v_dot2c_f32_bf16 v59, v125, v21
    v_dot2c_f32_bf16 v59, v126, v22
    v_dot2c_f32_bf16 v59, v127, v23
    v_dot2c_f32_bf16 v59, v128, v24
    v_dot2c_f32_bf16 v59, v129, v25
    v_dot2c_f32_bf16 v59, v130, v26
    v_dot2c_f32_bf16 v59, v131, v27
    ds_read_b128 v[16:19], v253 offset:6144
    ds_read_b128 v[20:23], v253 offset:6272
    ds_read_b128 v[24:27], v253 offset:6400
    v_add_f32_dpp v59, v59, v59 quad_perm:[1,0,3,2] row_mask:0xf bank_mask:0xf
    s_nop 1
    v_add_f32_dpp v59, v59, v59 quad_perm:[2,3,0,1] row_mask:0xf bank_mask:0xf
    s_nop 1
    v_add_f32_dpp v59, v59, v59 row_half_mirror row_mask:0xf bank_mask:0xf
    v_cvt_pk_bf16_f32 v59, 0, v59
    v_mul_f32 v59, 0x3d93cd3a, v59
    v_cvt_pk_bf16_f32 v59, 0, v59
    s_cmp_gt_i32 s68, 7
    s_cbranch_scc1 L_dw4_8
    s_cmp_gt_i32 s68, 6
    s_cbranch_scc1 L_dw4_7
    s_cmp_gt_i32 s68, 5
    s_cbranch_scc1 L_dw4_6
    s_cmp_gt_i32 s68, 4
    s_cbranch_scc1 L_dw4_5
    s_waitcnt vmcnt(3)
L_dw4_5:
    s_waitcnt vmcnt(4)
L_dw4_6:
    s_waitcnt vmcnt(5)
L_dw4_7:
    s_waitcnt vmcnt(6)
L_dw4_8:
    s_waitcnt vmcnt(7)
    buffer_load_dwordx4 v[100:103], v1, s[32:35], s56 offen offset:128 nt
    s_waitcnt lgkmcnt(0)
    v_dot2c_f32_bf16 v52, v132, v16
    v_dot2c_f32_bf16 v52, v133, v17
    v_dot2c_f32_bf16 v52, v134, v18
    v_dot2c_f32_bf16 v52, v135, v19
    v_dot2c_f32_bf16 v52, v136, v20
    v_dot2c_f32_bf16 v52, v137, v21
    v_dot2c_f32_bf16 v52, v138, v22
    v_dot2c_f32_bf16 v52, v139, v23
    v_dot2c_f32_bf16 v52, v140, v24
    v_dot2c_f32_bf16 v52, v141, v25
    v_dot2c_f32_bf16 v52, v142, v26
    v_dot2c_f32_bf16 v52, v143, v27
    s_nop 2
    v_add_f32_dpp v52, v52, v52 quad_perm:[1,0,3,2] row_mask:0xf bank_mask:0xf
    s_nop 1
    v_add_f32_dpp v52, v52, v52 quad_perm:[2,3,0,1] row_mask:0xf bank_mask:0xf
    s_nop 1
    v_add_f32_dpp v52, v52, v52 row_half_mirror row_mask:0xf bank_mask:0xf
    v_cvt_pk_bf16_f32 v52, 0, v52
    v_mul_f32 v52, 0x3d93cd3a, v52
    v_cvt_pk_bf16_f32 v52, 0, v52
    s_cmp_gt_i32 s68, 7
    s_cbranch_scc1 L_dw5_8
    s_cmp_gt_i32 s68, 6
    s_cbranch_scc1 L_dw5_7
    s_cmp_gt_i32 s68, 5
    s_cbranch_scc1 L_dw5_6
    s_cmp_gt_i32 s68, 4
    s_cbranch_scc1 L_dw5_5
    s_waitcnt vmcnt(3)
L_dw5_5:
    s_waitcnt vmcnt(4)
L_dw5_6:
    s_waitcnt vmcnt(5)
L_dw5_7:
    s_waitcnt vmcnt(6)
L_dw5_8:
    s_waitcnt vmcnt(7)
    buffer_load_dwordx4 v[104:107], v1, s[32:35], s56 offen offset:256 nt
    s_add_u32 s56, s89, 0
    ds_read_b32 v5, v2 offset:4
    v_dot2c_f32_bf16 v53, v144, v16
    v_dot2c_f32_bf16 v53, v145, v17
    v_dot2c_f32_bf16 v53, v146, v18
    v_dot2c_f32_bf16 v53, v147, v19
    v_dot2c_f32_bf16 v53, v148, v20
    v_dot2c_f32_bf16 v53, v149, v21
    v_dot2c_f32_bf16 v53, v150, v22
    v_dot2c_f32_bf16 v53, v151, v23
    v_dot2c_f32_bf16 v53, v152, v24
    v_dot2c_f32_bf16 v53, v153, v25
    v_dot2c_f32_bf16 v53, v154, v26
    v_dot2c_f32_bf16 v53, v155, v27
    s_nop 2
    v_add_f32_dpp v53, v53, v53 quad_perm:[1,0,3,2] row_mask:0xf bank_mask:0xf
    s_nop 1
    v_add_f32_dpp v53, v53, v53 quad_perm:[2,3,0,1] row_mask:0xf bank_mask:0xf
    s_nop 1
    v_add_f32_dpp v53, v53, v53 row_half_mirror row_mask:0xf bank_mask:0xf
    v_cvt_pk_bf16_f32 v53, 0, v53
    v_mul_f32 v53, 0x3d93cd3a, v53
    v_cvt_pk_bf16_f32 v53, 0, v53
    s_waitcnt lgkmcnt(0)
    v_readfirstlane_b32 s68, v5
    s_add_u32 s68, s68, s69
    s_cmp_gt_i32 s68, 7
    s_cbranch_scc1 L_dw6_8
    s_cmp_gt_i32 s68, 6
    s_cbranch_scc1 L_dw6_7
    s_cmp_gt_i32 s68, 5
    s_cbranch_scc1 L_dw6_6
    s_cmp_gt_i32 s68, 4
    s_cbranch_scc1 L_dw6_5
    s_waitcnt vmcnt(3)
L_dw6_5:
    s_waitcnt vmcnt(4)
L_dw6_6:
    s_waitcnt vmcnt(5)
L_dw6_7:
    s_waitcnt vmcnt(6)
L_dw6_8:
    s_waitcnt vmcnt(7)
    buffer_load_dwordx4 v[108:111], v1, s[32:35], s56 offen offset:0 nt
    s_mov_b64 exec, 1
    ds_add_u32 v2, v3 offset:0
    s_mov_b64 exec, -1
    v_dot2c_f32_bf16 v54, v156, v16
    v_dot2c_f32_bf16 v54, v157, v17
    v_dot2c_f32_bf16 v54, v158, v18
    v_dot2c_f32_bf16 v54, v159, v19
    v_dot2c_f32_bf16 v54, v160, v20
    v_dot2c_f32_bf16 v54, v161, v21
    v_dot2c_f32_bf16 v54, v162, v22
    v_dot2c_f32_bf16 v54, v163, v23
    v_dot2c_f32_bf16 v54, v164, v24
    v_dot2c_f32_bf16 v54, v165, v25
    v_dot2c_f32_bf16 v54, v166, v26
    v_dot2c_f32_bf16 v54, v167, v27
    s_nop 2
    v_add_f32_dpp v54, v54, v54 quad_perm:[1,0,3,2] row_mask:0xf bank_mask:0xf
    s_nop 1
    v_add_f32_dpp v54, v54, v54 quad_perm:[2,3,0,1] row_mask:0xf bank_mask:0xf
    s_nop 1
    v_add_f32_dpp v54, v54, v54 row_half_mirror row_mask:0xf bank_mask:0xf
    v_cvt_pk_bf16_f32 v54, 0, v54
    v_mul_f32 v54, 0x3d93cd3a, v54
    v_cvt_pk_bf16_f32 v54, 0, v54
    s_cmp_gt_i32 s68, 7
    s_cbranch_scc1 L_dw7_8
    s_cmp_gt_i32 s68, 6
    s_cbranch_scc1 L_dw7_7
    s_cmp_gt_i32 s68, 5
    s_cbranch_scc1 L_dw7_6
    s_cmp_gt_i32 s68, 4
    s_cbranch_scc1 L_dw7_5
    s_waitcnt vmcnt(3)
L_dw7_5:
    s_waitcnt vmcnt(4)
L_dw7_6:
    s_waitcnt vmcnt(5)
L_dw7_7:
    s_waitcnt vmcnt(6)
L_dw7_8:
    s_waitcnt vmcnt(7)
    buffer_load_dwordx4 v[112:115], v1, s[32:35], s56 offen offset:128 nt
    v_dot2c_f32_bf16 v55, v168, v16
    v_dot2c_f32_bf16 v55, v169, v17
    v_dot2c_f32_bf16 v55, v170, v18
    v_dot2c_f32_bf16 v55, v171, v19
    v_dot2c_f32_bf16 v55, v172, v20
    v_dot2c_f32_bf16 v55, v173, v21
    v_dot2c_f32_bf16 v55, v174, v22
    v_dot2c_f32_bf16 v55, v175, v23
    v_dot2c_f32_bf16 v55, v176, v24
    v_dot2c_f32_bf16 v55, v177, v25
    v_dot2c_f32_bf16 v55, v178, v26
    v_dot2c_f32_bf16 v55, v179, v27
    ds_read_b128 v[16:19], v253 offset:5760
    ds_read_b128 v[20:23], v253 offset:5888
    ds_read_b128 v[24:27], v253 offset:6016
    v_add_f32_dpp v55, v55, v55 quad_perm:[1,0,3,2] row_mask:0xf bank_mask:0xf
    s_nop 1
    v_add_f32_dpp v55, v55, v55 quad_perm:[2,3,0,1] row_mask:0xf bank_mask:0xf
    s_nop 1
    v_add_f32_dpp v55, v55, v55 row_half_mirror row_mask:0xf bank_mask:0xf
    v_cvt_pk_bf16_f32 v55, 0, v55
    v_mul_f32 v55, 0x3d93cd3a, v55
    v_cvt_pk_bf16_f32 v55, 0, v55
    s_cmp_gt_i32 s68, 7
    s_cbranch_scc1 L_dw8_8
    s_cmp_gt_i32 s68, 6
    s_cbranch_scc1 L_dw8_7
    s_cmp_gt_i32 s68, 5
    s_cbranch_scc1 L_dw8_6
    s_cmp_gt_i32 s68, 4
    s_cbranch_scc1 L_dw8_5
    s_waitcnt vmcnt(3)
L_dw8_5:
    s_waitcnt vmcnt(4)
L_dw8_6:
    s_waitcnt vmcnt(5)
L_dw8_7:
    s_waitcnt vmcnt(6)
L_dw8_8:
    s_waitcnt vmcnt(7)
    buffer_load_dwordx4 v[116:119], v1, s[32:35], s56 offen offset:256 nt
    s_add_u32 s56, s89, 393216
    s_mov_b64 exec, 1
    ds_add_rtn_u32 v4, v2, v3 offset:8
    s_mov_b64 exec, -1
    s_waitcnt lgkmcnt(0)
    v_dot2c_f32_bf16 v48, v180, v16
    v_dot2c_f32_bf16 v48, v181, v17
    v_dot2c_f32_bf16 v48, v182, v18
    v_dot2c_f32_bf16 v48, v183, v19
    v_dot2c_f32_bf16 v48, v184, v20
    v_dot2c_f32_bf16 v48, v185, v21
    v_dot2c_f32_bf16 v48, v186, v22
    v_dot2c_f32_bf16 v48, v187, v23
    v_dot2c_f32_bf16 v48, v188, v24
    v_dot2c_f32_bf16 v48, v189, v25
    v_dot2c_f32_bf16 v48, v190, v26
    v_dot2c_f32_bf16 v48, v191, v27
    s_nop 2
    v_add_f32_dpp v48, v48, v48 quad_perm:[1,0,3,2] row_mask:0xf bank_mask:0xf
    s_nop 1
    v_add_f32_dpp v48, v48, v48 quad_perm:[2,3,0,1] row_mask:0xf bank_mask:0xf
    s_nop 1
    v_add_f32_dpp v48, v48, v48 row_half_mirror row_mask:0xf bank_mask:0xf
    v_cvt_pk_bf16_f32 v48, 0, v48
    v_mul_f32 v48, 0x3d93cd3a, v48
    v_cvt_pk_bf16_f32 v48, 0, v48
    s_waitcnt lgkmcnt(0)
    v_readfirstlane_b32 s52, v4
    s_sub_u32 s68, s68, s69
    s_and_b32 s52, s52, 3
    s_lshl_b32 s52, s52, 3
    s_mov_b32 s69, 0x1000000
    s_lshr_b32 s69, s69, s52
    s_sext_i32_i8 s69, s69
    s_add_u32 s68, s68, s69
    s_cmp_gt_i32 s68, 7
    s_cbranch_scc1 L_dw9_8
    s_cmp_gt_i32 s68, 6
    s_cbranch_scc1 L_dw9_7
    s_cmp_gt_i32 s68, 5
    s_cbranch_scc1 L_dw9_6
    s_cmp_gt_i32 s68, 4
    s_cbranch_scc1 L_dw9_5
    s_waitcnt vmcnt(3)
L_dw9_5:
    s_waitcnt vmcnt(4)
L_dw9_6:
    s_waitcnt vmcnt(5)
L_dw9_7:
    s_waitcnt vmcnt(6)
L_dw9_8:
    s_waitcnt vmcnt(7)
    buffer_load_dwordx4 v[120:123], v1, s[32:35], s56 offen offset:0 nt
    ds_read_b32 v5, v2 offset:4
    v_dot2c_f32_bf16 v49, v192, v16
    v_dot2c_f32_bf16 v49, v193, v17
    v_dot2c_f32_bf16 v49, v194, v18
    v_dot2c_f32_bf16 v49, v195, v19
    v_dot2c_f32_bf16 v49, v196, v20
    v_dot2c_f32_bf16 v49, v197, v21
    v_dot2c_f32_bf16 v49, v198, v22
    v_dot2c_f32_bf16 v49, v199, v23
    v_dot2c_f32_bf16 v49, v200, v24
    v_dot2c_f32_bf16 v49, v201, v25
    v_dot2c_f32_bf16 v49, v202, v26
    v_dot2c_f32_bf16 v49, v203, v27
    s_nop 2
    v_add_f32_dpp v49, v49, v49 quad_perm:[1,0,3,2] row_mask:0xf bank_mask:0xf
    s_nop 1
    v_add_f32_dpp v49, v49, v49 quad_perm:[2,3,0,1] row_mask:0xf bank_mask:0xf
    s_nop 1
    v_add_f32_dpp v49, v49, v49 row_half_mirror row_mask:0xf bank_mask:0xf
    v_cvt_pk_bf16_f32 v49, 0, v49
    v_mul_f32 v49, 0x3d93cd3a, v49
    v_cvt_pk_bf16_f32 v49, 0, v49
    s_waitcnt lgkmcnt(0)
    v_readfirstlane_b32 s68, v5
    s_add_u32 s68, s68, s69
    s_cmp_gt_i32 s68, 7
    s_cbranch_scc1 L_dw10_8
    s_cmp_gt_i32 s68, 6
    s_cbranch_scc1 L_dw10_7
    s_cmp_gt_i32 s68, 5
    s_cbranch_scc1 L_dw10_6
    s_cmp_gt_i32 s68, 4
    s_cbranch_scc1 L_dw10_5
    s_waitcnt vmcnt(3)
L_dw10_5:
    s_waitcnt vmcnt(4)
L_dw10_6:
    s_waitcnt vmcnt(5)
L_dw10_7:
    s_waitcnt vmcnt(6)
L_dw10_8:
    s_waitcnt vmcnt(7)
    buffer_load_dwordx4 v[124:127], v1, s[32:35], s56 offen offset:128 nt
    v_dot2c_f32_bf16 v50, v204, v16
    v_dot2c_f32_bf16 v50, v205, v17
    v_dot2c_f32_bf16 v50, v206, v18
    v_dot2c_f32_bf16 v50, v207, v19
    v_dot2c_f32_bf16 v50, v208, v20
    v_dot2c_f32_bf16 v50, v209, v21
    v_dot2c_f32_bf16 v50, v210, v22
    v_dot2c_f32_bf16 v50, v211, v23
    v_dot2c_f32_bf16 v50, v212, v24
    v_dot2c_f32_bf16 v50, v213, v25
    v_dot2c_f32_bf16 v50, v214, v26
    v_dot2c_f32_bf16 v50, v215, v27
    s_nop 2
    v_add_f32_dpp v50, v50, v50 quad_perm:[1,0,3,2] row_mask:0xf bank_mask:0xf
    s_nop 1
    v_add_f32_dpp v50, v50, v50 quad_perm:[2,3,0,1] row_mask:0xf bank_mask:0xf
    s_nop 1
    v_add_f32_dpp v50, v50, v50 row_half_mirror row_mask:0xf bank_mask:0xf
    v_cvt_pk_bf16_f32 v50, 0, v50
    v_mul_f32 v50, 0x3d93cd3a, v50
    v_cvt_pk_bf16_f32 v50, 0, v50
    s_cmp_gt_i32 s68, 7
    s_cbranch_scc1 L_dw11_8
    s_cmp_gt_i32 s68, 6
    s_cbranch_scc1 L_dw11_7
    s_cmp_gt_i32 s68, 5
    s_cbranch_scc1 L_dw11_6
    s_cmp_gt_i32 s68, 4
    s_cbranch_scc1 L_dw11_5
    s_waitcnt vmcnt(3)
L_dw11_5:
    s_waitcnt vmcnt(4)
L_dw11_6:
    s_waitcnt vmcnt(5)
L_dw11_7:
    s_waitcnt vmcnt(6)
L_dw11_8:
    s_waitcnt vmcnt(7)
    buffer_load_dwordx4 v[128:131], v1, s[32:35], s56 offen offset:256 nt
    s_add_u32 s56, s89, 786432
    v_dot2c_f32_bf16 v51, v216, v16
    v_dot2c_f32_bf16 v51, v217, v17
    v_dot2c_f32_bf16 v51, v218, v18
    v_dot2c_f32_bf16 v51, v219, v19
    v_dot2c_f32_bf16 v51, v220, v20
    v_dot2c_f32_bf16 v51, v221, v21
    v_dot2c_f32_bf16 v51, v222, v22
    v_dot2c_f32_bf16 v51, v223, v23
    v_dot2c_f32_bf16 v51, v224, v24
    v_dot2c_f32_bf16 v51, v225, v25
    v_dot2c_f32_bf16 v51, v226, v26
    v_dot2c_f32_bf16 v51, v227, v27
    ds_read_b128 v[16:19], v253 offset:5376
    ds_read_b128 v[20:23], v253 offset:5504
    ds_read_b128 v[24:27], v253 offset:5632
    v_add_f32_dpp v51, v51, v51 quad_perm:[1,0,3,2] row_mask:0xf bank_mask:0xf
    s_nop 1
    v_add_f32_dpp v51, v51, v51 quad_perm:[2,3,0,1] row_mask:0xf bank_mask:0xf
    s_nop 1
    v_add_f32_dpp v51, v51, v51 row_half_mirror row_mask:0xf bank_mask:0xf
    v_cvt_pk_bf16_f32 v51, 0, v51
    v_mul_f32 v51, 0x3d93cd3a, v51
    v_cvt_pk_bf16_f32 v51, 0, v51
    s_cmp_gt_i32 s68, 7
    s_cbranch_scc1 L_dw12_8
    s_cmp_gt_i32 s68, 6
    s_cbranch_scc1 L_dw12_7
    s_cmp_gt_i32 s68, 5
    s_cbranch_scc1 L_dw12_6
    s_cmp_gt_i32 s68, 4
    s_cbranch_scc1 L_dw12_5
    s_waitcnt vmcnt(3)
L_dw12_5:
    s_waitcnt vmcnt(4)
L_dw12_6:
    s_waitcnt vmcnt(5)
L_dw12_7:
    s_waitcnt vmcnt(6)
L_dw12_8:
    s_waitcnt vmcnt(7)
    buffer_load_dwordx4 v[132:135], v1, s[32:35], s56 offen offset:0 nt
    s_waitcnt lgkmcnt(0)
    v_dot2c_f32_bf16 v44, v228, v16
    v_dot2c_f32_bf16 v44, v229, v17
    v_dot2c_f32_bf16 v44, v230, v18
    v_dot2c_f32_bf16 v44, v231, v19
    v_dot2c_f32_bf16 v44, v232, v20
    v_dot2c_f32_bf16 v44, v233, v21
    v_dot2c_f32_bf16 v44, v234, v22
    v_dot2c_f32_bf16 v44, v235, v23
    v_dot2c_f32_bf16 v44, v236, v24
    v_dot2c_f32_bf16 v44, v237, v25
    v_dot2c_f32_bf16 v44, v238, v26
    v_dot2c_f32_bf16 v44, v239, v27
    s_nop 2
    v_add_f32_dpp v44, v44, v44 quad_perm:[1,0,3,2] row_mask:0xf bank_mask:0xf
    s_nop 1
    v_add_f32_dpp v44, v44, v44 quad_perm:[2,3,0,1] row_mask:0xf bank_mask:0xf
    s_nop 1
    v_add_f32_dpp v44, v44, v44 row_half_mirror row_mask:0xf bank_mask:0xf
    v_cvt_pk_bf16_f32 v44, 0, v44
    v_mul_f32 v44, 0x3d93cd3a, v44
    v_cvt_pk_bf16_f32 v44, 0, v44
    s_cmp_gt_i32 s68, 7
    s_cbranch_scc1 L_dw13_8
    s_cmp_gt_i32 s68, 6
    s_cbranch_scc1 L_dw13_7
    s_cmp_gt_i32 s68, 5
    s_cbranch_scc1 L_dw13_6
    s_cmp_gt_i32 s68, 4
    s_cbranch_scc1 L_dw13_5
    s_waitcnt vmcnt(3)
L_dw13_5:
    s_waitcnt vmcnt(4)
L_dw13_6:
    s_waitcnt vmcnt(5)
L_dw13_7:
    s_waitcnt vmcnt(6)
L_dw13_8:
    s_waitcnt vmcnt(7)
    buffer_load_dwordx4 v[136:139], v1, s[32:35], s56 offen offset:128 nt
    ds_read_b32 v5, v2 offset:4
    v_dot2c_f32_bf16 v45, v240, v16
    v_dot2c_f32_bf16 v45, v241, v17
    v_dot2c_f32_bf16 v45, v242, v18
    v_dot2c_f32_bf16 v45, v243, v19
    v_dot2c_f32_bf16 v45, v244, v20
    v_dot2c_f32_bf16 v45, v245, v21
    v_dot2c_f32_bf16 v45, v246, v22
    v_dot2c_f32_bf16 v45, v247, v23
    v_dot2c_f32_bf16 v45, v248, v24
    v_dot2c_f32_bf16 v45, v249, v25
    v_dot2c_f32_bf16 v45, v250, v26
    v_dot2c_f32_bf16 v45, v251, v27
    s_nop 2
    v_add_f32_dpp v45, v45, v45 quad_perm:[1,0,3,2] row_mask:0xf bank_mask:0xf
    s_nop 1
    v_add_f32_dpp v45, v45, v45 quad_perm:[2,3,0,1] row_mask:0xf bank_mask:0xf
    s_nop 1
    v_add_f32_dpp v45, v45, v45 row_half_mirror row_mask:0xf bank_mask:0xf
    v_cvt_pk_bf16_f32 v45, 0, v45
    v_mul_f32 v45, 0x3d93cd3a, v45
    v_cvt_pk_bf16_f32 v45, 0, v45
    s_waitcnt lgkmcnt(0)
    v_readfirstlane_b32 s68, v5
    s_add_u32 s68, s68, s69
    s_cmp_gt_i32 s68, 7
    s_cbranch_scc1 L_dw14_8
    s_cmp_gt_i32 s68, 6
    s_cbranch_scc1 L_dw14_7
    s_cmp_gt_i32 s68, 5
    s_cbranch_scc1 L_dw14_6
    s_cmp_gt_i32 s68, 4
    s_cbranch_scc1 L_dw14_5
    s_waitcnt vmcnt(3)
L_dw14_5:
    s_waitcnt vmcnt(4)
L_dw14_6:
    s_waitcnt vmcnt(5)
L_dw14_7:
    s_waitcnt vmcnt(6)
L_dw14_8:
    s_waitcnt vmcnt(7)
    buffer_load_dwordx4 v[140:143], v1, s[32:35], s56 offen offset:256 nt
    s_add_u32 s56, s89, 1179648
    s_mov_b64 exec, 1
    ds_add_rtn_u32 v4, v2, v3 offset:8
    s_mov_b64 exec, -1
    s_mov_b64 exec, 1
    ds_add_u32 v2, v3 offset:0
    s_mov_b64 exec, -1
    v_dot2c_f32_bf16 v46, v84, v16
    v_dot2c_f32_bf16 v46, v85, v17
    v_dot2c_f32_bf16 v46, v86, v18
    v_dot2c_f32_bf16 v46, v87, v19
    v_dot2c_f32_bf16 v46, v88, v20
    v_dot2c_f32_bf16 v46, v89, v21
    v_dot2c_f32_bf16 v46, v90, v22
    v_dot2c_f32_bf16 v46, v91, v23
    v_dot2c_f32_bf16 v46, v92, v24
    v_dot2c_f32_bf16 v46, v93, v25
    v_dot2c_f32_bf16 v46, v94, v26
    v_dot2c_f32_bf16 v46, v95, v27
    s_nop 2
    v_add_f32_dpp v46, v46, v46 quad_perm:[1,0,3,2] row_mask:0xf bank_mask:0xf
    s_nop 1
    v_add_f32_dpp v46, v46, v46 quad_perm:[2,3,0,1] row_mask:0xf bank_mask:0xf
    s_nop 1
    v_add_f32_dpp v46, v46, v46 row_half_mirror row_mask:0xf bank_mask:0xf
    v_cvt_pk_bf16_f32 v46, 0, v46
    v_mul_f32 v46, 0x3d93cd3a, v46
    v_cvt_pk_bf16_f32 v46, 0, v46
    s_waitcnt lgkmcnt(0)
    v_readfirstlane_b32 s52, v4
    s_sub_u32 s68, s68, s69
    s_and_b32 s52, s52, 3
    s_lshl_b32 s52, s52, 3
    s_mov_b32 s69, 0x1000000
    s_lshr_b32 s69, s69, s52
    s_sext_i32_i8 s69, s69
    s_add_u32 s68, s68, s69
    s_cmp_gt_i32 s68, 7
    s_cbranch_scc1 L_dw15_8
    s_cmp_gt_i32 s68, 6
    s_cbranch_scc1 L_dw15_7
    s_cmp_gt_i32 s68, 5
    s_cbranch_scc1 L_dw15_6
    s_cmp_gt_i32 s68, 4
    s_cbranch_scc1 L_dw15_5
    s_waitcnt vmcnt(3)
L_dw15_5:
    s_waitcnt vmcnt(4)
L_dw15_6:
    s_waitcnt vmcnt(5)
L_dw15_7:
    s_waitcnt vmcnt(6)
L_dw15_8:
    s_waitcnt vmcnt(7)
    buffer_load_dwordx4 v[144:147], v1, s[32:35], s56 offen offset:0 nt
    v_dot2c_f32_bf16 v47, v96, v16
    v_dot2c_f32_bf16 v47, v97, v17
    v_dot2c_f32_bf16 v47, v98, v18
    v_dot2c_f32_bf16 v47, v99, v19
    v_dot2c_f32_bf16 v47, v100, v20
    v_dot2c_f32_bf16 v47, v101, v21
    v_dot2c_f32_bf16 v47, v102, v22
    v_dot2c_f32_bf16 v47, v103, v23
    v_dot2c_f32_bf16 v47, v104, v24
    v_dot2c_f32_bf16 v47, v105, v25
    v_dot2c_f32_bf16 v47, v106, v26
    v_dot2c_f32_bf16 v47, v107, v27
    ds_read_b128 v[16:19], v253 offset:4480
    ds_read_b128 v[20:23], v253 offset:4608
    ds_read_b128 v[24:27], v253 offset:4736
    v_add_f32_dpp v47, v47, v47 quad_perm:[1,0,3,2] row_mask:0xf bank_mask:0xf
    s_nop 1
    v_add_f32_dpp v47, v47, v47 quad_perm:[2,3,0,1] row_mask:0xf bank_mask:0xf
    s_nop 1
    v_add_f32_dpp v47, v47, v47 row_half_mirror row_mask:0xf bank_mask:0xf
    v_cvt_pk_bf16_f32 v47, 0, v47
    v_mul_f32 v47, 0x3d93cd3a, v47
    v_cvt_pk_bf16_f32 v47, 0, v47
    s_cmp_gt_i32 s68, 7
    s_cbranch_scc1 L_dw16_8
    s_cmp_gt_i32 s68, 6
    s_cbranch_scc1 L_dw16_7
    s_cmp_gt_i32 s68, 5
    s_cbranch_scc1 L_dw16_6
    s_cmp_gt_i32 s68, 4
    s_cbranch_scc1 L_dw16_5
    s_waitcnt vmcnt(3)
L_dw16_5:
    s_waitcnt vmcnt(4)
L_dw16_6:
    s_waitcnt vmcnt(5)
L_dw16_7:
    s_waitcnt vmcnt(6)
L_dw16_8:
    s_waitcnt vmcnt(7)
    buffer_load_dwordx4 v[148:151], v1, s[32:35], s56 offen offset:128 nt
    s_waitcnt lgkmcnt(0)
    v_dot2c_f32_bf16 v40, v108, v16
    v_dot2c_f32_bf16 v40, v109, v17
    v_dot2c_f32_bf16 v40, v110, v18
    v_dot2c_f32_bf16 v40, v111, v19
    v_dot2c_f32_bf16 v40, v112, v20
    v_dot2c_f32_bf16 v40, v113, v21
    v_dot2c_f32_bf16 v40, v114, v22
    v_dot2c_f32_bf16 v40, v115, v23
    v_dot2c_f32_bf16 v40, v116, v24
    v_dot2c_f32_bf16 v40, v117, v25
    v_dot2c_f32_bf16 v40, v118, v26
    v_dot2c_f32_bf16 v40, v119, v27
    s_nop 2
    v_add_f32_dpp v40, v40, v40 quad_perm:[1,0,3,2] row_mask:0xf bank_mask:0xf
    s_nop 1
    v_add_f32_dpp v40, v40, v40 quad_perm:[2,3,0,1] row_mask:0xf bank_mask:0xf
    s_nop 1
    v_add_f32_dpp v40, v40, v40 row_half_mirror row_mask:0xf bank_mask:0xf
    v_cvt_pk_bf16_f32 v40, 0, v40
    v_mul_f32 v40, 0x3d93cd3a, v40
    v_cvt_pk_bf16_f32 v40, 0, v40
    s_cmp_gt_i32 s68, 7
    s_cbranch_scc1 L_dw17_8
    s_cmp_gt_i32 s68, 6
    s_cbranch_scc1 L_dw17_7
    s_cmp_gt_i32 s68, 5
    s_cbranch_scc1 L_dw17_6
    s_cmp_gt_i32 s68, 4
    s_cbranch_scc1 L_dw17_5
    s_waitcnt vmcnt(3)
L_dw17_5:
    s_waitcnt vmcnt(4)
L_dw17_6:
    s_waitcnt vmcnt(5)
L_dw17_7:
    s_waitcnt vmcnt(6)
L_dw17_8:
    s_waitcnt vmcnt(7)
    buffer_load_dwordx4 v[152:155], v1, s[32:35], s56 offen offset:256 nt
    s_add_u32 s56, s88, 0
    ds_read_b32 v5, v2 offset:4
    v_dot2c_f32_bf16 v41, v120, v16
    v_dot2c_f32_bf16 v41, v121, v17
    v_dot2c_f32_bf16 v41, v122, v18
    v_dot2c_f32_bf16 v41, v123, v19
    s_waitcnt lgkmcnt(0)
    v_readfirstlane_b32 s68, v5
    s_add_u32 s68, s68, s69
    s_cmp_gt_i32 s68, 7
    s_cbranch_scc1 L_dw18_8
    s_cmp_gt_i32 s68, 6
    s_cbranch_scc1 L_dw18_7
    s_cmp_gt_i32 s68, 5
    s_cbranch_scc1 L_dw18_6
    s_cmp_gt_i32 s68, 4
    s_cbranch_scc1 L_dw18_5
    s_waitcnt vmcnt(3)
L_dw18_5:
    s_waitcnt vmcnt(4)
L_dw18_6:
    s_waitcnt vmcnt(5)
L_dw18_7:
    s_waitcnt vmcnt(6)
L_dw18_8:
    s_waitcnt vmcnt(7)
    buffer_load_dwordx4 v[156:159], v1, s[32:35], s56 offen offset:0 nt
    v_dot2c_f32_bf16 v41, v124, v20
    v_dot2c_f32_bf16 v41, v125, v21
    v_dot2c_f32_bf16 v41, v126, v22
    v_dot2c_f32_bf16 v41, v127, v23
    s_cmp_gt_i32 s68, 7
    s_cbranch_scc1 L_dw19_8
    s_cmp_gt_i32 s68, 6
    s_cbranch_scc1 L_dw19_7
    s_cmp_gt_i32 s68, 5
    s_cbranch_scc1 L_dw19_6
    s_cmp_gt_i32 s68, 4
    s_cbranch_scc1 L_dw19_5
    s_waitcnt vmcnt(3)
L_dw19_5:
    s_waitcnt vmcnt(4)
L_dw19_6:
    s_waitcnt vmcnt(5)
L_dw19_7:
    s_waitcnt vmcnt(6)
L_dw19_8:
    s_waitcnt vmcnt(7)
    buffer_load_dwordx4 v[160:163], v1, s[32:35], s56 offen offset:128 nt
    v_dot2c_f32_bf16 v41, v128, v24
    v_dot2c_f32_bf16 v41, v129, v25
    v_dot2c_f32_bf16 v41, v130, v26
    v_dot2c_f32_bf16 v41, v131, v27
    s_nop 2
    v_add_f32_dpp v41, v41, v41 quad_perm:[1,0,3,2] row_mask:0xf bank_mask:0xf
    s_nop 1
    v_add_f32_dpp v41, v41, v41 quad_perm:[2,3,0,1] row_mask:0xf bank_mask:0xf
    s_nop 1
    v_add_f32_dpp v41, v41, v41 row_half_mirror row_mask:0xf bank_mask:0xf
    v_cvt_pk_bf16_f32 v41, 0, v41
    v_mul_f32 v41, 0x3d93cd3a, v41
    v_cvt_pk_bf16_f32 v41, 0, v41
    s_cmp_gt_i32 s68, 7
    s_cbranch_scc1 L_dw20_8
    s_cmp_gt_i32 s68, 6
    s_cbranch_scc1 L_dw20_7
    s_cmp_gt_i32 s68, 5
    s_cbranch_scc1 L_dw20_6
    s_cmp_gt_i32 s68, 4
    s_cbranch_scc1 L_dw20_5
    s_waitcnt vmcnt(3)
L_dw20_5:
    s_waitcnt vmcnt(4)
L_dw20_6:
    s_waitcnt vmcnt(5)
L_dw20_7:
    s_waitcnt vmcnt(6)
L_dw20_8:
    s_waitcnt vmcnt(7)
    buffer_load_dwordx4 v[164:167], v1, s[32:35], s56 offen offset:256 nt
    s_add_u32 s56, s88, 393216
    s_mov_b64 exec, 1
    ds_add_rtn_u32 v4, v2, v3 offset:8
    s_mov_b64 exec, -1
    v_dot2c_f32_bf16 v42, v132, v16
    v_dot2c_f32_bf16 v42, v133, v17
    v_dot2c_f32_bf16 v42, v134, v18
    v_dot2c_f32_bf16 v42, v135, v19
    s_waitcnt lgkmcnt(0)
    v_readfirstlane_b32 s52, v4
    s_sub_u32 s68, s68, s69
    s_and_b32 s52, s52, 3
    s_lshl_b32 s52, s52, 3
    s_mov_b32 s69, 0x1000000
    s_lshr_b32 s69, s69, s52
    s_sext_i32_i8 s69, s69
    s_add_u32 s68, s68, s69
    s_cmp_gt_i32 s68, 7
    s_cbranch_scc1 L_dw21_8
    s_cmp_gt_i32 s68, 6
    s_cbranch_scc1 L_dw21_7
    s_cmp_gt_i32 s68, 5
    s_cbranch_scc1 L_dw21_6
    s_cmp_gt_i32 s68, 4
    s_cbranch_scc1 L_dw21_5
    s_waitcnt vmcnt(3)
L_dw21_5:
    s_waitcnt vmcnt(4)
L_dw21_6:
    s_waitcnt vmcnt(5)
L_dw21_7:
    s_waitcnt vmcnt(6)
L_dw21_8:
    s_waitcnt vmcnt(7)
    buffer_load_dwordx4 v[168:171], v1, s[32:35], s56 offen offset:0 nt
    ds_read_b32 v5, v2 offset:4
    v_dot2c_f32_bf16 v42, v136, v20
    v_dot2c_f32_bf16 v42, v137, v21
    v_dot2c_f32_bf16 v42, v138, v22
    v_dot2c_f32_bf16 v42, v139, v23
    s_waitcnt lgkmcnt(0)
    v_readfirstlane_b32 s68, v5
    s_add_u32 s68, s68, s69
    s_cmp_gt_i32 s68, 7
    s_cbranch_scc1 L_dw22_8
    s_cmp_gt_i32 s68, 6
    s_cbranch_scc1 L_dw22_7
    s_cmp_gt_i32 s68, 5
    s_cbranch_scc1 L_dw22_6
    s_cmp_gt_i32 s68, 4
    s_cbranch_scc1 L_dw22_5
    s_waitcnt vmcnt(3)
L_dw22_5:
    s_waitcnt vmcnt(4)
L_dw22_6:
    s_waitcnt vmcnt(5)
L_dw22_7:
    s_waitcnt vmcnt(6)
L_dw22_8:
    s_waitcnt vmcnt(7)
    buffer_load_dwordx4 v[172:175], v1, s[32:35], s56 offen offset:128 nt
    s_mov_b64 exec, 1
    ds_add_u32 v2, v3 offset:0
    s_mov_b64 exec, -1
    v_dot2c_f32_bf16 v42, v140, v24
    v_dot2c_f32_bf16 v42, v141, v25
    v_dot2c_f32_bf16 v42, v142, v26
    v_dot2c_f32_bf16 v42, v143, v27
    s_nop 2
    v_add_f32_dpp v42, v42, v42 quad_perm:[1,0,3,2] row_mask:0xf bank_mask:0xf
    s_nop 1
    v_add_f32_dpp v42, v42, v42 quad_perm:[2,3,0,1] row_mask:0xf bank_mask:0xf
    s_nop 1
    v_add_f32_dpp v42, v42, v42 row_half_mirror row_mask:0xf bank_mask:0xf
    v_cvt_pk_bf16_f32 v42, 0, v42
    v_mul_f32 v42, 0x3d93cd3a, v42
    v_cvt_pk_bf16_f32 v42, 0, v42
    s_cmp_gt_i32 s68, 7
    s_cbranch_scc1 L_dw23_8
    s_cmp_gt_i32 s68, 6
    s_cbranch_scc1 L_dw23_7
    s_cmp_gt_i32 s68, 5
    s_cbranch_scc1 L_dw23_6
    s_cmp_gt_i32 s68, 4
    s_cbranch_scc1 L_dw23_5
    s_waitcnt vmcnt(3)
L_dw23_5:
    s_waitcnt vmcnt(4)
L_dw23_6:
    s_waitcnt vmcnt(5)
L_dw23_7:
    s_waitcnt vmcnt(6)
L_dw23_8:
    s_waitcnt vmcnt(7)
    buffer_load_dwordx4 v[176:179], v1, s[32:35], s56 offen offset:256 nt
    s_add_u32 s56, s88, 786432
    v_dot2c_f32_bf16 v43, v144, v16
    v_dot2c_f32_bf16 v43, v145, v17
    v_dot2c_f32_bf16 v43, v146, v18
    v_dot2c_f32_bf16 v43, v147, v19
    s_cmp_gt_i32 s68, 7
    s_cbranch_scc1 L_dw24_8
    s_cmp_gt_i32 s68, 6
    s_cbranch_scc1 L_dw24_7
    s_cmp_gt_i32 s68, 5
    s_cbranch_scc1 L_dw24_6
    s_cmp_gt_i32 s68, 4
    s_cbranch_scc1 L_dw24_5
    s_waitcnt vmcnt(3)
L_dw24_5:
    s_waitcnt vmcnt(4)
L_dw24_6:
    s_waitcnt vmcnt(5)
L_dw24_7:
    s_waitcnt vmcnt(6)
L_dw24_8:
    s_waitcnt vmcnt(7)
    buffer_load_dwordx4 v[180:183], v1, s[32:35], s56 offen offset:0 nt
    v_dot2c_f32_bf16 v43, v148, v20
    v_dot2c_f32_bf16 v43, v149, v21
    v_dot2c_f32_bf16 v43, v150, v22
    v_dot2c_f32_bf16 v43, v151, v23
    s_cmp_gt_i32 s68, 7
    s_cbranch_scc1 L_dw25_8
    s_cmp_gt_i32 s68, 6
    s_cbranch_scc1 L_dw25_7
    s_cmp_gt_i32 s68, 5
    s_cbranch_scc1 L_dw25_6
    s_cmp_gt_i32 s68, 4
    s_cbranch_scc1 L_dw25_5
    s_waitcnt vmcnt(3)
L_dw25_5:
    s_waitcnt vmcnt(4)
L_dw25_6:
    s_waitcnt vmcnt(5)
L_dw25_7:
    s_waitcnt vmcnt(6)
L_dw25_8:
    s_waitcnt vmcnt(7)
    buffer_load_dwordx4 v[184:187], v1, s[32:35], s56 offen offset:128 nt
    ds_read_b32 v5, v2 offset:4
    v_dot2c_f32_bf16 v43, v152, v24
    v_dot2c_f32_bf16 v43, v153, v25
    v_dot2c_f32_bf16 v43, v154, v26
    v_dot2c_f32_bf16 v43, v155, v27
    ds_read_b128 v[16:19], v253 offset:4096
    ds_read_b128 v[20:23], v253 offset:4224
    ds_read_b128 v[24:27], v253 offset:4352
    v_add_f32_dpp v43, v43, v43 quad_perm:[1,0,3,2] row_mask:0xf bank_mask:0xf
    s_nop 1
    v_add_f32_dpp v43, v43, v43 quad_perm:[2,3,0,1] row_mask:0xf bank_mask:0xf
    s_nop 1
    v_add_f32_dpp v43, v43, v43 row_half_mirror row_mask:0xf bank_mask:0xf
    v_cvt_pk_bf16_f32 v43, 0, v43
    v_mul_f32 v43, 0x3d93cd3a, v43
    v_cvt_pk_bf16_f32 v43, 0, v43
    s_waitcnt lgkmcnt(0)
    v_readfirstlane_b32 s68, v5
    s_add_u32 s68, s68, s69
    s_cmp_gt_i32 s68, 7
    s_cbranch_scc1 L_dw26_8
    s_cmp_gt_i32 s68, 6
    s_cbranch_scc1 L_dw26_7
    s_cmp_gt_i32 s68, 5
    s_cbranch_scc1 L_dw26_6
    s_cmp_gt_i32 s68, 4
    s_cbranch_scc1 L_dw26_5
    s_waitcnt vmcnt(3)
L_dw26_5:
    s_waitcnt vmcnt(4)
L_dw26_6:
    s_waitcnt vmcnt(5)
L_dw26_7:
    s_waitcnt vmcnt(6)
L_dw26_8:
    s_waitcnt vmcnt(7)
    buffer_load_dwordx4 v[188:191], v1, s[32:35], s56 offen offset:256 nt
    s_add_u32 s56, s88, 1179648
    s_mov_b64 exec, 1
    ds_add_rtn_u32 v4, v2, v3 offset:8
    s_mov_b64 exec, -1
    s_waitcnt lgkmcnt(0)
    v_dot2c_f32_bf16 v36, v156, v16
    v_dot2c_f32_bf16 v36, v157, v17
    v_dot2c_f32_bf16 v36, v158, v18
    v_dot2c_f32_bf16 v36, v159, v19
    s_waitcnt lgkmcnt(0)
    v_readfirstlane_b32 s52, v4
    s_sub_u32 s68, s68, s69
    s_and_b32 s52, s52, 3
    s_lshl_b32 s52, s52, 3
    s_mov_b32 s69, 0x1000000
    s_lshr_b32 s69, s69, s52
    s_sext_i32_i8 s69, s69
    s_add_u32 s68, s68, s69
    s_cmp_gt_i32 s68, 7
    s_cbranch_scc1 L_dw27_8
    s_cmp_gt_i32 s68, 6
    s_cbranch_scc1 L_dw27_7
    s_cmp_gt_i32 s68, 5
    s_cbranch_scc1 L_dw27_6
    s_cmp_gt_i32 s68, 4
    s_cbranch_scc1 L_dw27_5
    s_waitcnt vmcnt(3)
L_dw27_5:
    s_waitcnt vmcnt(4)
L_dw27_6:
    s_waitcnt vmcnt(5)
L_dw27_7:
    s_waitcnt vmcnt(6)
L_dw27_8:
    s_waitcnt vmcnt(7)
    buffer_load_dwordx4 v[192:195], v1, s[32:35], s56 offen offset:0 nt
    v_dot2c_f32_bf16 v36, v160, v20
    v_dot2c_f32_bf16 v36, v161, v21
    v_dot2c_f32_bf16 v36, v162, v22
    v_dot2c_f32_bf16 v36, v163, v23
    s_cmp_gt_i32 s68, 7
    s_cbranch_scc1 L_dw28_8
    s_cmp_gt_i32 s68, 6
    s_cbranch_scc1 L_dw28_7
    s_cmp_gt_i32 s68, 5
    s_cbranch_scc1 L_dw28_6
    s_cmp_gt_i32 s68, 4
    s_cbranch_scc1 L_dw28_5
    s_waitcnt vmcnt(3)
L_dw28_5:
    s_waitcnt vmcnt(4)
L_dw28_6:
    s_waitcnt vmcnt(5)
L_dw28_7:
    s_waitcnt vmcnt(6)
L_dw28_8:
    s_waitcnt vmcnt(7)
    buffer_load_dwordx4 v[196:199], v1, s[32:35], s56 offen offset:128 nt
    v_dot2c_f32_bf16 v36, v164, v24
    v_dot2c_f32_bf16 v36, v165, v25
    v_dot2c_f32_bf16 v36, v166, v26
    v_dot2c_f32_bf16 v36, v167, v27
    s_nop 2
    v_add_f32_dpp v36, v36, v36 quad_perm:[1,0,3,2] row_mask:0xf bank_mask:0xf
    s_nop 1
    v_add_f32_dpp v36, v36, v36 quad_perm:[2,3,0,1] row_mask:0xf bank_mask:0xf
    s_nop 1
    v_add_f32_dpp v36, v36, v36 row_half_mirror row_mask:0xf bank_mask:0xf
    v_cvt_pk_bf16_f32 v36, 0, v36
    v_mul_f32 v36, 0x3d93cd3a, v36
    v_cvt_pk_bf16_f32 v36, 0, v36
    s_cmp_gt_i32 s68, 7
    s_cbranch_scc1 L_dw29_8
    s_cmp_gt_i32 s68, 6
    s_cbranch_scc1 L_dw29_7
    s_cmp_gt_i32 s68, 5
    s_cbranch_scc1 L_dw29_6
    s_cmp_gt_i32 s68, 4
    s_cbranch_scc1 L_dw29_5
    s_waitcnt vmcnt(3)
L_dw29_5:
    s_waitcnt vmcnt(4)
L_dw29_6:
    s_waitcnt vmcnt(5)
L_dw29_7:
    s_waitcnt vmcnt(6)
L_dw29_8:
    s_waitcnt vmcnt(7)
    buffer_load_dwordx4 v[200:203], v1, s[32:35], s56 offen offset:256 nt
    s_add_u32 s56, s87, 0
    ds_read_b32 v5, v2 offset:4
    v_dot2c_f32_bf16 v37, v168, v16
    v_dot2c_f32_bf16 v37, v169, v17
    v_dot2c_f32_bf16 v37, v170, v18
    v_dot2c_f32_bf16 v37, v171, v19
    s_waitcnt lgkmcnt(0)
    v_readfirstlane_b32 s68, v5
    s_add_u32 s68, s68, s69
    s_cmp_gt_i32 s68, 7
    s_cbranch_scc1 L_dw30_8
    s_cmp_gt_i32 s68, 6
    s_cbranch_scc1 L_dw30_7
    s_cmp_gt_i32 s68, 5
    s_cbranch_scc1 L_dw30_6
    s_cmp_gt_i32 s68, 4
    s_cbranch_scc1 L_dw30_5
    s_waitcnt vmcnt(3)
L_dw30_5:
    s_waitcnt vmcnt(4)
L_dw30_6:
    s_waitcnt vmcnt(5)
L_dw30_7:
    s_waitcnt vmcnt(6)
L_dw30_8:
    s_waitcnt vmcnt(7)
    buffer_load_dwordx4 v[204:207], v1, s[32:35], s56 offen offset:0 nt
    s_mov_b64 exec, 1
    ds_add_u32 v2, v3 offset:0
    s_mov_b64 exec, -1
    v_dot2c_f32_bf16 v37, v172, v20
    v_dot2c_f32_bf16 v37, v173, v21
    v_dot2c_f32_bf16 v37, v174, v22
    v_dot2c_f32_bf16 v37, v175, v23
    s_cmp_gt_i32 s68, 7
    s_cbranch_scc1 L_dw31_8
    s_cmp_gt_i32 s68, 6
    s_cbranch_scc1 L_dw31_7
    s_cmp_gt_i32 s68, 5
    s_cbranch_scc1 L_dw31_6
    s_cmp_gt_i32 s68, 4
    s_cbranch_scc1 L_dw31_5
    s_waitcnt vmcnt(3)
L_dw31_5:
    s_waitcnt vmcnt(4)
L_dw31_6:
    s_waitcnt vmcnt(5)
L_dw31_7:
    s_waitcnt vmcnt(6)
L_dw31_8:
    s_waitcnt vmcnt(7)
    buffer_load_dwordx4 v[208:211], v1, s[32:35], s56 offen offset:128 nt
    v_dot2c_f32_bf16 v37, v176, v24
    v_dot2c_f32_bf16 v37, v177, v25
    v_dot2c_f32_bf16 v37, v178, v26
    v_dot2c_f32_bf16 v37, v179, v27
    s_nop 2
    v_add_f32_dpp v37, v37, v37 quad_perm:[1,0,3,2] row_mask:0xf bank_mask:0xf
    s_nop 1
    v_add_f32_dpp v37, v37, v37 quad_perm:[2,3,0,1] row_mask:0xf bank_mask:0xf
    s_nop 1
    v_add_f32_dpp v37, v37, v37 row_half_mirror row_mask:0xf bank_mask:0xf
    v_cvt_pk_bf16_f32 v37, 0, v37
    v_mul_f32 v37, 0x3d93cd3a, v37
    v_cvt_pk_bf16_f32 v37, 0, v37
    s_cmp_gt_i32 s68, 7
    s_cbranch_scc1 L_dw32_8
    s_cmp_gt_i32 s68, 6
    s_cbranch_scc1 L_dw32_7
    s_cmp_gt_i32 s68, 5
    s_cbranch_scc1 L_dw32_6
    s_cmp_gt_i32 s68, 4
    s_cbranch_scc1 L_dw32_5
    s_waitcnt vmcnt(3)
L_dw32_5:
    s_waitcnt vmcnt(4)
L_dw32_6:
    s_waitcnt vmcnt(5)
L_dw32_7:
    s_waitcnt vmcnt(6)
L_dw32_8:
    s_waitcnt vmcnt(7)
    buffer_load_dwordx4 v[212:215], v1, s[32:35], s56 offen offset:256 nt
    s_add_u32 s56, s87, 393216
    s_mov_b64 exec, 1
    ds_add_rtn_u32 v4, v2, v3 offset:8
    s_mov_b64 exec, -1
    v_dot2c_f32_bf16 v38, v180, v16
    v_dot2c_f32_bf16 v38, v181, v17
    v_dot2c_f32_bf16 v38, v182, v18
    v_dot2c_f32_bf16 v38, v183, v19
    s_waitcnt lgkmcnt(0)
    v_readfirstlane_b32 s52, v4
    s_sub_u32 s68, s68, s69
    s_and_b32 s52, s52, 3
    s_lshl_b32 s52, s52, 3
    s_mov_b32 s69, 0x1000000
    s_lshr_b32 s69, s69, s52
    s_sext_i32_i8 s69, s69
    s_add_u32 s68, s68, s69
    s_cmp_gt_i32 s68, 7
    s_cbranch_scc1 L_dw33_8
    s_cmp_gt_i32 s68, 6
    s_cbranch_scc1 L_dw33_7
    s_cmp_gt_i32 s68, 5
    s_cbranch_scc1 L_dw33_6
    s_cmp_gt_i32 s68, 4
    s_cbranch_scc1 L_dw33_5
    s_waitcnt vmcnt(3)
L_dw33_5:
    s_waitcnt vmcnt(4)
L_dw33_6:
    s_waitcnt vmcnt(5)
L_dw33_7:
    s_waitcnt vmcnt(6)
L_dw33_8:
    s_waitcnt vmcnt(7)
    buffer_load_dwordx4 v[216:219], v1, s[32:35], s56 offen offset:0 nt
    ds_read_b32 v5, v2 offset:4
    v_dot2c_f32_bf16 v38, v184, v20
    v_dot2c_f32_bf16 v38, v185, v21
    v_dot2c_f32_bf16 v38, v186, v22
    v_dot2c_f32_bf16 v38, v187, v23
    s_waitcnt lgkmcnt(0)
    v_readfirstlane_b32 s68, v5
    s_add_u32 s68, s68, s69
    s_cmp_gt_i32 s68, 7
    s_cbranch_scc1 L_dw34_8
    s_cmp_gt_i32 s68, 6
    s_cbranch_scc1 L_dw34_7
    s_cmp_gt_i32 s68, 5
    s_cbranch_scc1 L_dw34_6
    s_cmp_gt_i32 s68, 4
    s_cbranch_scc1 L_dw34_5
    s_waitcnt vmcnt(3)
L_dw34_5:
    s_waitcnt vmcnt(4)
L_dw34_6:
    s_waitcnt vmcnt(5)
L_dw34_7:
    s_waitcnt vmcnt(6)
L_dw34_8:
    s_waitcnt vmcnt(7)
    buffer_load_dwordx4 v[220:223], v1, s[32:35], s56 offen offset:128 nt
    v_dot2c_f32_bf16 v38, v188, v24
    v_dot2c_f32_bf16 v38, v189, v25
    v_dot2c_f32_bf16 v38, v190, v26
    v_dot2c_f32_bf16 v38, v191, v27
    s_nop 2
    v_add_f32_dpp v38, v38, v38 quad_perm:[1,0,3,2] row_mask:0xf bank_mask:0xf
    s_nop 1
    v_add_f32_dpp v38, v38, v38 quad_perm:[2,3,0,1] row_mask:0xf bank_mask:0xf
    s_nop 1
    v_add_f32_dpp v38, v38, v38 row_half_mirror row_mask:0xf bank_mask:0xf
    v_cvt_pk_bf16_f32 v38, 0, v38
    v_mul_f32 v38, 0x3d93cd3a, v38
    v_cvt_pk_bf16_f32 v38, 0, v38
    s_cmp_gt_i32 s68, 7
    s_cbranch_scc1 L_dw35_8
    s_cmp_gt_i32 s68, 6
    s_cbranch_scc1 L_dw35_7
    s_cmp_gt_i32 s68, 5
    s_cbranch_scc1 L_dw35_6
    s_cmp_gt_i32 s68, 4
    s_cbranch_scc1 L_dw35_5
    s_waitcnt vmcnt(3)
L_dw35_5:
    s_waitcnt vmcnt(4)
L_dw35_6:
    s_waitcnt vmcnt(5)
L_dw35_7:
    s_waitcnt vmcnt(6)
L_dw35_8:
    s_waitcnt vmcnt(7)
    buffer_load_dwordx4 v[224:227], v1, s[32:35], s56 offen offset:256 nt
    s_add_u32 s56, s87, 786432
    v_dot2c_f32_bf16 v39, v192, v16
    v_dot2c_f32_bf16 v39, v193, v17
    v_dot2c_f32_bf16 v39, v194, v18
    v_dot2c_f32_bf16 v39, v195, v19
    s_cmp_gt_i32 s68, 7
    s_cbranch_scc1 L_dw36_8
    s_cmp_gt_i32 s68, 6
    s_cbranch_scc1 L_dw36_7
    s_cmp_gt_i32 s68, 5
    s_cbranch_scc1 L_dw36_6
    s_cmp_gt_i32 s68, 4
    s_cbranch_scc1 L_dw36_5
    s_waitcnt vmcnt(3)
L_dw36_5:
    s_waitcnt vmcnt(4)
L_dw36_6:
    s_waitcnt vmcnt(5)
L_dw36_7:
    s_waitcnt vmcnt(6)
L_dw36_8:
    s_waitcnt vmcnt(7)
    buffer_load_dwordx4 v[228:231], v1, s[32:35], s56 offen offset:0 nt
    v_dot2c_f32_bf16 v39, v196, v20
    v_dot2c_f32_bf16 v39, v197, v21
    v_dot2c_f32_bf16 v39, v198, v22
    v_dot2c_f32_bf16 v39, v199, v23
    s_cmp_gt_i32 s68, 7
    s_cbranch_scc1 L_dw37_8
    s_cmp_gt_i32 s68, 6
    s_cbranch_scc1 L_dw37_7
    s_cmp_gt_i32 s68, 5
    s_cbranch_scc1 L_dw37_6
    s_cmp_gt_i32 s68, 4
    s_cbranch_scc1 L_dw37_5
    s_waitcnt vmcnt(3)
L_dw37_5:
    s_waitcnt vmcnt(4)
L_dw37_6:
    s_waitcnt vmcnt(5)
L_dw37_7:
    s_waitcnt vmcnt(6)
L_dw37_8:
    s_waitcnt vmcnt(7)
    buffer_load_dwordx4 v[232:235], v1, s[32:35], s56 offen offset:128 nt
    ds_read_b32 v5, v2 offset:4
    v_dot2c_f32_bf16 v39, v200, v24
    v_dot2c_f32_bf16 v39, v201, v25
    v_dot2c_f32_bf16 v39, v202, v26
    v_dot2c_f32_bf16 v39, v203, v27
    ds_read_b128 v[16:19], v253 offset:3712
    ds_read_b128 v[20:23], v253 offset:3840
    ds_read_b128 v[24:27], v253 offset:3968
    v_add_f32_dpp v39, v39, v39 quad_perm:[1,0,3,2] row_mask:0xf bank_mask:0xf
    s_nop 1
    v_add_f32_dpp v39, v39, v39 quad_perm:[2,3,0,1] row_mask:0xf bank_mask:0xf
    s_nop 1
    v_add_f32_dpp v39, v39, v39 row_half_mirror row_mask:0xf bank_mask:0xf
    v_cvt_pk_bf16_f32 v39, 0, v39
    v_mul_f32 v39, 0x3d93cd3a, v39
    v_cvt_pk_bf16_f32 v39, 0, v39
    s_waitcnt lgkmcnt(0)
    v_readfirstlane_b32 s68, v5
    s_add_u32 s68, s68, s69
    s_cmp_gt_i32 s68, 7
    s_cbranch_scc1 L_dw38_8
    s_cmp_gt_i32 s68, 6
    s_cbranch_scc1 L_dw38_7
    s_cmp_gt_i32 s68, 5
    s_cbranch_scc1 L_dw38_6
    s_cmp_gt_i32 s68, 4
    s_cbranch_scc1 L_dw38_5
    s_waitcnt vmcnt(3)
L_dw38_5:
    s_waitcnt vmcnt(4)
L_dw38_6:
    s_waitcnt vmcnt(5)
L_dw38_7:
    s_waitcnt vmcnt(6)
L_dw38_8:
    s_waitcnt vmcnt(7)
    buffer_load_dwordx4 v[236:239], v1, s[32:35], s56 offen offset:256 nt
    s_add_u32 s56, s87, 1179648
    s_mov_b64 exec, 1
    ds_add_rtn_u32 v4, v2, v3 offset:8
    s_mov_b64 exec, -1
    s_mov_b64 exec, 1
    ds_add_u32 v2, v3 offset:0
    s_mov_b64 exec, -1
    s_waitcnt lgkmcnt(0)
    v_dot2c_f32_bf16 v32, v204, v16
    v_dot2c_f32_bf16 v32, v205, v17
    v_dot2c_f32_bf16 v32, v206, v18
    v_dot2c_f32_bf16 v32, v207, v19
    s_waitcnt lgkmcnt(0)
    v_readfirstlane_b32 s52, v4
    s_sub_u32 s68, s68, s69
    s_and_b32 s52, s52, 3
    s_lshl_b32 s52, s52, 3
    s_mov_b32 s69, 0x1000000
    s_lshr_b32 s69, s69, s52
    s_sext_i32_i8 s69, s69
    s_add_u32 s68, s68, s69
    s_cmp_gt_i32 s68, 7
    s_cbranch_scc1 L_dw39_8
    s_cmp_gt_i32 s68, 6
    s_cbranch_scc1 L_dw39_7
    s_cmp_gt_i32 s68, 5
    s_cbranch_scc1 L_dw39_6
    s_cmp_gt_i32 s68, 4
    s_cbranch_scc1 L_dw39_5
    s_waitcnt vmcnt(3)
L_dw39_5:
    s_waitcnt vmcnt(4)
L_dw39_6:
    s_waitcnt vmcnt(5)
L_dw39_7:
    s_waitcnt vmcnt(6)
L_dw39_8:
    s_waitcnt vmcnt(7)
    buffer_load_dwordx4 v[240:243], v1, s[32:35], s56 offen offset:0 nt
    v_dot2c_f32_bf16 v32, v208, v20
    v_dot2c_f32_bf16 v32, v209, v21
    v_dot2c_f32_bf16 v32, v210, v22
    v_dot2c_f32_bf16 v32, v211, v23
    s_cmp_gt_i32 s68, 7
    s_cbranch_scc1 L_dw40_8
    s_cmp_gt_i32 s68, 6
    s_cbranch_scc1 L_dw40_7
    s_cmp_gt_i32 s68, 5
    s_cbranch_scc1 L_dw40_6
    s_cmp_gt_i32 s68, 4
    s_cbranch_scc1 L_dw40_5
    s_waitcnt vmcnt(3)
L_dw40_5:
    s_waitcnt vmcnt(4)
L_dw40_6:
    s_waitcnt vmcnt(5)
L_dw40_7:
    s_waitcnt vmcnt(6)
L_dw40_8:
    s_waitcnt vmcnt(7)
    buffer_load_dwordx4 v[244:247], v1, s[32:35], s56 offen offset:128 nt
    v_dot2c_f32_bf16 v32, v212, v24
    v_dot2c_f32_bf16 v32, v213, v25
    v_dot2c_f32_bf16 v32, v214, v26
    v_dot2c_f32_bf16 v32, v215, v27
    s_nop 2
    v_add_f32_dpp v32, v32, v32 quad_perm:[1,0,3,2] row_mask:0xf bank_mask:0xf
    s_nop 1
    v_add_f32_dpp v32, v32, v32 quad_perm:[2,3,0,1] row_mask:0xf bank_mask:0xf
    s_nop 1
    v_add_f32_dpp v32, v32, v32 row_half_mirror row_mask:0xf bank_mask:0xf
    v_cvt_pk_bf16_f32 v32, 0, v32
    v_mul_f32 v32, 0x3d93cd3a, v32
    v_cvt_pk_bf16_f32 v32, 0, v32
    s_cmp_gt_i32 s68, 7
    s_cbranch_scc1 L_dw41_8
    s_cmp_gt_i32 s68, 6
    s_cbranch_scc1 L_dw41_7
    s_cmp_gt_i32 s68, 5
    s_cbranch_scc1 L_dw41_6
    s_cmp_gt_i32 s68, 4
    s_cbranch_scc1 L_dw41_5
    s_waitcnt vmcnt(3)
L_dw41_5:
    s_waitcnt vmcnt(4)
L_dw41_6:
    s_waitcnt vmcnt(5)
L_dw41_7:
    s_waitcnt vmcnt(6)
L_dw41_8:
    s_waitcnt vmcnt(7)
    buffer_load_dwordx4 v[248:251], v1, s[32:35], s56 offen offset:256 nt
    s_add_u32 s56, s86, 0
    ds_read_b32 v5, v2 offset:4
    v_dot2c_f32_bf16 v33, v216, v16
    v_dot2c_f32_bf16 v33, v217, v17
    v_dot2c_f32_bf16 v33, v218, v18
    v_dot2c_f32_bf16 v33, v219, v19
    s_waitcnt lgkmcnt(0)
    v_readfirstlane_b32 s68, v5
    s_add_u32 s68, s68, s69
    s_cmp_gt_i32 s68, 7
    s_cbranch_scc1 L_dw42_8
    s_cmp_gt_i32 s68, 6
    s_cbranch_scc1 L_dw42_7
    s_cmp_gt_i32 s68, 5
    s_cbranch_scc1 L_dw42_6
    s_cmp_gt_i32 s68, 4
    s_cbranch_scc1 L_dw42_5
    s_waitcnt vmcnt(3)
L_dw42_5:
    s_waitcnt vmcnt(4)
L_dw42_6:
    s_waitcnt vmcnt(5)
L_dw42_7:
    s_waitcnt vmcnt(6)
L_dw42_8:
    s_waitcnt vmcnt(7)
    buffer_load_dwordx4 v[84:87], v1, s[32:35], s56 offen offset:0 nt
    v_dot2c_f32_bf16 v33, v220, v20
    v_dot2c_f32_bf16 v33, v221, v21
    v_dot2c_f32_bf16 v33, v222, v22
    v_dot2c_f32_bf16 v33, v223, v23
    s_cmp_gt_i32 s68, 7
    s_cbranch_scc1 L_dw43_8
    s_cmp_gt_i32 s68, 6
    s_cbranch_scc1 L_dw43_7
    s_cmp_gt_i32 s68, 5
    s_cbranch_scc1 L_dw43_6
    s_cmp_gt_i32 s68, 4
    s_cbranch_scc1 L_dw43_5
    s_waitcnt vmcnt(3)
L_dw43_5:
    s_waitcnt vmcnt(4)
L_dw43_6:
    s_waitcnt vmcnt(5)
L_dw43_7:
    s_waitcnt vmcnt(6)
L_dw43_8:
    s_waitcnt vmcnt(7)
    buffer_load_dwordx4 v[88:91], v1, s[32:35], s56 offen offset:128 nt
    v_dot2c_f32_bf16 v33, v224, v24
    v_dot2c_f32_bf16 v33, v225, v25
    v_dot2c_f32_bf16 v33, v226, v26
    v_dot2c_f32_bf16 v33, v227, v27
    s_nop 2
    v_add_f32_dpp v33, v33, v33 quad_perm:[1,0,3,2] row_mask:0xf bank_mask:0xf
    s_nop 1
    v_add_f32_dpp v33, v33, v33 quad_perm:[2,3,0,1] row_mask:0xf bank_mask:0xf
    s_nop 1
    v_add_f32_dpp v33, v33, v33 row_half_mirror row_mask:0xf bank_mask:0xf
    v_cvt_pk_bf16_f32 v33, 0, v33
    v_mul_f32 v33, 0x3d93cd3a, v33
    v_cvt_pk_bf16_f32 v33, 0, v33
    s_cmp_gt_i32 s68, 7
    s_cbranch_scc1 L_dw44_8
    s_cmp_gt_i32 s68, 6
    s_cbranch_scc1 L_dw44_7
    s_cmp_gt_i32 s68, 5
    s_cbranch_scc1 L_dw44_6
    s_cmp_gt_i32 s68, 4
    s_cbranch_scc1 L_dw44_5
    s_waitcnt vmcnt(3)
L_dw44_5:
    s_waitcnt vmcnt(4)
L_dw44_6:
    s_waitcnt vmcnt(5)
L_dw44_7:
    s_waitcnt vmcnt(6)
L_dw44_8:
    s_waitcnt vmcnt(7)
    buffer_load_dwordx4 v[92:95], v1, s[32:35], s56 offen offset:256 nt
    s_add_u32 s56, s86, 393216
    s_mov_b64 exec, 1
    ds_add_rtn_u32 v4, v2, v3 offset:8
    s_mov_b64 exec, -1
    v_dot2c_f32_bf16 v34, v228, v16
    v_dot2c_f32_bf16 v34, v229, v17
    v_dot2c_f32_bf16 v34, v230, v18
    v_dot2c_f32_bf16 v34, v231, v19
    s_waitcnt lgkmcnt(0)
    v_readfirstlane_b32 s52, v4
    s_sub_u32 s68, s68, s69
    s_and_b32 s52, s52, 3
    s_lshl_b32 s52, s52, 3
    s_mov_b32 s69, 0x1000000
    s_lshr_b32 s69, s69, s52
    s_sext_i32_i8 s69, s69
    s_add_u32 s68, s68, s69
    s_cmp_gt_i32 s68, 7
    s_cbranch_scc1 L_dw45_8
    s_cmp_gt_i32 s68, 6
    s_cbranch_scc1 L_dw45_7
    s_cmp_gt_i32 s68, 5
    s_cbranch_scc1 L_dw45_6
    s_cmp_gt_i32 s68, 4
    s_cbranch_scc1 L_dw45_5
    s_waitcnt vmcnt(3)
L_dw45_5:
    s_waitcnt vmcnt(4)
L_dw45_6:
    s_waitcnt vmcnt(5)
L_dw45_7:
    s_waitcnt vmcnt(6)
L_dw45_8:
    s_waitcnt vmcnt(7)
    buffer_load_dwordx4 v[96:99], v1, s[32:35], s56 offen offset:0 nt
    ds_read_b32 v5, v2 offset:4
    v_dot2c_f32_bf16 v34, v232, v20
    v_dot2c_f32_bf16 v34, v233, v21
    v_dot2c_f32_bf16 v34, v234, v22
    v_dot2c_f32_bf16 v34, v235, v23
    s_waitcnt lgkmcnt(0)
    v_readfirstlane_b32 s68, v5
    s_add_u32 s68, s68, s69
    s_cmp_gt_i32 s68, 7
    s_cbranch_scc1 L_dw46_8
    s_cmp_gt_i32 s68, 6
    s_cbranch_scc1 L_dw46_7
    s_cmp_gt_i32 s68, 5
    s_cbranch_scc1 L_dw46_6
    s_cmp_gt_i32 s68, 4
    s_cbranch_scc1 L_dw46_5
    s_waitcnt vmcnt(3)
L_dw46_5:
    s_waitcnt vmcnt(4)
L_dw46_6:
    s_waitcnt vmcnt(5)
L_dw46_7:
    s_waitcnt vmcnt(6)
L_dw46_8:
    s_waitcnt vmcnt(7)
    buffer_load_dwordx4 v[100:103], v1, s[32:35], s56 offen offset:128 nt
    s_mov_b64 exec, 1
    ds_add_u32 v2, v3 offset:0
    s_mov_b64 exec, -1
    v_dot2c_f32_bf16 v34, v236, v24
    v_dot2c_f32_bf16 v34, v237, v25
    v_dot2c_f32_bf16 v34, v238, v26
    v_dot2c_f32_bf16 v34, v239, v27
    s_nop 2
    v_add_f32_dpp v34, v34, v34 quad_perm:[1,0,3,2] row_mask:0xf bank_mask:0xf
    s_nop 1
    v_add_f32_dpp v34, v34, v34 quad_perm:[2,3,0,1] row_mask:0xf bank_mask:0xf
    s_nop 1
    v_add_f32_dpp v34, v34, v34 row_half_mirror row_mask:0xf bank_mask:0xf
    v_cvt_pk_bf16_f32 v34, 0, v34
    v_mul_f32 v34, 0x3d93cd3a, v34
    v_cvt_pk_bf16_f32 v34, 0, v34
    s_cmp_gt_i32 s68, 7
    s_cbranch_scc1 L_dw47_8
    s_cmp_gt_i32 s68, 6
    s_cbranch_scc1 L_dw47_7
    s_cmp_gt_i32 s68, 5
    s_cbranch_scc1 L_dw47_6
    s_cmp_gt_i32 s68, 4
    s_cbranch_scc1 L_dw47_5
    s_waitcnt vmcnt(3)
L_dw47_5:
    s_waitcnt vmcnt(4)
L_dw47_6:
    s_waitcnt vmcnt(5)
L_dw47_7:
    s_waitcnt vmcnt(6)
L_dw47_8:
    s_waitcnt vmcnt(7)
    buffer_load_dwordx4 v[104:107], v1, s[32:35], s56 offen offset:256 nt
    s_add_u32 s56, s86, 786432
    v_dot2c_f32_bf16 v35, v240, v16
    v_dot2c_f32_bf16 v35, v241, v17
    v_dot2c_f32_bf16 v35, v242, v18
    v_dot2c_f32_bf16 v35, v243, v19
    s_cmp_gt_i32 s68, 7
    s_cbranch_scc1 L_dw48_8
    s_cmp_gt_i32 s68, 6
    s_cbranch_scc1 L_dw48_7
    s_cmp_gt_i32 s68, 5
    s_cbranch_scc1 L_dw48_6
    s_cmp_gt_i32 s68, 4
    s_cbranch_scc1 L_dw48_5
    s_waitcnt vmcnt(3)
L_dw48_5:
    s_waitcnt vmcnt(4)
L_dw48_6:
    s_waitcnt vmcnt(5)
L_dw48_7:
    s_waitcnt vmcnt(6)
L_dw48_8:
    s_waitcnt vmcnt(7)
    buffer_load_dwordx4 v[108:111], v1, s[32:35], s56 offen offset:0 nt
    v_dot2c_f32_bf16 v35, v244, v20
    v_dot2c_f32_bf16 v35, v245, v21
    v_dot2c_f32_bf16 v35, v246, v22
    v_dot2c_f32_bf16 v35, v247, v23
    s_cmp_gt_i32 s68, 7
    s_cbranch_scc1 L_dw49_8
    s_cmp_gt_i32 s68, 6
    s_cbranch_scc1 L_dw49_7
    s_cmp_gt_i32 s68, 5
    s_cbranch_scc1 L_dw49_6
    s_cmp_gt_i32 s68, 4
    s_cbranch_scc1 L_dw49_5
    s_waitcnt vmcnt(3)
L_dw49_5:
    s_waitcnt vmcnt(4)
L_dw49_6:
    s_waitcnt vmcnt(5)
L_dw49_7:
    s_waitcnt vmcnt(6)
L_dw49_8:
    s_waitcnt vmcnt(7)
    buffer_load_dwordx4 v[112:115], v1, s[32:35], s56 offen offset:128 nt
    ds_read_b32 v5, v2 offset:4
    v_dot2c_f32_bf16 v35, v248, v24
    v_dot2c_f32_bf16 v35, v249, v25
    v_dot2c_f32_bf16 v35, v250, v26
    v_dot2c_f32_bf16 v35, v251, v27
    ds_read_b128 v[16:19], v253 offset:3328
    ds_read_b128 v[20:23], v253 offset:3456
    ds_read_b128 v[24:27], v253 offset:3584
    v_add_f32_dpp v35, v35, v35 quad_perm:[1,0,3,2] row_mask:0xf bank_mask:0xf
    s_nop 1
    v_add_f32_dpp v35, v35, v35 quad_perm:[2,3,0,1] row_mask:0xf bank_mask:0xf
    s_nop 1
    v_add_f32_dpp v35, v35, v35 row_half_mirror row_mask:0xf bank_mask:0xf
    v_cvt_pk_bf16_f32 v35, 0, v35
    v_mul_f32 v35, 0x3d93cd3a, v35
    v_cvt_pk_bf16_f32 v35, 0, v35
    s_waitcnt lgkmcnt(0)
    v_readfirstlane_b32 s68, v5
    s_add_u32 s68, s68, s69
    s_cmp_gt_i32 s68, 7
    s_cbranch_scc1 L_dw50_8
    s_cmp_gt_i32 s68, 6
    s_cbranch_scc1 L_dw50_7
    s_cmp_gt_i32 s68, 5
    s_cbranch_scc1 L_dw50_6
    s_cmp_gt_i32 s68, 4
    s_cbranch_scc1 L_dw50_5
    s_waitcnt vmcnt(3)
L_dw50_5:
    s_waitcnt vmcnt(4)
L_dw50_6:
    s_waitcnt vmcnt(5)
L_dw50_7:
    s_waitcnt vmcnt(6)
L_dw50_8:
    s_waitcnt vmcnt(7)
    buffer_load_dwordx4 v[116:119], v1, s[32:35], s56 offen offset:256 nt
    s_add_u32 s56, s86, 1179648
    s_mov_b64 exec, 1
    ds_add_rtn_u32 v4, v2, v3 offset:8
    s_mov_b64 exec, -1
    s_waitcnt lgkmcnt(0)
    v_dot2c_f32_bf16 v28, v84, v16
    v_dot2c_f32_bf16 v28, v85, v17
    v_dot2c_f32_bf16 v28, v86, v18
    v_dot2c_f32_bf16 v28, v87, v19
    s_waitcnt lgkmcnt(0)
    v_readfirstlane_b32 s52, v4
    s_sub_u32 s68, s68, s69
    s_and_b32 s52, s52, 3
    s_lshl_b32 s52, s52, 3
    s_mov_b32 s69, 0x1000000
    s_lshr_b32 s69, s69, s52
    s_sext_i32_i8 s69, s69
    s_add_u32 s68, s68, s69
    s_cmp_gt_i32 s68, 7
    s_cbranch_scc1 L_dw51_8
    s_cmp_gt_i32 s68, 6
    s_cbranch_scc1 L_dw51_7
    s_cmp_gt_i32 s68, 5
    s_cbranch_scc1 L_dw51_6
    s_cmp_gt_i32 s68, 4
    s_cbranch_scc1 L_dw51_5
    s_waitcnt vmcnt(3)
L_dw51_5:
    s_waitcnt vmcnt(4)
L_dw51_6:
    s_waitcnt vmcnt(5)
L_dw51_7:
    s_waitcnt vmcnt(6)
L_dw51_8:
    s_waitcnt vmcnt(7)
    buffer_load_dwordx4 v[120:123], v1, s[32:35], s56 offen offset:0 nt
    v_dot2c_f32_bf16 v28, v88, v20
    v_dot2c_f32_bf16 v28, v89, v21
    v_dot2c_f32_bf16 v28, v90, v22
    v_dot2c_f32_bf16 v28, v91, v23
    s_cmp_gt_i32 s68, 7
    s_cbranch_scc1 L_dw52_8
    s_cmp_gt_i32 s68, 6
    s_cbranch_scc1 L_dw52_7
    s_cmp_gt_i32 s68, 5
    s_cbranch_scc1 L_dw52_6
    s_cmp_gt_i32 s68, 4
    s_cbranch_scc1 L_dw52_5
    s_waitcnt vmcnt(3)
L_dw52_5:
    s_waitcnt vmcnt(4)
L_dw52_6:
    s_waitcnt vmcnt(5)
L_dw52_7:
    s_waitcnt vmcnt(6)
L_dw52_8:
    s_waitcnt vmcnt(7)
    buffer_load_dwordx4 v[124:127], v1, s[32:35], s56 offen offset:128 nt
    v_dot2c_f32_bf16 v28, v92, v24
    v_dot2c_f32_bf16 v28, v93, v25
    v_dot2c_f32_bf16 v28, v94, v26
    v_dot2c_f32_bf16 v28, v95, v27
    s_nop 2
    v_add_f32_dpp v28, v28, v28 quad_perm:[1,0,3,2] row_mask:0xf bank_mask:0xf
    s_nop 1
    v_add_f32_dpp v28, v28, v28 quad_perm:[2,3,0,1] row_mask:0xf bank_mask:0xf
    s_nop 1
    v_add_f32_dpp v28, v28, v28 row_half_mirror row_mask:0xf bank_mask:0xf
    v_cvt_pk_bf16_f32 v28, 0, v28
    v_mul_f32 v28, 0x3d93cd3a, v28
    v_cvt_pk_bf16_f32 v28, 0, v28
    s_cmp_gt_i32 s68, 7
    s_cbranch_scc1 L_dw53_8
    s_cmp_gt_i32 s68, 6
    s_cbranch_scc1 L_dw53_7
    s_cmp_gt_i32 s68, 5
    s_cbranch_scc1 L_dw53_6
    s_cmp_gt_i32 s68, 4
    s_cbranch_scc1 L_dw53_5
    s_waitcnt vmcnt(3)
L_dw53_5:
    s_waitcnt vmcnt(4)
L_dw53_6:
    s_waitcnt vmcnt(5)
L_dw53_7:
    s_waitcnt vmcnt(6)
L_dw53_8:
    s_waitcnt vmcnt(7)
    buffer_load_dwordx4 v[128:131], v1, s[32:35], s56 offen offset:256 nt
    s_add_u32 s56, s86, 0
    ds_read_b32 v5, v2 offset:4
    v_dot2c_f32_bf16 v29, v96, v16
    v_dot2c_f32_bf16 v29, v97, v17
    v_dot2c_f32_bf16 v29, v98, v18
    v_dot2c_f32_bf16 v29, v99, v19
    s_waitcnt lgkmcnt(0)
    v_readfirstlane_b32 s68, v5
    s_add_u32 s68, s68, s69
    s_cmp_gt_i32 s68, 7
    s_cbranch_scc1 L_dw54_8
    s_cmp_gt_i32 s68, 6
    s_cbranch_scc1 L_dw54_7
    s_cmp_gt_i32 s68, 5
    s_cbranch_scc1 L_dw54_6
    s_cmp_gt_i32 s68, 4
    s_cbranch_scc1 L_dw54_5
    s_waitcnt vmcnt(3)
L_dw54_5:
    s_waitcnt vmcnt(4)
L_dw54_6:
    s_waitcnt vmcnt(5)
L_dw54_7:
    s_waitcnt vmcnt(6)
L_dw54_8:
    s_waitcnt vmcnt(7)
    buffer_load_dwordx4 v[132:135], v1, s[36:39], s56 offen offset:0 nt
    s_mov_b64 exec, 1
    ds_add_u32 v2, v3 offset:0
    s_mov_b64 exec, -1
    v_dot2c_f32_bf16 v29, v100, v20
    v_dot2c_f32_bf16 v29, v101, v21
    v_dot2c_f32_bf16 v29, v102, v22
    v_dot2c_f32_bf16 v29, v103, v23
    s_cmp_gt_i32 s68, 7
    s_cbranch_scc1 L_dw55_8
    s_cmp_gt_i32 s68, 6
    s_cbranch_scc1 L_dw55_7
    s_cmp_gt_i32 s68, 5
    s_cbranch_scc1 L_dw55_6
    s_cmp_gt_i32 s68, 4
    s_cbranch_scc1 L_dw55_5
    s_waitcnt vmcnt(3)
L_dw55_5:
    s_waitcnt vmcnt(4)
L_dw55_6:
    s_waitcnt vmcnt(5)
L_dw55_7:
    s_waitcnt vmcnt(6)
L_dw55_8:
    s_waitcnt vmcnt(7)
    buffer_load_dwordx4 v[136:139], v1, s[36:39], s56 offen offset:128 nt
    v_dot2c_f32_bf16 v29, v104, v24
    v_dot2c_f32_bf16 v29, v105, v25
    v_dot2c_f32_bf16 v29, v106, v26
    v_dot2c_f32_bf16 v29, v107, v27
    s_nop 2
    v_add_f32_dpp v29, v29, v29 quad_perm:[1,0,3,2] row_mask:0xf bank_mask:0xf
    s_nop 1
    v_add_f32_dpp v29, v29, v29 quad_perm:[2,3,0,1] row_mask:0xf bank_mask:0xf
    s_nop 1
    v_add_f32_dpp v29, v29, v29 row_half_mirror row_mask:0xf bank_mask:0xf
    v_cvt_pk_bf16_f32 v29, 0, v29
    v_mul_f32 v29, 0x3d93cd3a, v29
    v_cvt_pk_bf16_f32 v29, 0, v29
    s_cmp_gt_i32 s68, 7
    s_cbranch_scc1 L_dw56_8
    s_cmp_gt_i32 s68, 6
    s_cbranch_scc1 L_dw56_7
    s_cmp_gt_i32 s68, 5
    s_cbranch_scc1 L_dw56_6
    s_cmp_gt_i32 s68, 4
    s_cbranch_scc1 L_dw56_5
    s_waitcnt vmcnt(3)
L_dw56_5:
    s_waitcnt vmcnt(4)
L_dw56_6:
    s_waitcnt vmcnt(5)
L_dw56_7:
    s_waitcnt vmcnt(6)
L_dw56_8:
    s_waitcnt vmcnt(7)
    buffer_load_dwordx4 v[140:143], v1, s[36:39], s56 offen offset:256 nt
    s_add_u32 s56, s86, 393216
    s_mov_b64 exec, 1
    ds_add_rtn_u32 v4, v2, v3 offset:8
    s_mov_b64 exec, -1
    v_dot2c_f32_bf16 v30, v108, v16
    v_dot2c_f32_bf16 v30, v109, v17
    v_dot2c_f32_bf16 v30, v110, v18
    v_dot2c_f32_bf16 v30, v111, v19
    s_waitcnt lgkmcnt(0)
    v_readfirstlane_b32 s52, v4
    s_sub_u32 s68, s68, s69
    s_and_b32 s52, s52, 3
    s_lshl_b32 s52, s52, 3
    s_mov_b32 s69, 0x1000000
    s_lshr_b32 s69, s69, s52
    s_sext_i32_i8 s69, s69
    s_add_u32 s68, s68, s69
    s_cmp_gt_i32 s68, 7
    s_cbranch_scc1 L_dw57_8
    s_cmp_gt_i32 s68, 6
    s_cbranch_scc1 L_dw57_7
    s_cmp_gt_i32 s68, 5
    s_cbranch_scc1 L_dw57_6
    s_cmp_gt_i32 s68, 4
    s_cbranch_scc1 L_dw57_5
    s_waitcnt vmcnt(3)
L_dw57_5:
    s_waitcnt vmcnt(4)
L_dw57_6:
    s_waitcnt vmcnt(5)
L_dw57_7:
    s_waitcnt vmcnt(6)
L_dw57_8:
    s_waitcnt vmcnt(7)
    buffer_load_dwordx4 v[144:147], v1, s[36:39], s56 offen offset:0 nt
    ds_read_b32 v5, v2 offset:4
    v_dot2c_f32_bf16 v30, v112, v20
    v_dot2c_f32_bf16 v30, v113, v21
    v_dot2c_f32_bf16 v30, v114, v22
    v_dot2c_f32_bf16 v30, v115, v23
    s_waitcnt lgkmcnt(0)
    v_readfirstlane_b32 s68, v5
    s_add_u32 s68, s68, s69
    s_cmp_gt_i32 s68, 7
    s_cbranch_scc1 L_dw58_8
    s_cmp_gt_i32 s68, 6
    s_cbranch_scc1 L_dw58_7
    s_cmp_gt_i32 s68, 5
    s_cbranch_scc1 L_dw58_6
    s_cmp_gt_i32 s68, 4
    s_cbranch_scc1 L_dw58_5
    s_waitcnt vmcnt(3)
L_dw58_5:
    s_waitcnt vmcnt(4)
L_dw58_6:
    s_waitcnt vmcnt(5)
L_dw58_7:
    s_waitcnt vmcnt(6)
L_dw58_8:
    s_waitcnt vmcnt(7)
    buffer_load_dwordx4 v[148:151], v1, s[36:39], s56 offen offset:128 nt
    v_dot2c_f32_bf16 v30, v116, v24
    v_dot2c_f32_bf16 v30, v117, v25
    v_dot2c_f32_bf16 v30, v118, v26
    v_dot2c_f32_bf16 v30, v119, v27
    s_nop 2
    v_add_f32_dpp v30, v30, v30 quad_perm:[1,0,3,2] row_mask:0xf bank_mask:0xf
    s_nop 1
    v_add_f32_dpp v30, v30, v30 quad_perm:[2,3,0,1] row_mask:0xf bank_mask:0xf
    s_nop 1
    v_add_f32_dpp v30, v30, v30 row_half_mirror row_mask:0xf bank_mask:0xf
    v_cvt_pk_bf16_f32 v30, 0, v30
    v_mul_f32 v30, 0x3d93cd3a, v30
    v_cvt_pk_bf16_f32 v30, 0, v30
    s_cmp_gt_i32 s68, 7
    s_cbranch_scc1 L_dw59_8
    s_cmp_gt_i32 s68, 6
    s_cbranch_scc1 L_dw59_7
    s_cmp_gt_i32 s68, 5
    s_cbranch_scc1 L_dw59_6
    s_cmp_gt_i32 s68, 4
    s_cbranch_scc1 L_dw59_5
    s_waitcnt vmcnt(3)
L_dw59_5:
    s_waitcnt vmcnt(4)
L_dw59_6:
    s_waitcnt vmcnt(5)
L_dw59_7:
    s_waitcnt vmcnt(6)
L_dw59_8:
    s_waitcnt vmcnt(7)
    buffer_load_dwordx4 v[152:155], v1, s[36:39], s56 offen offset:256 nt
    s_add_u32 s56, s86, 786432
    v_dot2c_f32_bf16 v31, v120, v16
    v_dot2c_f32_bf16 v31, v121, v17
    v_dot2c_f32_bf16 v31, v122, v18
    v_dot2c_f32_bf16 v31, v123, v19
    s_cmp_gt_i32 s68, 7
    s_cbranch_scc1 L_dw60_8
    s_cmp_gt_i32 s68, 6
    s_cbranch_scc1 L_dw60_7
    s_cmp_gt_i32 s68, 5
    s_cbranch_scc1 L_dw60_6
    s_cmp_gt_i32 s68, 4
    s_cbranch_scc1 L_dw60_5
    s_waitcnt vmcnt(3)
L_dw60_5:
    s_waitcnt vmcnt(4)
L_dw60_6:
    s_waitcnt vmcnt(5)
L_dw60_7:
    s_waitcnt vmcnt(6)
L_dw60_8:
    s_waitcnt vmcnt(7)
    buffer_load_dwordx4 v[156:159], v1, s[36:39], s56 offen offset:0 nt
    v_dot2c_f32_bf16 v31, v124, v20
    v_dot2c_f32_bf16 v31, v125, v21
    v_dot2c_f32_bf16 v31, v126, v22
    v_dot2c_f32_bf16 v31, v127, v23
    s_cmp_gt_i32 s68, 7
    s_cbranch_scc1 L_dw61_8
    s_cmp_gt_i32 s68, 6
    s_cbranch_scc1 L_dw61_7
    s_cmp_gt_i32 s68, 5
    s_cbranch_scc1 L_dw61_6
    s_cmp_gt_i32 s68, 4
    s_cbranch_scc1 L_dw61_5
    s_waitcnt vmcnt(3)
L_dw61_5:
    s_waitcnt vmcnt(4)
L_dw61_6:
    s_waitcnt vmcnt(5)
L_dw61_7:
    s_waitcnt vmcnt(6)
L_dw61_8:
    s_waitcnt vmcnt(7)
    buffer_load_dwordx4 v[160:163], v1, s[36:39], s56 offen offset:128 nt
    ds_read_b32 v5, v2 offset:4
    v_dot2c_f32_bf16 v31, v128, v24
    v_dot2c_f32_bf16 v31, v129, v25
    v_dot2c_f32_bf16 v31, v130, v26
    v_dot2c_f32_bf16 v31, v131, v27
    s_nop 2
    v_add_f32_dpp v31, v31, v31 quad_perm:[1,0,3,2] row_mask:0xf bank_mask:0xf
    s_nop 1
    v_add_f32_dpp v31, v31, v31 quad_perm:[2,3,0,1] row_mask:0xf bank_mask:0xf
    s_nop 1
    v_add_f32_dpp v31, v31, v31 row_half_mirror row_mask:0xf bank_mask:0xf
    v_cvt_pk_bf16_f32 v31, 0, v31
    v_mul_f32 v31, 0x3d93cd3a, v31
    v_cvt_pk_bf16_f32 v31, 0, v31
    s_waitcnt lgkmcnt(0)
    v_readfirstlane_b32 s68, v5
    s_add_u32 s68, s68, s69
    s_cmp_gt_i32 s68, 7
    s_cbranch_scc1 L_dw62_8
    s_cmp_gt_i32 s68, 6
    s_cbranch_scc1 L_dw62_7
    s_cmp_gt_i32 s68, 5
    s_cbranch_scc1 L_dw62_6
    s_cmp_gt_i32 s68, 4
    s_cbranch_scc1 L_dw62_5
    s_waitcnt vmcnt(3)
L_dw62_5:
    s_waitcnt vmcnt(4)
L_dw62_6:
    s_waitcnt vmcnt(5)
L_dw62_7:
    s_waitcnt vmcnt(6)
L_dw62_8:
    s_waitcnt vmcnt(7)
    buffer_load_dwordx4 v[164:167], v1, s[36:39], s56 offen offset:256 nt
    s_add_u32 s56, s86, 1179648
    s_mov_b64 exec, 1
    ds_add_rtn_u32 v4, v2, v3 offset:8
    s_mov_b64 exec, -1
    s_mov_b64 exec, 1
    ds_add_u32 v2, v3 offset:0
    s_mov_b64 exec, -1
    v_max3_f32 v16, v28, v29, v30
    v_max3_f32 v17, v32, v33, v34
    v_max3_f32 v18, v36, v37, v38
    v_max3_f32 v19, v40, v41, v42
    v_max3_f32 v20, v44, v45, v46
    v_max3_f32 v21, v48, v49, v50
    v_max3_f32 v22, v52, v53, v54
    v_max3_f32 v23, v56, v57, v58
    v_max_f32 v16, v16, v31
    v_max_f32 v17, v17, v35
    v_max_f32 v18, v18, v39
    v_max_f32 v19, v19, v43
    v_max_f32 v20, v20, v47
    v_max_f32 v21, v21, v51
    v_max_f32 v22, v22, v55
    v_max_f32 v23, v23, v59
    s_nop 1
    v_permlane32_swap_b32 v16, v20
    v_permlane32_swap_b32 v17, v21
    v_permlane32_swap_b32 v18, v22
    v_permlane32_swap_b32 v19, v23
    v_max_f32 v16, v16, v20
    v_max_f32 v17, v17, v21
    v_max_f32 v18, v18, v22
    v_max_f32 v19, v19, v23
    s_nop 1
    v_permlane16_swap_b32 v16, v18
    v_permlane16_swap_b32 v17, v19
    v_max_f32 v16, v16, v18
    v_max_f32 v17, v17, v19
    s_nop 1
    v_max_f32_dpp v24, v16, v16 row_ror:8 row_mask:0xf bank_mask:0x3
    v_max_f32_dpp v24, v17, v17 row_ror:8 row_mask:0xf bank_mask:0xc
    v_mul_f32 v24, v24, v252
    s_nop 0
    v_readlane_b32 s90, v24, 0
    v_readlane_b32 s91, v24, 8
    v_readlane_b32 s92, v24, 16
    v_readlane_b32 s93, v24, 24
    v_readlane_b32 s94, v24, 32
    v_readlane_b32 s95, v24, 40
    v_readlane_b32 s96, v24, 48
    v_readlane_b32 s97, v24, 56
    s_nop 1
    s_waitcnt lgkmcnt(0)
    v_readfirstlane_b32 s52, v4
    s_sub_u32 s68, s68, s69
    s_and_b32 s52, s52, 3
    s_lshl_b32 s52, s52, 3
    s_mov_b32 s69, 0x1000000
    s_lshr_b32 s69, s69, s52
    s_sext_i32_i8 s69, s69
    s_add_u32 s68, s68, s69
    s_cmp_gt_i32 s68, 7
    s_cbranch_scc1 L_dw63_8
    s_cmp_gt_i32 s68, 6
    s_cbranch_scc1 L_dw63_7
    s_cmp_gt_i32 s68, 5
    s_cbranch_scc1 L_dw63_6
    s_cmp_gt_i32 s68, 4
    s_cbranch_scc1 L_dw63_5
    s_waitcnt vmcnt(3)
L_dw63_5:
    s_waitcnt vmcnt(4)
L_dw63_6:
    s_waitcnt vmcnt(5)
L_dw63_7:
    s_waitcnt vmcnt(6)
L_dw63_8:
    s_waitcnt vmcnt(7)
    buffer_load_dwordx4 v[168:171], v1, s[36:39], s56 offen offset:0 nt
    v_fma_f32 v28, v28, v252, -s90
    v_fma_f32 v29, v29, v252, -s90
    v_fma_f32 v30, v30, v252, -s90
    v_fma_f32 v31, v31, v252, -s90
    v_exp_f32 v28, v28
    v_exp_f32 v29, v29
    v_exp_f32 v30, v30
    v_exp_f32 v31, v31
    v_add_f32 v16, v28, v29
    v_add_f32 v16, v16, v30
    v_add_f32 v16, v16, v31
    s_cmp_gt_i32 s68, 7
    s_cbranch_scc1 L_dw64_8
    s_cmp_gt_i32 s68, 6
    s_cbranch_scc1 L_dw64_7
    s_cmp_gt_i32 s68, 5
    s_cbranch_scc1 L_dw64_6
    s_cmp_gt_i32 s68, 4
    s_cbranch_scc1 L_dw64_5
    s_waitcnt vmcnt(3)
L_dw64_5:
    s_waitcnt vmcnt(4)
L_dw64_6:
    s_waitcnt vmcnt(5)
L_dw64_7:
    s_waitcnt vmcnt(6)
L_dw64_8:
    s_waitcnt vmcnt(7)
    buffer_load_dwordx4 v[172:175], v1, s[36:39], s56 offen offset:128 nt
    v_fma_f32 v32, v32, v252, -s91
    v_fma_f32 v33, v33, v252, -s91
    v_fma_f32 v34, v34, v252, -s91
    v_fma_f32 v35, v35, v252, -s91
    v_exp_f32 v32, v32
    v_exp_f32 v33, v33
    v_exp_f32 v34, v34
    v_exp_f32 v35, v35
    v_add_f32 v17, v32, v33
    v_add_f32 v17, v17, v34
    v_add_f32 v17, v17, v35
    s_cmp_gt_i32 s68, 7
    s_cbranch_scc1 L_dw65_8
    s_cmp_gt_i32 s68, 6
    s_cbranch_scc1 L_dw65_7
    s_cmp_gt_i32 s68, 5
    s_cbranch_scc1 L_dw65_6
    s_cmp_gt_i32 s68, 4
    s_cbranch_scc1 L_dw65_5
    s_waitcnt vmcnt(3)
L_dw65_5:
    s_waitcnt vmcnt(4)
L_dw65_6:
    s_waitcnt vmcnt(5)
L_dw65_7:
    s_waitcnt vmcnt(6)
L_dw65_8:
    s_waitcnt vmcnt(7)
    buffer_load_dwordx4 v[176:179], v1, s[36:39], s56 offen offset:256 nt
    s_add_u32 s56, s87, 0
    ds_read_b32 v5, v2 offset:4
    v_fma_f32 v36, v36, v252, -s92
    v_fma_f32 v37, v37, v252, -s92
    v_fma_f32 v38, v38, v252, -s92
    v_fma_f32 v39, v39, v252, -s92
    v_exp_f32 v36, v36
    v_exp_f32 v37, v37
    v_exp_f32 v38, v38
    v_exp_f32 v39, v39
    v_add_f32 v18, v36, v37
    v_add_f32 v18, v18, v38
    v_add_f32 v18, v18, v39
    s_waitcnt lgkmcnt(0)
    v_readfirstlane_b32 s68, v5
    s_add_u32 s68, s68, s69
    s_cmp_gt_i32 s68, 7
    s_cbranch_scc1 L_dw66_8
    s_cmp_gt_i32 s68, 6
    s_cbranch_scc1 L_dw66_7
    s_cmp_gt_i32 s68, 5
    s_cbranch_scc1 L_dw66_6
    s_cmp_gt_i32 s68, 4
    s_cbranch_scc1 L_dw66_5
    s_waitcnt vmcnt(3)
L_dw66_5:
    s_waitcnt vmcnt(4)
L_dw66_6:
    s_waitcnt vmcnt(5)
L_dw66_7:
    s_waitcnt vmcnt(6)
L_dw66_8:
    s_waitcnt vmcnt(7)
    buffer_load_dwordx4 v[180:183], v1, s[36:39], s56 offen offset:0 nt
    v_fma_f32 v40, v40, v252, -s93
    v_fma_f32 v41, v41, v252, -s93
    v_fma_f32 v42, v42, v252, -s93
    v_fma_f32 v43, v43, v252, -s93
    v_exp_f32 v40, v40
    v_exp_f32 v41, v41
    v_exp_f32 v42, v42
    v_exp_f32 v43, v43
    v_add_f32 v19, v40, v41
    v_add_f32 v19, v19, v42
    v_add_f32 v19, v19, v43
    s_cmp_gt_i32 s68, 7
    s_cbranch_scc1 L_dw67_8
    s_cmp_gt_i32 s68, 6
    s_cbranch_scc1 L_dw67_7
    s_cmp_gt_i32 s68, 5
    s_cbranch_scc1 L_dw67_6
    s_cmp_gt_i32 s68, 4
    s_cbranch_scc1 L_dw67_5
    s_waitcnt vmcnt(3)
L_dw67_5:
    s_waitcnt vmcnt(4)
L_dw67_6:
    s_waitcnt vmcnt(5)
L_dw67_7:
    s_waitcnt vmcnt(6)
L_dw67_8:
    s_waitcnt vmcnt(7)
    buffer_load_dwordx4 v[184:187], v1, s[36:39], s56 offen offset:128 nt
    v_fma_f32 v44, v44, v252, -s94
    v_fma_f32 v45, v45, v252, -s94
    v_fma_f32 v46, v46, v252, -s94
    v_fma_f32 v47, v47, v252, -s94
    v_exp_f32 v44, v44
    v_exp_f32 v45, v45
    v_exp_f32 v46, v46
    v_exp_f32 v47, v47
    v_add_f32 v20, v44, v45
    v_add_f32 v20, v20, v46
    v_add_f32 v20, v20, v47
    s_cmp_gt_i32 s68, 7
    s_cbranch_scc1 L_dw68_8
    s_cmp_gt_i32 s68, 6
    s_cbranch_scc1 L_dw68_7
    s_cmp_gt_i32 s68, 5
    s_cbranch_scc1 L_dw68_6
    s_cmp_gt_i32 s68, 4
    s_cbranch_scc1 L_dw68_5
    s_waitcnt vmcnt(3)
L_dw68_5:
    s_waitcnt vmcnt(4)
L_dw68_6:
    s_waitcnt vmcnt(5)
L_dw68_7:
    s_waitcnt vmcnt(6)
L_dw68_8:
    s_waitcnt vmcnt(7)
    buffer_load_dwordx4 v[188:191], v1, s[36:39], s56 offen offset:256 nt
    s_add_u32 s56, s87, 393216
    s_mov_b64 exec, 1
    ds_add_rtn_u32 v4, v2, v3 offset:8
    s_mov_b64 exec, -1
    v_fma_f32 v48, v48, v252, -s95
    v_fma_f32 v49, v49, v252, -s95
    v_fma_f32 v50, v50, v252, -s95
    v_fma_f32 v51, v51, v252, -s95
    v_exp_f32 v48, v48
    v_exp_f32 v49, v49
    v_exp_f32 v50, v50
    v_exp_f32 v51, v51
    v_add_f32 v21, v48, v49
    v_add_f32 v21, v21, v50
    v_add_f32 v21, v21, v51
    s_waitcnt lgkmcnt(0)
    v_readfirstlane_b32 s52, v4
    s_sub_u32 s68, s68, s69
    s_and_b32 s52, s52, 3
    s_lshl_b32 s52, s52, 3
    s_mov_b32 s69, 0x1000000
    s_lshr_b32 s69, s69, s52
    s_sext_i32_i8 s69, s69
    s_add_u32 s68, s68, s69
    s_cmp_gt_i32 s68, 7
    s_cbranch_scc1 L_dw69_8
    s_cmp_gt_i32 s68, 6
    s_cbranch_scc1 L_dw69_7
    s_cmp_gt_i32 s68, 5
    s_cbranch_scc1 L_dw69_6
    s_cmp_gt_i32 s68, 4
    s_cbranch_scc1 L_dw69_5
    s_waitcnt vmcnt(3)
L_dw69_5:
    s_waitcnt vmcnt(4)
L_dw69_6:
    s_waitcnt vmcnt(5)
L_dw69_7:
    s_waitcnt vmcnt(6)
L_dw69_8:
    s_waitcnt vmcnt(7)
    buffer_load_dwordx4 v[192:195], v1, s[36:39], s56 offen offset:0 nt
    ds_read_b32 v5, v2 offset:4
    v_fma_f32 v52, v52, v252, -s96
    v_fma_f32 v53, v53, v252, -s96
    v_fma_f32 v54, v54, v252, -s96
    v_fma_f32 v55, v55, v252, -s96
    v_exp_f32 v52, v52
    v_exp_f32 v53, v53
    v_exp_f32 v54, v54
    v_exp_f32 v55, v55
    v_add_f32 v22, v52, v53
    v_add_f32 v22, v22, v54
    v_add_f32 v22, v22, v55
    s_waitcnt lgkmcnt(0)
    v_readfirstlane_b32 s68, v5
    s_add_u32 s68, s68, s69
    s_cmp_gt_i32 s68, 7
    s_cbranch_scc1 L_dw70_8
    s_cmp_gt_i32 s68, 6
    s_cbranch_scc1 L_dw70_7
    s_cmp_gt_i32 s68, 5
    s_cbranch_scc1 L_dw70_6
    s_cmp_gt_i32 s68, 4
    s_cbranch_scc1 L_dw70_5
    s_waitcnt vmcnt(3)
L_dw70_5:
    s_waitcnt vmcnt(4)
L_dw70_6:
    s_waitcnt vmcnt(5)
L_dw70_7:
    s_waitcnt vmcnt(6)
L_dw70_8:
    s_waitcnt vmcnt(7)
    buffer_load_dwordx4 v[196:199], v1, s[36:39], s56 offen offset:128 nt
    s_mov_b64 exec, 1
    ds_add_u32 v2, v3 offset:0
    s_mov_b64 exec, -1
    v_fma_f32 v56, v56, v252, -s97
    v_fma_f32 v57, v57, v252, -s97
    v_fma_f32 v58, v58, v252, -s97
    v_fma_f32 v59, v59, v252, -s97
    v_exp_f32 v56, v56
    v_exp_f32 v57, v57
    v_exp_f32 v58, v58
    v_exp_f32 v59, v59
    v_add_f32 v23, v56, v57
    v_add_f32 v23, v23, v58
    v_add_f32 v23, v23, v59
    s_cmp_gt_i32 s68, 7
    s_cbranch_scc1 L_dw71_8
    s_cmp_gt_i32 s68, 6
    s_cbranch_scc1 L_dw71_7
    s_cmp_gt_i32 s68, 5
    s_cbranch_scc1 L_dw71_6
    s_cmp_gt_i32 s68, 4
    s_cbranch_scc1 L_dw71_5
    s_waitcnt vmcnt(3)
L_dw71_5:
    s_waitcnt vmcnt(4)
L_dw71_6:
    s_waitcnt vmcnt(5)
L_dw71_7:
    s_waitcnt vmcnt(6)
L_dw71_8:
    s_waitcnt vmcnt(7)
    buffer_load_dwordx4 v[200:203], v1, s[36:39], s56 offen offset:256 nt
    s_add_u32 s56, s87, 786432
    s_nop 1
    v_permlane32_swap_b32 v16, v20
    v_permlane32_swap_b32 v17, v21
    v_permlane32_swap_b32 v18, v22
    v_permlane32_swap_b32 v19, v23
    v_add_f32 v16, v16, v20
    v_add_f32 v17, v17, v21
    v_add_f32 v18, v18, v22
    v_add_f32 v19, v19, v23
    s_nop 1
    v_permlane16_swap_b32 v16, v18
    v_permlane16_swap_b32 v17, v19
    v_add_f32 v16, v16, v18
    v_add_f32 v17, v17, v19
    s_nop 1
    v_add_f32_dpp v25, v16, v16 row_ror:8 row_mask:0xf bank_mask:0x3
    v_add_f32_dpp v25, v17, v17 row_ror:8 row_mask:0xf bank_mask:0xc
    v_lshrrev_b32 v6, 3, v0
    s_lshl_b32 s52, s3, 3
    v_lshl_add_u32 v6, v6, 5, s52
    ds_write_b64 v6, v[24:25] offset:256
    s_mov_b64 exec, 1
    ds_add_u32 v2, v3 offset:20
    s_mov_b64 exec, -1
    s_cmp_gt_i32 s68, 7
    s_cbranch_scc1 L_dw72_8
    s_cmp_gt_i32 s68, 6
    s_cbranch_scc1 L_dw72_7
    s_cmp_gt_i32 s68, 5
    s_cbranch_scc1 L_dw72_6
    s_cmp_gt_i32 s68, 4
    s_cbranch_scc1 L_dw72_5
    s_waitcnt vmcnt(3)
L_dw72_5:
    s_waitcnt vmcnt(4)
L_dw72_6:
    s_waitcnt vmcnt(5)
L_dw72_7:
    s_waitcnt vmcnt(6)
L_dw72_8:
    s_waitcnt vmcnt(7)
    buffer_load_dwordx4 v[204:207], v1, s[36:39], s56 offen offset:0 nt
    v_cvt_pk_bf16_f32 v14, v28, 0
    v_cvt_pk_bf16_f32 v15, 0, v28
    v_dot2_f32_bf16 v60, v132, v14, 0
    v_dot2_f32_bf16 v61, v132, v15, 0
    v_dot2_f32_bf16 v62, v133, v14, 0
    v_dot2_f32_bf16 v63, v133, v15, 0
    v_dot2_f32_bf16 v64, v134, v14, 0
    v_dot2_f32_bf16 v65, v134, v15, 0
    v_dot2_f32_bf16 v66, v135, v14, 0
    v_dot2_f32_bf16 v67, v135, v15, 0
    v_dot2_f32_bf16 v68, v136, v14, 0
    v_dot2_f32_bf16 v69, v136, v15, 0
    v_dot2_f32_bf16 v70, v137, v14, 0
    v_dot2_f32_bf16 v71, v137, v15, 0
    v_dot2_f32_bf16 v72, v138, v14, 0
    v_dot2_f32_bf16 v73, v138, v15, 0
    v_dot2_f32_bf16 v74, v139, v14, 0
    v_dot2_f32_bf16 v75, v139, v15, 0
    s_cmp_gt_i32 s68, 7
    s_cbranch_scc1 L_dw73_8
    s_cmp_gt_i32 s68, 6
    s_cbranch_scc1 L_dw73_7
    s_cmp_gt_i32 s68, 5
    s_cbranch_scc1 L_dw73_6
    s_cmp_gt_i32 s68, 4
    s_cbranch_scc1 L_dw73_5
    s_waitcnt vmcnt(3)
L_dw73_5:
    s_waitcnt vmcnt(4)
L_dw73_6:
    s_waitcnt vmcnt(5)
L_dw73_7:
    s_waitcnt vmcnt(6)
L_dw73_8:
    s_waitcnt vmcnt(7)
    buffer_load_dwordx4 v[208:211], v1, s[36:39], s56 offen offset:128 nt
    ds_read_b32 v5, v2 offset:4
    v_dot2_f32_bf16 v76, v140, v14, 0
    v_dot2_f32_bf16 v77, v140, v15, 0
    v_dot2_f32_bf16 v78, v141, v14, 0
    v_dot2_f32_bf16 v79, v141, v15, 0
    v_dot2_f32_bf16 v80, v142, v14, 0
    v_dot2_f32_bf16 v81, v142, v15, 0
    v_dot2_f32_bf16 v82, v143, v14, 0
    v_dot2_f32_bf16 v83, v143, v15, 0
    v_cvt_pk_bf16_f32 v14, v29, 0
    v_cvt_pk_bf16_f32 v15, 0, v29
    v_dot2c_f32_bf16 v60, v144, v14
    v_dot2c_f32_bf16 v61, v144, v15
    v_dot2c_f32_bf16 v62, v145, v14
    v_dot2c_f32_bf16 v63, v145, v15
    v_dot2c_f32_bf16 v64, v146, v14
    v_dot2c_f32_bf16 v65, v146, v15
    v_dot2c_f32_bf16 v66, v147, v14
    v_dot2c_f32_bf16 v67, v147, v15
    s_waitcnt lgkmcnt(0)
    v_readfirstlane_b32 s68, v5
    s_add_u32 s68, s68, s69
    s_cmp_gt_i32 s68, 7
    s_cbranch_scc1 L_dw74_8
    s_cmp_gt_i32 s68, 6
    s_cbranch_scc1 L_dw74_7
    s_cmp_gt_i32 s68, 5
    s_cbranch_scc1 L_dw74_6
    s_cmp_gt_i32 s68, 4
    s_cbranch_scc1 L_dw74_5
    s_waitcnt vmcnt(3)
L_dw74_5:
    s_waitcnt vmcnt(4)
L_dw74_6:
    s_waitcnt vmcnt(5)
L_dw74_7:
    s_waitcnt vmcnt(6)
L_dw74_8:
    s_waitcnt vmcnt(7)
    buffer_load_dwordx4 v[212:215], v1, s[36:39], s56 offen offset:256 nt
    s_add_u32 s56, s87, 1179648
    s_mov_b64 exec, 1
    ds_add_rtn_u32 v4, v2, v3 offset:8
    s_mov_b64 exec, -1
    v_dot2c_f32_bf16 v68, v148, v14
    v_dot2c_f32_bf16 v69, v148, v15
    v_dot2c_f32_bf16 v70, v149, v14
    v_dot2c_f32_bf16 v71, v149, v15
    v_dot2c_f32_bf16 v72, v150, v14
    v_dot2c_f32_bf16 v73, v150, v15
    v_dot2c_f32_bf16 v74, v151, v14
    v_dot2c_f32_bf16 v75, v151, v15
    v_dot2c_f32_bf16 v76, v152, v14
    v_dot2c_f32_bf16 v77, v152, v15
    v_dot2c_f32_bf16 v78, v153, v14
    v_dot2c_f32_bf16 v79, v153, v15
    v_dot2c_f32_bf16 v80, v154, v14
    v_dot2c_f32_bf16 v81, v154, v15
    v_dot2c_f32_bf16 v82, v155, v14
    v_dot2c_f32_bf16 v83, v155, v15
    s_waitcnt lgkmcnt(0)
    v_readfirstlane_b32 s52, v4
    s_sub_u32 s68, s68, s69
    s_and_b32 s52, s52, 3
    s_lshl_b32 s52, s52, 3
    s_mov_b32 s69, 0x1000000
    s_lshr_b32 s69, s69, s52
    s_sext_i32_i8 s69, s69
    s_add_u32 s68, s68, s69
    s_cmp_gt_i32 s68, 7
    s_cbranch_scc1 L_dw75_8
    s_cmp_gt_i32 s68, 6
    s_cbranch_scc1 L_dw75_7
    s_cmp_gt_i32 s68, 5
    s_cbranch_scc1 L_dw75_6
    s_cmp_gt_i32 s68, 4
    s_cbranch_scc1 L_dw75_5
    s_waitcnt vmcnt(3)
L_dw75_5:
    s_waitcnt vmcnt(4)
L_dw75_6:
    s_waitcnt vmcnt(5)
L_dw75_7:
    s_waitcnt vmcnt(6)
L_dw75_8:
    s_waitcnt vmcnt(7)
    buffer_load_dwordx4 v[216:219], v1, s[36:39], s56 offen offset:0 nt
    v_cvt_pk_bf16_f32 v14, v30, 0
    v_cvt_pk_bf16_f32 v15, 0, v30
    v_dot2c_f32_bf16 v60, v156, v14
    v_dot2c_f32_bf16 v61, v156, v15
    v_dot2c_f32_bf16 v62, v157, v14
    v_dot2c_f32_bf16 v63, v157, v15
    v_dot2c_f32_bf16 v64, v158, v14
    v_dot2c_f32_bf16 v65, v158, v15
    v_dot2c_f32_bf16 v66, v159, v14
    v_dot2c_f32_bf16 v67, v159, v15
    v_dot2c_f32_bf16 v68, v160, v14
    v_dot2c_f32_bf16 v69, v160, v15
    v_dot2c_f32_bf16 v70, v161, v14
    v_dot2c_f32_bf16 v71, v161, v15
    v_dot2c_f32_bf16 v72, v162, v14
    v_dot2c_f32_bf16 v73, v162, v15
    v_dot2c_f32_bf16 v74, v163, v14
    v_dot2c_f32_bf16 v75, v163, v15
    s_cmp_gt_i32 s68, 7
    s_cbranch_scc1 L_dw76_8
    s_cmp_gt_i32 s68, 6
    s_cbranch_scc1 L_dw76_7
    s_cmp_gt_i32 s68, 5
    s_cbranch_scc1 L_dw76_6
    s_cmp_gt_i32 s68, 4
    s_cbranch_scc1 L_dw76_5
    s_waitcnt vmcnt(3)
L_dw76_5:
    s_waitcnt vmcnt(4)
L_dw76_6:
    s_waitcnt vmcnt(5)
L_dw76_7:
    s_waitcnt vmcnt(6)
L_dw76_8:
    s_waitcnt vmcnt(7)
    buffer_load_dwordx4 v[220:223], v1, s[36:39], s56 offen offset:128 nt
    v_dot2c_f32_bf16 v76, v164, v14
    v_dot2c_f32_bf16 v77, v164, v15
    v_dot2c_f32_bf16 v78, v165, v14
    v_dot2c_f32_bf16 v79, v165, v15
    v_dot2c_f32_bf16 v80, v166, v14
    v_dot2c_f32_bf16 v81, v166, v15
    v_dot2c_f32_bf16 v82, v167, v14
    v_dot2c_f32_bf16 v83, v167, v15
    v_cvt_pk_bf16_f32 v14, v31, 0
    v_cvt_pk_bf16_f32 v15, 0, v31
    v_dot2c_f32_bf16 v60, v168, v14
    v_dot2c_f32_bf16 v61, v168, v15
    v_dot2c_f32_bf16 v62, v169, v14
    v_dot2c_f32_bf16 v63, v169, v15
    v_dot2c_f32_bf16 v64, v170, v14
    v_dot2c_f32_bf16 v65, v170, v15
    v_dot2c_f32_bf16 v66, v171, v14
    v_dot2c_f32_bf16 v67, v171, v15
    s_cmp_gt_i32 s68, 7
    s_cbranch_scc1 L_dw77_8
    s_cmp_gt_i32 s68, 6
    s_cbranch_scc1 L_dw77_7
    s_cmp_gt_i32 s68, 5
    s_cbranch_scc1 L_dw77_6
    s_cmp_gt_i32 s68, 4
    s_cbranch_scc1 L_dw77_5
    s_waitcnt vmcnt(3)
L_dw77_5:
    s_waitcnt vmcnt(4)
L_dw77_6:
    s_waitcnt vmcnt(5)
L_dw77_7:
    s_waitcnt vmcnt(6)
L_dw77_8:
    s_waitcnt vmcnt(7)
    buffer_load_dwordx4 v[224:227], v1, s[36:39], s56 offen offset:256 nt
    s_add_u32 s56, s88, 0
    ds_read_b32 v5, v2 offset:4
    s_nop 2
    v_permlane32_swap_b32 v60, v64
    v_permlane32_swap_b32 v61, v65
    v_permlane32_swap_b32 v62, v66
    v_permlane32_swap_b32 v63, v67
    v_add_f32 v60, v60, v64
    v_add_f32 v61, v61, v65
    v_add_f32 v62, v62, v66
    v_add_f32 v63, v63, v67
    s_nop 0
    v_permlane16_swap_b32 v60, v62
    v_permlane16_swap_b32 v61, v63
    v_add_f32 v60, v60, v62
    v_add_f32 v61, v61, v63
    s_nop 0
    v_add_f32_dpp v6, v60, v60 row_ror:8 row_mask:0xf bank_mask:0x3
    v_add_f32_dpp v6, v61, v61 row_ror:8 row_mask:0xf bank_mask:0xc
    ds_write_b32 v254, v6 offset:17664
    s_waitcnt lgkmcnt(0)
    v_readfirstlane_b32 s68, v5
    s_add_u32 s68, s68, s69
    s_cmp_gt_i32 s68, 7
    s_cbranch_scc1 L_dw78_8
    s_cmp_gt_i32 s68, 6
    s_cbranch_scc1 L_dw78_7
    s_cmp_gt_i32 s68, 5
    s_cbranch_scc1 L_dw78_6
    s_cmp_gt_i32 s68, 4
    s_cbranch_scc1 L_dw78_5
    s_waitcnt vmcnt(3)
L_dw78_5:
    s_waitcnt vmcnt(4)
L_dw78_6:
    s_waitcnt vmcnt(5)
L_dw78_7:
    s_waitcnt vmcnt(6)
L_dw78_8:
    s_waitcnt vmcnt(7)
    buffer_load_dwordx4 v[228:231], v1, s[36:39], s56 offen offset:0 nt
    s_mov_b64 exec, 1
    ds_add_u32 v2, v3 offset:0
    s_mov_b64 exec, -1
    v_dot2c_f32_bf16 v68, v172, v14
    v_dot2c_f32_bf16 v69, v172, v15
    v_dot2c_f32_bf16 v70, v173, v14
    v_dot2c_f32_bf16 v71, v173, v15
    v_dot2c_f32_bf16 v72, v174, v14
    v_dot2c_f32_bf16 v73, v174, v15
    v_dot2c_f32_bf16 v74, v175, v14
    v_dot2c_f32_bf16 v75, v175, v15
    s_nop 2
    v_permlane32_swap_b32 v68, v72
    v_permlane32_swap_b32 v69, v73
    v_permlane32_swap_b32 v70, v74
    v_permlane32_swap_b32 v71, v75
    v_add_f32 v68, v68, v72
    v_add_f32 v69, v69, v73
    v_add_f32 v70, v70, v74
    v_add_f32 v71, v71, v75
    s_nop 0
    v_permlane16_swap_b32 v68, v70
    v_permlane16_swap_b32 v69, v71
    v_add_f32 v68, v68, v70
    v_add_f32 v69, v69, v71
    s_nop 0
    v_add_f32_dpp v7, v68, v68 row_ror:8 row_mask:0xf bank_mask:0x3
    v_add_f32_dpp v7, v69, v69 row_ror:8 row_mask:0xf bank_mask:0xc
    ds_write_b32 v254, v7 offset:17920
    s_cmp_gt_i32 s68, 7
    s_cbranch_scc1 L_dw79_8
    s_cmp_gt_i32 s68, 6
    s_cbranch_scc1 L_dw79_7
    s_cmp_gt_i32 s68, 5
    s_cbranch_scc1 L_dw79_6
    s_cmp_gt_i32 s68, 4
    s_cbranch_scc1 L_dw79_5
    s_waitcnt vmcnt(3)
L_dw79_5:
    s_waitcnt vmcnt(4)
L_dw79_6:
    s_waitcnt vmcnt(5)
L_dw79_7:
    s_waitcnt vmcnt(6)
L_dw79_8:
    s_waitcnt vmcnt(7)
    buffer_load_dwordx4 v[232:235], v1, s[36:39], s56 offen offset:128 nt
    v_dot2c_f32_bf16 v76, v176, v14
    v_dot2c_f32_bf16 v77, v176, v15
    v_dot2c_f32_bf16 v78, v177, v14
    v_dot2c_f32_bf16 v79, v177, v15
    v_dot2c_f32_bf16 v80, v178, v14
    v_dot2c_f32_bf16 v81, v178, v15
    v_dot2c_f32_bf16 v82, v179, v14
    v_dot2c_f32_bf16 v83, v179, v15
    s_nop 2
    v_permlane32_swap_b32 v76, v80
    v_permlane32_swap_b32 v77, v81
    v_permlane32_swap_b32 v78, v82
    v_permlane32_swap_b32 v79, v83
    v_add_f32 v76, v76, v80
    v_add_f32 v77, v77, v81
    v_add_f32 v78, v78, v82
    v_add_f32 v79, v79, v83
    s_nop 0
    v_permlane16_swap_b32 v76, v78
    v_permlane16_swap_b32 v77, v79
    v_add_f32 v76, v76, v78
    v_add_f32 v77, v77, v79
    s_nop 0
    v_add_f32_dpp v8, v76, v76 row_ror:8 row_mask:0xf bank_mask:0x3
    v_add_f32_dpp v8, v77, v77 row_ror:8 row_mask:0xf bank_mask:0xc
    ds_write_b32 v254, v8 offset:18176
    s_mov_b64 exec, 1
    ds_add_u32 v2, v3 offset:32
    s_mov_b64 exec, -1
    s_cmp_gt_i32 s68, 7
    s_cbranch_scc1 L_dw80_8
    s_cmp_gt_i32 s68, 6
    s_cbranch_scc1 L_dw80_7
    s_cmp_gt_i32 s68, 5
    s_cbranch_scc1 L_dw80_6
    s_cmp_gt_i32 s68, 4
    s_cbranch_scc1 L_dw80_5
    s_waitcnt vmcnt(3)
L_dw80_5:
    s_waitcnt vmcnt(4)
L_dw80_6:
    s_waitcnt vmcnt(5)
L_dw80_7:
    s_waitcnt vmcnt(6)
L_dw80_8:
    s_waitcnt vmcnt(7)
    buffer_load_dwordx4 v[236:239], v1, s[36:39], s56 offen offset:256 nt
    s_add_u32 s56, s88, 393216
    s_mov_b64 exec, 1
    ds_add_rtn_u32 v4, v2, v3 offset:8
    s_mov_b64 exec, -1
    v_cvt_pk_bf16_f32 v14, v32, 0
    v_cvt_pk_bf16_f32 v15, 0, v32
    v_dot2_f32_bf16 v60, v180, v14, 0
    v_dot2_f32_bf16 v61, v180, v15, 0
    v_dot2_f32_bf16 v62, v181, v14, 0
    v_dot2_f32_bf16 v63, v181, v15, 0
    v_dot2_f32_bf16 v64, v182, v14, 0
    v_dot2_f32_bf16 v65, v182, v15, 0
    v_dot2_f32_bf16 v66, v183, v14, 0
    v_dot2_f32_bf16 v67, v183, v15, 0
    v_dot2_f32_bf16 v68, v184, v14, 0
    v_dot2_f32_bf16 v69, v184, v15, 0
    v_dot2_f32_bf16 v70, v185, v14, 0
    v_dot2_f32_bf16 v71, v185, v15, 0
    v_dot2_f32_bf16 v72, v186, v14, 0
    v_dot2_f32_bf16 v73, v186, v15, 0
    v_dot2_f32_bf16 v74, v187, v14, 0
    v_dot2_f32_bf16 v75, v187, v15, 0
    s_waitcnt lgkmcnt(0)
    v_readfirstlane_b32 s52, v4
    s_sub_u32 s68, s68, s69
    s_and_b32 s52, s52, 3
    s_lshl_b32 s52, s52, 3
    s_mov_b32 s69, 0x1000000
    s_lshr_b32 s69, s69, s52
    s_sext_i32_i8 s69, s69
    s_add_u32 s68, s68, s69
    s_cmp_gt_i32 s68, 7
    s_cbranch_scc1 L_dw81_8
    s_cmp_gt_i32 s68, 6
    s_cbranch_scc1 L_dw81_7
    s_cmp_gt_i32 s68, 5
    s_cbranch_scc1 L_dw81_6
    s_cmp_gt_i32 s68, 4
    s_cbranch_scc1 L_dw81_5
    s_waitcnt vmcnt(3)
L_dw81_5:
    s_waitcnt vmcnt(4)
L_dw81_6:
    s_waitcnt vmcnt(5)
L_dw81_7:
    s_waitcnt vmcnt(6)
L_dw81_8:
    s_waitcnt vmcnt(7)
    buffer_load_dwordx4 v[240:243], v1, s[36:39], s56 offen offset:0 nt
    ds_read_b32 v5, v2 offset:4
    v_dot2_f32_bf16 v76, v188, v14, 0
    v_dot2_f32_bf16 v77, v188, v15, 0
    v_dot2_f32_bf16 v78, v189, v14, 0
    v_dot2_f32_bf16 v79, v189, v15, 0
    v_dot2_f32_bf16 v80, v190, v14, 0
    v_dot2_f32_bf16 v81, v190, v15, 0
    v_dot2_f32_bf16 v82, v191, v14, 0
    v_dot2_f32_bf16 v83, v191, v15, 0
    v_cvt_pk_bf16_f32 v14, v33, 0
    v_cvt_pk_bf16_f32 v15, 0, v33
    v_dot2c_f32_bf16 v60, v192, v14
    v_dot2c_f32_bf16 v61, v192, v15
    v_dot2c_f32_bf16 v62, v193, v14
    v_dot2c_f32_bf16 v63, v193, v15
    v_dot2c_f32_bf16 v64, v194, v14
    v_dot2c_f32_bf16 v65, v194, v15
    v_dot2c_f32_bf16 v66, v195, v14
    v_dot2c_f32_bf16 v67, v195, v15
    s_waitcnt lgkmcnt(0)
    v_readfirstlane_b32 s68, v5
    s_add_u32 s68, s68, s69
    s_cmp_gt_i32 s68, 7
    s_cbranch_scc1 L_dw82_8
    s_cmp_gt_i32 s68, 6
    s_cbranch_scc1 L_dw82_7
    s_cmp_gt_i32 s68, 5
    s_cbranch_scc1 L_dw82_6
    s_cmp_gt_i32 s68, 4
    s_cbranch_scc1 L_dw82_5
    s_waitcnt vmcnt(3)
L_dw82_5:
    s_waitcnt vmcnt(4)
L_dw82_6:
    s_waitcnt vmcnt(5)
L_dw82_7:
    s_waitcnt vmcnt(6)
L_dw82_8:
    s_waitcnt vmcnt(7)
    buffer_load_dwordx4 v[244:247], v1, s[36:39], s56 offen offset:128 nt
    v_dot2c_f32_bf16 v68, v196, v14
    v_dot2c_f32_bf16 v69, v196, v15
    v_dot2c_f32_bf16 v70, v197, v14
    v_dot2c_f32_bf16 v71, v197, v15
    v_dot2c_f32_bf16 v72, v198, v14
    v_dot2c_f32_bf16 v73, v198, v15
    v_dot2c_f32_bf16 v74, v199, v14
    v_dot2c_f32_bf16 v75, v199, v15
    v_dot2c_f32_bf16 v76, v200, v14
    v_dot2c_f32_bf16 v77, v200, v15
    v_dot2c_f32_bf16 v78, v201, v14
    v_dot2c_f32_bf16 v79, v201, v15
    v_dot2c_f32_bf16 v80, v202, v14
    v_dot2c_f32_bf16 v81, v202, v15
    v_dot2c_f32_bf16 v82, v203, v14
    v_dot2c_f32_bf16 v83, v203, v15
    s_cmp_gt_i32 s68, 7
    s_cbranch_scc1 L_dw83_8
    s_cmp_gt_i32 s68, 6
    s_cbranch_scc1 L_dw83_7
    s_cmp_gt_i32 s68, 5
    s_cbranch_scc1 L_dw83_6
    s_cmp_gt_i32 s68, 4
    s_cbranch_scc1 L_dw83_5
    s_waitcnt vmcnt(3)
L_dw83_5:
    s_waitcnt vmcnt(4)
L_dw83_6:
    s_waitcnt vmcnt(5)
L_dw83_7:
    s_waitcnt vmcnt(6)
L_dw83_8:
    s_waitcnt vmcnt(7)
    buffer_load_dwordx4 v[248:251], v1, s[36:39], s56 offen offset:256 nt
    s_add_u32 s56, s88, 786432
    v_cvt_pk_bf16_f32 v14, v34, 0
    v_cvt_pk_bf16_f32 v15, 0, v34
    v_dot2c_f32_bf16 v60, v204, v14
    v_dot2c_f32_bf16 v61, v204, v15
    v_dot2c_f32_bf16 v62, v205, v14
    v_dot2c_f32_bf16 v63, v205, v15
    v_dot2c_f32_bf16 v64, v206, v14
    v_dot2c_f32_bf16 v65, v206, v15
    v_dot2c_f32_bf16 v66, v207, v14
    v_dot2c_f32_bf16 v67, v207, v15
    v_dot2c_f32_bf16 v68, v208, v14
    v_dot2c_f32_bf16 v69, v208, v15
    v_dot2c_f32_bf16 v70, v209, v14
    v_dot2c_f32_bf16 v71, v209, v15
    v_dot2c_f32_bf16 v72, v210, v14
    v_dot2c_f32_bf16 v73, v210, v15
    v_dot2c_f32_bf16 v74, v211, v14
    v_dot2c_f32_bf16 v75, v211, v15
    s_cmp_gt_i32 s68, 7
    s_cbranch_scc1 L_dw84_8
    s_cmp_gt_i32 s68, 6
    s_cbranch_scc1 L_dw84_7
    s_cmp_gt_i32 s68, 5
    s_cbranch_scc1 L_dw84_6
    s_cmp_gt_i32 s68, 4
    s_cbranch_scc1 L_dw84_5
    s_waitcnt vmcnt(3)
L_dw84_5:
    s_waitcnt vmcnt(4)
L_dw84_6:
    s_waitcnt vmcnt(5)
L_dw84_7:
    s_waitcnt vmcnt(6)
L_dw84_8:
    s_waitcnt vmcnt(7)
    buffer_load_dwordx4 v[84:87], v1, s[36:39], s56 offen offset:0 nt
    v_dot2c_f32_bf16 v76, v212, v14
    v_dot2c_f32_bf16 v77, v212, v15
    v_dot2c_f32_bf16 v78, v213, v14
    v_dot2c_f32_bf16 v79, v213, v15
    v_dot2c_f32_bf16 v80, v214, v14
    v_dot2c_f32_bf16 v81, v214, v15
    v_dot2c_f32_bf16 v82, v215, v14
    v_dot2c_f32_bf16 v83, v215, v15
    v_cvt_pk_bf16_f32 v14, v35, 0
    v_cvt_pk_bf16_f32 v15, 0, v35
    v_dot2c_f32_bf16 v60, v216, v14
    v_dot2c_f32_bf16 v61, v216, v15
    v_dot2c_f32_bf16 v62, v217, v14
    v_dot2c_f32_bf16 v63, v217, v15
    v_dot2c_f32_bf16 v64, v218, v14
    v_dot2c_f32_bf16 v65, v218, v15
    v_dot2c_f32_bf16 v66, v219, v14
    v_dot2c_f32_bf16 v67, v219, v15
    s_cmp_gt_i32 s68, 7
    s_cbranch_scc1 L_dw85_8
    s_cmp_gt_i32 s68, 6
    s_cbranch_scc1 L_dw85_7
    s_cmp_gt_i32 s68, 5
    s_cbranch_scc1 L_dw85_6
    s_cmp_gt_i32 s68, 4
    s_cbranch_scc1 L_dw85_5
    s_waitcnt vmcnt(3)
L_dw85_5:
    s_waitcnt vmcnt(4)
L_dw85_6:
    s_waitcnt vmcnt(5)
L_dw85_7:
    s_waitcnt vmcnt(6)
L_dw85_8:
    s_waitcnt vmcnt(7)
    buffer_load_dwordx4 v[88:91], v1, s[36:39], s56 offen offset:128 nt
    ds_read_b32 v5, v2 offset:4
    s_nop 2
    v_permlane32_swap_b32 v60, v64
    v_permlane32_swap_b32 v61, v65
    v_permlane32_swap_b32 v62, v66
    v_permlane32_swap_b32 v63, v67
    v_add_f32 v60, v60, v64
    v_add_f32 v61, v61, v65
    v_add_f32 v62, v62, v66
    v_add_f32 v63, v63, v67
    s_nop 0
    v_permlane16_swap_b32 v60, v62
    v_permlane16_swap_b32 v61, v63
    v_add_f32 v60, v60, v62
    v_add_f32 v61, v61, v63
    s_nop 0
    v_add_f32_dpp v6, v60, v60 row_ror:8 row_mask:0xf bank_mask:0x3
    v_add_f32_dpp v6, v61, v61 row_ror:8 row_mask:0xf bank_mask:0xc
    ds_write_b32 v254, v6 offset:20736
    s_waitcnt lgkmcnt(0)
    v_readfirstlane_b32 s68, v5
    s_add_u32 s68, s68, s69
    s_cmp_gt_i32 s68, 7
    s_cbranch_scc1 L_dw86_8
    s_cmp_gt_i32 s68, 6
    s_cbranch_scc1 L_dw86_7
    s_cmp_gt_i32 s68, 5
    s_cbranch_scc1 L_dw86_6
    s_cmp_gt_i32 s68, 4
    s_cbranch_scc1 L_dw86_5
    s_waitcnt vmcnt(3)
L_dw86_5:
    s_waitcnt vmcnt(4)
L_dw86_6:
    s_waitcnt vmcnt(5)
L_dw86_7:
    s_waitcnt vmcnt(6)
L_dw86_8:
    s_waitcnt vmcnt(7)
    buffer_load_dwordx4 v[92:95], v1, s[36:39], s56 offen offset:256 nt
    s_add_u32 s56, s88, 1179648
    s_mov_b64 exec, 1
    ds_add_rtn_u32 v4, v2, v3 offset:8
    s_mov_b64 exec, -1
    s_mov_b64 exec, 1
    ds_add_u32 v2, v3 offset:0
    s_mov_b64 exec, -1
    v_dot2c_f32_bf16 v68, v220, v14
    v_dot2c_f32_bf16 v69, v220, v15
    v_dot2c_f32_bf16 v70, v221, v14
    v_dot2c_f32_bf16 v71, v221, v15
    v_dot2c_f32_bf16 v72, v222, v14
    v_dot2c_f32_bf16 v73, v222, v15
    v_dot2c_f32_bf16 v74, v223, v14
    v_dot2c_f32_bf16 v75, v223, v15
    s_nop 2
    v_permlane32_swap_b32 v68, v72
    v_permlane32_swap_b32 v69, v73
    v_permlane32_swap_b32 v70, v74
    v_permlane32_swap_b32 v71, v75
    v_add_f32 v68, v68, v72
    v_add_f32 v69, v69, v73
    v_add_f32 v70, v70, v74
    v_add_f32 v71, v71, v75
    s_nop 0
    v_permlane16_swap_b32 v68, v70
    v_permlane16_swap_b32 v69, v71
    v_add_f32 v68, v68, v70
    v_add_f32 v69, v69, v71
    s_nop 0
    v_add_f32_dpp v7, v68, v68 row_ror:8 row_mask:0xf bank_mask:0x3
    v_add_f32_dpp v7, v69, v69 row_ror:8 row_mask:0xf bank_mask:0xc
    ds_write_b32 v254, v7 offset:20992
    s_waitcnt lgkmcnt(0)
    v_readfirstlane_b32 s52, v4
    s_sub_u32 s68, s68, s69
    s_and_b32 s52, s52, 3
    s_lshl_b32 s52, s52, 3
    s_mov_b32 s69, 0x1000000
    s_lshr_b32 s69, s69, s52
    s_sext_i32_i8 s69, s69
    s_add_u32 s68, s68, s69
    s_cmp_gt_i32 s68, 7
    s_cbranch_scc1 L_dw87_8
    s_cmp_gt_i32 s68, 6
    s_cbranch_scc1 L_dw87_7
    s_cmp_gt_i32 s68, 5
    s_cbranch_scc1 L_dw87_6
    s_cmp_gt_i32 s68, 4
    s_cbranch_scc1 L_dw87_5
    s_waitcnt vmcnt(3)
L_dw87_5:
    s_waitcnt vmcnt(4)
L_dw87_6:
    s_waitcnt vmcnt(5)
L_dw87_7:
    s_waitcnt vmcnt(6)
L_dw87_8:
    s_waitcnt vmcnt(7)
    buffer_load_dwordx4 v[96:99], v1, s[36:39], s56 offen offset:0 nt
    v_dot2c_f32_bf16 v76, v224, v14
    v_dot2c_f32_bf16 v77, v224, v15
    v_dot2c_f32_bf16 v78, v225, v14
    v_dot2c_f32_bf16 v79, v225, v15
    v_dot2c_f32_bf16 v80, v226, v14
    v_dot2c_f32_bf16 v81, v226, v15
    v_dot2c_f32_bf16 v82, v227, v14
    v_dot2c_f32_bf16 v83, v227, v15
    s_nop 2
    v_permlane32_swap_b32 v76, v80
    v_permlane32_swap_b32 v77, v81
    v_permlane32_swap_b32 v78, v82
    v_permlane32_swap_b32 v79, v83
    v_add_f32 v76, v76, v80
    v_add_f32 v77, v77, v81
    v_add_f32 v78, v78, v82
    v_add_f32 v79, v79, v83
    s_nop 0
    v_permlane16_swap_b32 v76, v78
    v_permlane16_swap_b32 v77, v79
    v_add_f32 v76, v76, v78
    v_add_f32 v77, v77, v79
    s_nop 0
    v_add_f32_dpp v8, v76, v76 row_ror:8 row_mask:0xf bank_mask:0x3
    v_add_f32_dpp v8, v77, v77 row_ror:8 row_mask:0xf bank_mask:0xc
    ds_write_b32 v254, v8 offset:21248
    s_mov_b64 exec, 1
    ds_add_u32 v2, v3 offset:36
    s_mov_b64 exec, -1
    s_cmp_gt_i32 s68, 7
    s_cbranch_scc1 L_dw88_8
    s_cmp_gt_i32 s68, 6
    s_cbranch_scc1 L_dw88_7
    s_cmp_gt_i32 s68, 5
    s_cbranch_scc1 L_dw88_6
    s_cmp_gt_i32 s68, 4
    s_cbranch_scc1 L_dw88_5
    s_waitcnt vmcnt(3)
L_dw88_5:
    s_waitcnt vmcnt(4)
L_dw88_6:
    s_waitcnt vmcnt(5)
L_dw88_7:
    s_waitcnt vmcnt(6)
L_dw88_8:
    s_waitcnt vmcnt(7)
    buffer_load_dwordx4 v[100:103], v1, s[36:39], s56 offen offset:128 nt
    v_cvt_pk_bf16_f32 v14, v36, 0
    v_cvt_pk_bf16_f32 v15, 0, v36
    v_dot2_f32_bf16 v60, v228, v14, 0
    v_dot2_f32_bf16 v61, v228, v15, 0
    v_dot2_f32_bf16 v62, v229, v14, 0
    v_dot2_f32_bf16 v63, v229, v15, 0
    v_dot2_f32_bf16 v64, v230, v14, 0
    v_dot2_f32_bf16 v65, v230, v15, 0
    v_dot2_f32_bf16 v66, v231, v14, 0
    v_dot2_f32_bf16 v67, v231, v15, 0
    v_dot2_f32_bf16 v68, v232, v14, 0
    v_dot2_f32_bf16 v69, v232, v15, 0
    v_dot2_f32_bf16 v70, v233, v14, 0
    v_dot2_f32_bf16 v71, v233, v15, 0
    v_dot2_f32_bf16 v72, v234, v14, 0
    v_dot2_f32_bf16 v73, v234, v15, 0
    v_dot2_f32_bf16 v74, v235, v14, 0
    v_dot2_f32_bf16 v75, v235, v15, 0
    s_cmp_gt_i32 s68, 7
    s_cbranch_scc1 L_dw89_8
    s_cmp_gt_i32 s68, 6
    s_cbranch_scc1 L_dw89_7
    s_cmp_gt_i32 s68, 5
    s_cbranch_scc1 L_dw89_6
    s_cmp_gt_i32 s68, 4
    s_cbranch_scc1 L_dw89_5
    s_waitcnt vmcnt(3)
L_dw89_5:
    s_waitcnt vmcnt(4)
L_dw89_6:
    s_waitcnt vmcnt(5)
L_dw89_7:
    s_waitcnt vmcnt(6)
L_dw89_8:
    s_waitcnt vmcnt(7)
    buffer_load_dwordx4 v[104:107], v1, s[36:39], s56 offen offset:256 nt
    s_add_u32 s56, s89, 0
    ds_read_b32 v5, v2 offset:4
    v_dot2_f32_bf16 v76, v236, v14, 0
    v_dot2_f32_bf16 v77, v236, v15, 0
    v_dot2_f32_bf16 v78, v237, v14, 0
    v_dot2_f32_bf16 v79, v237, v15, 0
    v_dot2_f32_bf16 v80, v238, v14, 0
    v_dot2_f32_bf16 v81, v238, v15, 0
    v_dot2_f32_bf16 v82, v239, v14, 0
    v_dot2_f32_bf16 v83, v239, v15, 0
    v_cvt_pk_bf16_f32 v14, v37, 0
    v_cvt_pk_bf16_f32 v15, 0, v37
    v_dot2c_f32_bf16 v60, v240, v14
    v_dot2c_f32_bf16 v61, v240, v15
    v_dot2c_f32_bf16 v62, v241, v14
    v_dot2c_f32_bf16 v63, v241, v15
    v_dot2c_f32_bf16 v64, v242, v14
    v_dot2c_f32_bf16 v65, v242, v15
    v_dot2c_f32_bf16 v66, v243, v14
    v_dot2c_f32_bf16 v67, v243, v15
    s_waitcnt lgkmcnt(0)
    v_readfirstlane_b32 s68, v5
    s_add_u32 s68, s68, s69
    s_cmp_gt_i32 s68, 7
    s_cbranch_scc1 L_dw90_8
    s_cmp_gt_i32 s68, 6
    s_cbranch_scc1 L_dw90_7
    s_cmp_gt_i32 s68, 5
    s_cbranch_scc1 L_dw90_6
    s_cmp_gt_i32 s68, 4
    s_cbranch_scc1 L_dw90_5
    s_waitcnt vmcnt(3)
L_dw90_5:
    s_waitcnt vmcnt(4)
L_dw90_6:
    s_waitcnt vmcnt(5)
L_dw90_7:
    s_waitcnt vmcnt(6)
L_dw90_8:
    s_waitcnt vmcnt(7)
    buffer_load_dwordx4 v[108:111], v1, s[36:39], s56 offen offset:0 nt
    v_dot2c_f32_bf16 v68, v244, v14
    v_dot2c_f32_bf16 v69, v244, v15
    v_dot2c_f32_bf16 v70, v245, v14
    v_dot2c_f32_bf16 v71, v245, v15
    v_dot2c_f32_bf16 v72, v246, v14
    v_dot2c_f32_bf16 v73, v246, v15
    v_dot2c_f32_bf16 v74, v247, v14
    v_dot2c_f32_bf16 v75, v247, v15
    s_cmp_gt_i32 s68, 7
    s_cbranch_scc1 L_dw91_8
    s_cmp_gt_i32 s68, 6
    s_cbranch_scc1 L_dw91_7
    s_cmp_gt_i32 s68, 5
    s_cbranch_scc1 L_dw91_6
    s_cmp_gt_i32 s68, 4
    s_cbranch_scc1 L_dw91_5
    s_waitcnt vmcnt(3)
L_dw91_5:
    s_waitcnt vmcnt(4)
L_dw91_6:
    s_waitcnt vmcnt(5)
L_dw91_7:
    s_waitcnt vmcnt(6)
L_dw91_8:
    s_waitcnt vmcnt(7)
    buffer_load_dwordx4 v[112:115], v1, s[36:39], s56 offen offset:128 nt
    v_dot2c_f32_bf16 v76, v248, v14
    v_dot2c_f32_bf16 v77, v248, v15
    v_dot2c_f32_bf16 v78, v249, v14
    v_dot2c_f32_bf16 v79, v249, v15
    v_dot2c_f32_bf16 v80, v250, v14
    v_dot2c_f32_bf16 v81, v250, v15
    v_dot2c_f32_bf16 v82, v251, v14
    v_dot2c_f32_bf16 v83, v251, v15
    s_cmp_gt_i32 s68, 7
    s_cbranch_scc1 L_dw92_8
    s_cmp_gt_i32 s68, 6
    s_cbranch_scc1 L_dw92_7
    s_cmp_gt_i32 s68, 5
    s_cbranch_scc1 L_dw92_6
    s_cmp_gt_i32 s68, 4
    s_cbranch_scc1 L_dw92_5
    s_waitcnt vmcnt(3)
L_dw92_5:
    s_waitcnt vmcnt(4)
L_dw92_6:
    s_waitcnt vmcnt(5)
L_dw92_7:
    s_waitcnt vmcnt(6)
L_dw92_8:
    s_waitcnt vmcnt(7)
    buffer_load_dwordx4 v[116:119], v1, s[36:39], s56 offen offset:256 nt
    s_add_u32 s56, s89, 393216
    s_mov_b64 exec, 1
    ds_add_rtn_u32 v4, v2, v3 offset:8
    s_mov_b64 exec, -1
    v_cvt_pk_bf16_f32 v14, v38, 0
    v_cvt_pk_bf16_f32 v15, 0, v38
    v_dot2c_f32_bf16 v60, v84, v14
    v_dot2c_f32_bf16 v61, v84, v15
    v_dot2c_f32_bf16 v62, v85, v14
    v_dot2c_f32_bf16 v63, v85, v15
    v_dot2c_f32_bf16 v64, v86, v14
    v_dot2c_f32_bf16 v65, v86, v15
    v_dot2c_f32_bf16 v66, v87, v14
    v_dot2c_f32_bf16 v67, v87, v15
    s_waitcnt lgkmcnt(0)
    v_readfirstlane_b32 s52, v4
    s_sub_u32 s68, s68, s69
    s_and_b32 s52, s52, 3
    s_lshl_b32 s52, s52, 3
    s_mov_b32 s69, 0x1000000
    s_lshr_b32 s69, s69, s52
    s_sext_i32_i8 s69, s69
    s_add_u32 s68, s68, s69
    s_cmp_gt_i32 s68, 7
    s_cbranch_scc1 L_dw93_8
    s_cmp_gt_i32 s68, 6
    s_cbranch_scc1 L_dw93_7
    s_cmp_gt_i32 s68, 5
    s_cbranch_scc1 L_dw93_6
    s_cmp_gt_i32 s68, 4
    s_cbranch_scc1 L_dw93_5
    s_waitcnt vmcnt(3)
L_dw93_5:
    s_waitcnt vmcnt(4)
L_dw93_6:
    s_waitcnt vmcnt(5)
L_dw93_7:
    s_waitcnt vmcnt(6)
L_dw93_8:
    s_waitcnt vmcnt(7)
    buffer_load_dwordx4 v[120:123], v1, s[36:39], s56 offen offset:0 nt
    ds_read_b32 v5, v2 offset:4
    v_dot2c_f32_bf16 v68, v88, v14
    v_dot2c_f32_bf16 v69, v88, v15
    v_dot2c_f32_bf16 v70, v89, v14
    v_dot2c_f32_bf16 v71, v89, v15
    v_dot2c_f32_bf16 v72, v90, v14
    v_dot2c_f32_bf16 v73, v90, v15
    v_dot2c_f32_bf16 v74, v91, v14
    v_dot2c_f32_bf16 v75, v91, v15
    s_waitcnt lgkmcnt(0)
    v_readfirstlane_b32 s68, v5
    s_add_u32 s68, s68, s69
    s_cmp_gt_i32 s68, 7
    s_cbranch_scc1 L_dw94_8
    s_cmp_gt_i32 s68, 6
    s_cbranch_scc1 L_dw94_7
    s_cmp_gt_i32 s68, 5
    s_cbranch_scc1 L_dw94_6
    s_cmp_gt_i32 s68, 4
    s_cbranch_scc1 L_dw94_5
    s_waitcnt vmcnt(3)
L_dw94_5:
    s_waitcnt vmcnt(4)
L_dw94_6:
    s_waitcnt vmcnt(5)
L_dw94_7:
    s_waitcnt vmcnt(6)
L_dw94_8:
    s_waitcnt vmcnt(7)
    buffer_load_dwordx4 v[124:127], v1, s[36:39], s56 offen offset:128 nt
    s_mov_b64 exec, 1
    ds_add_u32 v2, v3 offset:0
    s_mov_b64 exec, -1
    v_dot2c_f32_bf16 v76, v92, v14
    v_dot2c_f32_bf16 v77, v92, v15
    v_dot2c_f32_bf16 v78, v93, v14
    v_dot2c_f32_bf16 v79, v93, v15
    v_dot2c_f32_bf16 v80, v94, v14
    v_dot2c_f32_bf16 v81, v94, v15
    v_dot2c_f32_bf16 v82, v95, v14
    v_dot2c_f32_bf16 v83, v95, v15
    s_cmp_gt_i32 s68, 7
    s_cbranch_scc1 L_dw95_8
    s_cmp_gt_i32 s68, 6
    s_cbranch_scc1 L_dw95_7
    s_cmp_gt_i32 s68, 5
    s_cbranch_scc1 L_dw95_6
    s_cmp_gt_i32 s68, 4
    s_cbranch_scc1 L_dw95_5
    s_waitcnt vmcnt(3)
L_dw95_5:
    s_waitcnt vmcnt(4)
L_dw95_6:
    s_waitcnt vmcnt(5)
L_dw95_7:
    s_waitcnt vmcnt(6)
L_dw95_8:
    s_waitcnt vmcnt(7)
    buffer_load_dwordx4 v[128:131], v1, s[36:39], s56 offen offset:256 nt
    s_add_u32 s56, s89, 786432
    v_cvt_pk_bf16_f32 v14, v39, 0
    v_cvt_pk_bf16_f32 v15, 0, v39
    v_dot2c_f32_bf16 v60, v96, v14
    v_dot2c_f32_bf16 v61, v96, v15
    v_dot2c_f32_bf16 v62, v97, v14
    v_dot2c_f32_bf16 v63, v97, v15
    v_dot2c_f32_bf16 v64, v98, v14
    v_dot2c_f32_bf16 v65, v98, v15
    v_dot2c_f32_bf16 v66, v99, v14
    v_dot2c_f32_bf16 v67, v99, v15
    s_nop 2
    v_permlane32_swap_b32 v60, v64
    v_permlane32_swap_b32 v61, v65
    v_permlane32_swap_b32 v62, v66
    v_permlane32_swap_b32 v63, v67
    v_add_f32 v60, v60, v64
    v_add_f32 v61, v61, v65
    v_add_f32 v62, v62, v66
    v_add_f32 v63, v63, v67
    s_nop 0
    v_permlane16_swap_b32 v60, v62
    v_permlane16_swap_b32 v61, v63
    v_add_f32 v60, v60, v62
    v_add_f32 v61, v61, v63
    s_nop 0
    v_add_f32_dpp v6, v60, v60 row_ror:8 row_mask:0xf bank_mask:0x3
    v_add_f32_dpp v6, v61, v61 row_ror:8 row_mask:0xf bank_mask:0xc
    ds_write_b32 v254, v6 offset:23808
    s_cmp_gt_i32 s68, 7
    s_cbranch_scc1 L_dw96_8
    s_cmp_gt_i32 s68, 6
    s_cbranch_scc1 L_dw96_7
    s_cmp_gt_i32 s68, 5
    s_cbranch_scc1 L_dw96_6
    s_cmp_gt_i32 s68, 4
    s_cbranch_scc1 L_dw96_5
    s_waitcnt vmcnt(3)
L_dw96_5:
    s_waitcnt vmcnt(4)
L_dw96_6:
    s_waitcnt vmcnt(5)
L_dw96_7:
    s_waitcnt vmcnt(6)
L_dw96_8:
    s_waitcnt vmcnt(7)
    buffer_load_dwordx4 v[132:135], v1, s[36:39], s56 offen offset:0 nt
    v_dot2c_f32_bf16 v68, v100, v14
    v_dot2c_f32_bf16 v69, v100, v15
    v_dot2c_f32_bf16 v70, v101, v14
    v_dot2c_f32_bf16 v71, v101, v15
    v_dot2c_f32_bf16 v72, v102, v14
    v_dot2c_f32_bf16 v73, v102, v15
    v_dot2c_f32_bf16 v74, v103, v14
    v_dot2c_f32_bf16 v75, v103, v15
    s_nop 2
    v_permlane32_swap_b32 v68, v72
    v_permlane32_swap_b32 v69, v73
    v_permlane32_swap_b32 v70, v74
    v_permlane32_swap_b32 v71, v75
    v_add_f32 v68, v68, v72
    v_add_f32 v69, v69, v73
    v_add_f32 v70, v70, v74
    v_add_f32 v71, v71, v75
    s_nop 0
    v_permlane16_swap_b32 v68, v70
    v_permlane16_swap_b32 v69, v71
    v_add_f32 v68, v68, v70
    v_add_f32 v69, v69, v71
    s_nop 0
    v_add_f32_dpp v7, v68, v68 row_ror:8 row_mask:0xf bank_mask:0x3
    v_add_f32_dpp v7, v69, v69 row_ror:8 row_mask:0xf bank_mask:0xc
    ds_write_b32 v254, v7 offset:24064
    s_cmp_gt_i32 s68, 7
    s_cbranch_scc1 L_dw97_8
    s_cmp_gt_i32 s68, 6
    s_cbranch_scc1 L_dw97_7
    s_cmp_gt_i32 s68, 5
    s_cbranch_scc1 L_dw97_6
    s_cmp_gt_i32 s68, 4
    s_cbranch_scc1 L_dw97_5
    s_waitcnt vmcnt(3)
L_dw97_5:
    s_waitcnt vmcnt(4)
L_dw97_6:
    s_waitcnt vmcnt(5)
L_dw97_7:
    s_waitcnt vmcnt(6)
L_dw97_8:
    s_waitcnt vmcnt(7)
    buffer_load_dwordx4 v[136:139], v1, s[36:39], s56 offen offset:128 nt
    ds_read_b32 v5, v2 offset:4
    v_dot2c_f32_bf16 v76, v104, v14
    v_dot2c_f32_bf16 v77, v104, v15
    v_dot2c_f32_bf16 v78, v105, v14
    v_dot2c_f32_bf16 v79, v105, v15
    v_dot2c_f32_bf16 v80, v106, v14
    v_dot2c_f32_bf16 v81, v106, v15
    v_dot2c_f32_bf16 v82, v107, v14
    v_dot2c_f32_bf16 v83, v107, v15
    s_nop 2
    v_permlane32_swap_b32 v76, v80
    v_permlane32_swap_b32 v77, v81
    v_permlane32_swap_b32 v78, v82
    v_permlane32_swap_b32 v79, v83
    v_add_f32 v76, v76, v80
    v_add_f32 v77, v77, v81
    v_add_f32 v78, v78, v82
    v_add_f32 v79, v79, v83
    s_nop 0
    v_permlane16_swap_b32 v76, v78
    v_permlane16_swap_b32 v77, v79
    v_add_f32 v76, v76, v78
    v_add_f32 v77, v77, v79
    s_nop 0
    v_add_f32_dpp v8, v76, v76 row_ror:8 row_mask:0xf bank_mask:0x3
    v_add_f32_dpp v8, v77, v77 row_ror:8 row_mask:0xf bank_mask:0xc
    ds_write_b32 v254, v8 offset:24320
    s_mov_b64 exec, 1
    ds_add_u32 v2, v3 offset:40
    s_mov_b64 exec, -1
    s_waitcnt lgkmcnt(0)
    v_readfirstlane_b32 s68, v5
    s_add_u32 s68, s68, s69
    s_cmp_gt_i32 s68, 7
    s_cbranch_scc1 L_dw98_8
    s_cmp_gt_i32 s68, 6
    s_cbranch_scc1 L_dw98_7
    s_cmp_gt_i32 s68, 5
    s_cbranch_scc1 L_dw98_6
    s_cmp_gt_i32 s68, 4
    s_cbranch_scc1 L_dw98_5
    s_waitcnt vmcnt(3)
L_dw98_5:
    s_waitcnt vmcnt(4)
L_dw98_6:
    s_waitcnt vmcnt(5)
L_dw98_7:
    s_waitcnt vmcnt(6)
L_dw98_8:
    s_waitcnt vmcnt(7)
    buffer_load_dwordx4 v[140:143], v1, s[36:39], s56 offen offset:256 nt
    s_add_u32 s56, s89, 1179648
    s_mov_b64 exec, 1
    ds_add_rtn_u32 v4, v2, v3 offset:8
    s_mov_b64 exec, -1
    v_cvt_pk_bf16_f32 v14, v40, 0
    v_cvt_pk_bf16_f32 v15, 0, v40
    v_dot2_f32_bf16 v60, v108, v14, 0
    v_dot2_f32_bf16 v61, v108, v15, 0
    v_dot2_f32_bf16 v62, v109, v14, 0
    v_dot2_f32_bf16 v63, v109, v15, 0
    v_dot2_f32_bf16 v64, v110, v14, 0
    v_dot2_f32_bf16 v65, v110, v15, 0
    v_dot2_f32_bf16 v66, v111, v14, 0
    v_dot2_f32_bf16 v67, v111, v15, 0
    s_waitcnt lgkmcnt(0)
    v_readfirstlane_b32 s52, v4
    s_sub_u32 s68, s68, s69
    s_and_b32 s52, s52, 3
    s_lshl_b32 s52, s52, 3
    s_mov_b32 s69, 0x1000000
    s_lshr_b32 s69, s69, s52
    s_sext_i32_i8 s69, s69
    s_add_u32 s68, s68, s69
    s_cmp_gt_i32 s68, 7
    s_cbranch_scc1 L_dw99_8
    s_cmp_gt_i32 s68, 6
    s_cbranch_scc1 L_dw99_7
    s_cmp_gt_i32 s68, 5
    s_cbranch_scc1 L_dw99_6
    s_cmp_gt_i32 s68, 4
    s_cbranch_scc1 L_dw99_5
    s_waitcnt vmcnt(3)
L_dw99_5:
    s_waitcnt vmcnt(4)
L_dw99_6:
    s_waitcnt vmcnt(5)
L_dw99_7:
    s_waitcnt vmcnt(6)
L_dw99_8:
    s_waitcnt vmcnt(7)
    buffer_load_dwordx4 v[144:147], v1, s[36:39], s56 offen offset:0 nt
    v_dot2_f32_bf16 v68, v112, v14, 0
    v_dot2_f32_bf16 v69, v112, v15, 0
    v_dot2_f32_bf16 v70, v113, v14, 0
    v_dot2_f32_bf16 v71, v113, v15, 0
    v_dot2_f32_bf16 v72, v114, v14, 0
    v_dot2_f32_bf16 v73, v114, v15, 0
    v_dot2_f32_bf16 v74, v115, v14, 0
    v_dot2_f32_bf16 v75, v115, v15, 0
    s_cmp_gt_i32 s68, 7
    s_cbranch_scc1 L_dw100_8
    s_cmp_gt_i32 s68, 6
    s_cbranch_scc1 L_dw100_7
    s_cmp_gt_i32 s68, 5
    s_cbranch_scc1 L_dw100_6
    s_cmp_gt_i32 s68, 4
    s_cbranch_scc1 L_dw100_5
    s_waitcnt vmcnt(3)
L_dw100_5:
    s_waitcnt vmcnt(4)
L_dw100_6:
    s_waitcnt vmcnt(5)
L_dw100_7:
    s_waitcnt vmcnt(6)
L_dw100_8:
    s_waitcnt vmcnt(7)
    buffer_load_dwordx4 v[148:151], v1, s[36:39], s56 offen offset:128 nt
    v_dot2_f32_bf16 v76, v116, v14, 0
    v_dot2_f32_bf16 v77, v116, v15, 0
    v_dot2_f32_bf16 v78, v117, v14, 0
    v_dot2_f32_bf16 v79, v117, v15, 0
    v_dot2_f32_bf16 v80, v118, v14, 0
    v_dot2_f32_bf16 v81, v118, v15, 0
    v_dot2_f32_bf16 v82, v119, v14, 0
    v_dot2_f32_bf16 v83, v119, v15, 0
    s_cmp_gt_i32 s68, 7
    s_cbranch_scc1 L_dw101_8
    s_cmp_gt_i32 s68, 6
    s_cbranch_scc1 L_dw101_7
    s_cmp_gt_i32 s68, 5
    s_cbranch_scc1 L_dw101_6
    s_cmp_gt_i32 s68, 4
    s_cbranch_scc1 L_dw101_5
    s_waitcnt vmcnt(3)
L_dw101_5:
    s_waitcnt vmcnt(4)
L_dw101_6:
    s_waitcnt vmcnt(5)
L_dw101_7:
    s_waitcnt vmcnt(6)
L_dw101_8:
    s_waitcnt vmcnt(7)
    buffer_load_dwordx4 v[152:155], v1, s[36:39], s56 offen offset:256 nt
    s_add_u32 s56, s86, 50331648
    ds_read_b32 v5, v2 offset:4
    v_cvt_pk_bf16_f32 v14, v41, 0
    v_cvt_pk_bf16_f32 v15, 0, v41
    v_dot2c_f32_bf16 v60, v120, v14
    v_dot2c_f32_bf16 v61, v120, v15
    v_dot2c_f32_bf16 v62, v121, v14
    v_dot2c_f32_bf16 v63, v121, v15
    v_dot2c_f32_bf16 v64, v122, v14
    v_dot2c_f32_bf16 v65, v122, v15
    v_dot2c_f32_bf16 v66, v123, v14
    v_dot2c_f32_bf16 v67, v123, v15
    s_waitcnt lgkmcnt(0)
    v_readfirstlane_b32 s68, v5
    s_add_u32 s68, s68, s69
    s_cmp_gt_i32 s68, 7
    s_cbranch_scc1 L_dw102_8
    s_cmp_gt_i32 s68, 6
    s_cbranch_scc1 L_dw102_7
    s_cmp_gt_i32 s68, 5
    s_cbranch_scc1 L_dw102_6
    s_cmp_gt_i32 s68, 4
    s_cbranch_scc1 L_dw102_5
    s_waitcnt vmcnt(3)
L_dw102_5:
    s_waitcnt vmcnt(4)
L_dw102_6:
    s_waitcnt vmcnt(5)
L_dw102_7:
    s_waitcnt vmcnt(6)
L_dw102_8:
    s_waitcnt vmcnt(7)
    buffer_load_dwordx4 v[156:159], v1, s[36:39], s56 offen offset:0 nt
    s_mov_b64 exec, 1
    ds_add_u32 v2, v3 offset:0
    s_mov_b64 exec, -1
    v_dot2c_f32_bf16 v68, v124, v14
    v_dot2c_f32_bf16 v69, v124, v15
    v_dot2c_f32_bf16 v70, v125, v14
    v_dot2c_f32_bf16 v71, v125, v15
    v_dot2c_f32_bf16 v72, v126, v14
    v_dot2c_f32_bf16 v73, v126, v15
    v_dot2c_f32_bf16 v74, v127, v14
    v_dot2c_f32_bf16 v75, v127, v15
    s_cmp_gt_i32 s68, 7
    s_cbranch_scc1 L_dw103_8
    s_cmp_gt_i32 s68, 6
    s_cbranch_scc1 L_dw103_7
    s_cmp_gt_i32 s68, 5
    s_cbranch_scc1 L_dw103_6
    s_cmp_gt_i32 s68, 4
    s_cbranch_scc1 L_dw103_5
    s_waitcnt vmcnt(3)
L_dw103_5:
    s_waitcnt vmcnt(4)
L_dw103_6:
    s_waitcnt vmcnt(5)
L_dw103_7:
    s_waitcnt vmcnt(6)
L_dw103_8:
    s_waitcnt vmcnt(7)
    buffer_load_dwordx4 v[160:163], v1, s[36:39], s56 offen offset:128 nt
    v_dot2c_f32_bf16 v76, v128, v14
    v_dot2c_f32_bf16 v77, v128, v15
    v_dot2c_f32_bf16 v78, v129, v14
    v_dot2c_f32_bf16 v79, v129, v15
    v_dot2c_f32_bf16 v80, v130, v14
    v_dot2c_f32_bf16 v81, v130, v15
    v_dot2c_f32_bf16 v82, v131, v14
    v_dot2c_f32_bf16 v83, v131, v15
    s_cmp_gt_i32 s68, 7
    s_cbranch_scc1 L_dw104_8
    s_cmp_gt_i32 s68, 6
    s_cbranch_scc1 L_dw104_7
    s_cmp_gt_i32 s68, 5
    s_cbranch_scc1 L_dw104_6
    s_cmp_gt_i32 s68, 4
    s_cbranch_scc1 L_dw104_5
    s_waitcnt vmcnt(3)
L_dw104_5:
    s_waitcnt vmcnt(4)
L_dw104_6:
    s_waitcnt vmcnt(5)
L_dw104_7:
    s_waitcnt vmcnt(6)
L_dw104_8:
    s_waitcnt vmcnt(7)
    buffer_load_dwordx4 v[164:167], v1, s[36:39], s56 offen offset:256 nt
    s_add_u32 s56, s86, 50724864
    s_mov_b64 exec, 1
    ds_add_rtn_u32 v4, v2, v3 offset:8
    s_mov_b64 exec, -1
    v_cvt_pk_bf16_f32 v14, v42, 0
    v_cvt_pk_bf16_f32 v15, 0, v42
    v_dot2c_f32_bf16 v60, v132, v14
    v_dot2c_f32_bf16 v61, v132, v15
    v_dot2c_f32_bf16 v62, v133, v14
    v_dot2c_f32_bf16 v63, v133, v15
    v_dot2c_f32_bf16 v64, v134, v14
    v_dot2c_f32_bf16 v65, v134, v15
    v_dot2c_f32_bf16 v66, v135, v14
    v_dot2c_f32_bf16 v67, v135, v15
    s_waitcnt lgkmcnt(0)
    v_readfirstlane_b32 s52, v4
    s_sub_u32 s68, s68, s69
    s_and_b32 s52, s52, 3
    s_lshl_b32 s52, s52, 3
    s_mov_b32 s69, 0x1000000
    s_lshr_b32 s69, s69, s52
    s_sext_i32_i8 s69, s69
    s_add_u32 s68, s68, s69
    s_cmp_gt_i32 s68, 7
    s_cbranch_scc1 L_dw105_8
    s_cmp_gt_i32 s68, 6
    s_cbranch_scc1 L_dw105_7
    s_cmp_gt_i32 s68, 5
    s_cbranch_scc1 L_dw105_6
    s_cmp_gt_i32 s68, 4
    s_cbranch_scc1 L_dw105_5
    s_waitcnt vmcnt(3)
L_dw105_5:
    s_waitcnt vmcnt(4)
L_dw105_6:
    s_waitcnt vmcnt(5)
L_dw105_7:
    s_waitcnt vmcnt(6)
L_dw105_8:
    s_waitcnt vmcnt(7)
    buffer_load_dwordx4 v[168:171], v1, s[36:39], s56 offen offset:0 nt
    ds_read_b32 v5, v2 offset:4
    v_dot2c_f32_bf16 v68, v136, v14
    v_dot2c_f32_bf16 v69, v136, v15
    v_dot2c_f32_bf16 v70, v137, v14
    v_dot2c_f32_bf16 v71, v137, v15
    v_dot2c_f32_bf16 v72, v138, v14
    v_dot2c_f32_bf16 v73, v138, v15
    v_dot2c_f32_bf16 v74, v139, v14
    v_dot2c_f32_bf16 v75, v139, v15
    s_waitcnt lgkmcnt(0)
    v_readfirstlane_b32 s68, v5
    s_add_u32 s68, s68, s69
    s_cmp_gt_i32 s68, 7
    s_cbranch_scc1 L_dw106_8
    s_cmp_gt_i32 s68, 6
    s_cbranch_scc1 L_dw106_7
    s_cmp_gt_i32 s68, 5
    s_cbranch_scc1 L_dw106_6
    s_cmp_gt_i32 s68, 4
    s_cbranch_scc1 L_dw106_5
    s_waitcnt vmcnt(3)
L_dw106_5:
    s_waitcnt vmcnt(4)
L_dw106_6:
    s_waitcnt vmcnt(5)
L_dw106_7:
    s_waitcnt vmcnt(6)
L_dw106_8:
    s_waitcnt vmcnt(7)
    buffer_load_dwordx4 v[172:175], v1, s[36:39], s56 offen offset:128 nt
    v_dot2c_f32_bf16 v76, v140, v14
    v_dot2c_f32_bf16 v77, v140, v15
    v_dot2c_f32_bf16 v78, v141, v14
    v_dot2c_f32_bf16 v79, v141, v15
    v_dot2c_f32_bf16 v80, v142, v14
    v_dot2c_f32_bf16 v81, v142, v15
    v_dot2c_f32_bf16 v82, v143, v14
    v_dot2c_f32_bf16 v83, v143, v15
    s_cmp_gt_i32 s68, 7
    s_cbranch_scc1 L_dw107_8
    s_cmp_gt_i32 s68, 6
    s_cbranch_scc1 L_dw107_7
    s_cmp_gt_i32 s68, 5
    s_cbranch_scc1 L_dw107_6
    s_cmp_gt_i32 s68, 4
    s_cbranch_scc1 L_dw107_5
    s_waitcnt vmcnt(3)
L_dw107_5:
    s_waitcnt vmcnt(4)
L_dw107_6:
    s_waitcnt vmcnt(5)
L_dw107_7:
    s_waitcnt vmcnt(6)
L_dw107_8:
    s_waitcnt vmcnt(7)
    buffer_load_dwordx4 v[176:179], v1, s[36:39], s56 offen offset:256 nt
    s_add_u32 s56, s86, 51118080
    v_cvt_pk_bf16_f32 v14, v43, 0
    v_cvt_pk_bf16_f32 v15, 0, v43
    v_dot2c_f32_bf16 v60, v144, v14
    v_dot2c_f32_bf16 v61, v144, v15
    v_dot2c_f32_bf16 v62, v145, v14
    v_dot2c_f32_bf16 v63, v145, v15
    v_dot2c_f32_bf16 v64, v146, v14
    v_dot2c_f32_bf16 v65, v146, v15
    v_dot2c_f32_bf16 v66, v147, v14
    v_dot2c_f32_bf16 v67, v147, v15
    s_nop 2
    v_permlane32_swap_b32 v60, v64
    v_permlane32_swap_b32 v61, v65
    v_permlane32_swap_b32 v62, v66
    v_permlane32_swap_b32 v63, v67
    v_add_f32 v60, v60, v64
    v_add_f32 v61, v61, v65
    v_add_f32 v62, v62, v66
    v_add_f32 v63, v63, v67
    s_nop 0
    v_permlane16_swap_b32 v60, v62
    v_permlane16_swap_b32 v61, v63
    v_add_f32 v60, v60, v62
    v_add_f32 v61, v61, v63
    s_nop 0
    v_add_f32_dpp v6, v60, v60 row_ror:8 row_mask:0xf bank_mask:0x3
    v_add_f32_dpp v6, v61, v61 row_ror:8 row_mask:0xf bank_mask:0xc
    ds_write_b32 v254, v6 offset:26880
    s_cmp_gt_i32 s68, 7
    s_cbranch_scc1 L_dw108_8
    s_cmp_gt_i32 s68, 6
    s_cbranch_scc1 L_dw108_7
    s_cmp_gt_i32 s68, 5
    s_cbranch_scc1 L_dw108_6
    s_cmp_gt_i32 s68, 4
    s_cbranch_scc1 L_dw108_5
    s_waitcnt vmcnt(3)
L_dw108_5:
    s_waitcnt vmcnt(4)
L_dw108_6:
    s_waitcnt vmcnt(5)
L_dw108_7:
    s_waitcnt vmcnt(6)
L_dw108_8:
    s_waitcnt vmcnt(7)
    buffer_load_dwordx4 v[180:183], v1, s[36:39], s56 offen offset:0 nt
    v_dot2c_f32_bf16 v68, v148, v14
    v_dot2c_f32_bf16 v69, v148, v15
    v_dot2c_f32_bf16 v70, v149, v14
    v_dot2c_f32_bf16 v71, v149, v15
    v_dot2c_f32_bf16 v72, v150, v14
    v_dot2c_f32_bf16 v73, v150, v15
    v_dot2c_f32_bf16 v74, v151, v14
    v_dot2c_f32_bf16 v75, v151, v15
    s_nop 2
    v_permlane32_swap_b32 v68, v72
    v_permlane32_swap_b32 v69, v73
    v_permlane32_swap_b32 v70, v74
    v_permlane32_swap_b32 v71, v75
    v_add_f32 v68, v68, v72
    v_add_f32 v69, v69, v73
    v_add_f32 v70, v70, v74
    v_add_f32 v71, v71, v75
    s_nop 0
    v_permlane16_swap_b32 v68, v70
    v_permlane16_swap_b32 v69, v71
    v_add_f32 v68, v68, v70
    v_add_f32 v69, v69, v71
    s_nop 0
    v_add_f32_dpp v7, v68, v68 row_ror:8 row_mask:0xf bank_mask:0x3
    v_add_f32_dpp v7, v69, v69 row_ror:8 row_mask:0xf bank_mask:0xc
    ds_write_b32 v254, v7 offset:27136
    s_cmp_gt_i32 s68, 7
    s_cbranch_scc1 L_dw109_8
    s_cmp_gt_i32 s68, 6
    s_cbranch_scc1 L_dw109_7
    s_cmp_gt_i32 s68, 5
    s_cbranch_scc1 L_dw109_6
    s_cmp_gt_i32 s68, 4
    s_cbranch_scc1 L_dw109_5
    s_waitcnt vmcnt(3)
L_dw109_5:
    s_waitcnt vmcnt(4)
L_dw109_6:
    s_waitcnt vmcnt(5)
L_dw109_7:
    s_waitcnt vmcnt(6)
L_dw109_8:
    s_waitcnt vmcnt(7)
    buffer_load_dwordx4 v[184:187], v1, s[36:39], s56 offen offset:128 nt
    ds_read_b32 v5, v2 offset:4
    v_dot2c_f32_bf16 v76, v152, v14
    v_dot2c_f32_bf16 v77, v152, v15
    v_dot2c_f32_bf16 v78, v153, v14
    v_dot2c_f32_bf16 v79, v153, v15
    v_dot2c_f32_bf16 v80, v154, v14
    v_dot2c_f32_bf16 v81, v154, v15
    v_dot2c_f32_bf16 v82, v155, v14
    v_dot2c_f32_bf16 v83, v155, v15
    s_nop 2
    v_permlane32_swap_b32 v76, v80
    v_permlane32_swap_b32 v77, v81
    v_permlane32_swap_b32 v78, v82
    v_permlane32_swap_b32 v79, v83
    v_add_f32 v76, v76, v80
    v_add_f32 v77, v77, v81
    v_add_f32 v78, v78, v82
    v_add_f32 v79, v79, v83
    s_nop 0
    v_permlane16_swap_b32 v76, v78
    v_permlane16_swap_b32 v77, v79
    v_add_f32 v76, v76, v78
    v_add_f32 v77, v77, v79
    s_nop 0
    v_add_f32_dpp v8, v76, v76 row_ror:8 row_mask:0xf bank_mask:0x3
    v_add_f32_dpp v8, v77, v77 row_ror:8 row_mask:0xf bank_mask:0xc
    ds_write_b32 v254, v8 offset:27392
    s_mov_b64 exec, 1
    ds_add_u32 v2, v3 offset:44
    s_mov_b64 exec, -1
    s_waitcnt lgkmcnt(0)
    v_readfirstlane_b32 s68, v5
    s_add_u32 s68, s68, s69
    s_cmp_gt_i32 s68, 7
    s_cbranch_scc1 L_dw110_8
    s_cmp_gt_i32 s68, 6
    s_cbranch_scc1 L_dw110_7
    s_cmp_gt_i32 s68, 5
    s_cbranch_scc1 L_dw110_6
    s_cmp_gt_i32 s68, 4
    s_cbranch_scc1 L_dw110_5
    s_waitcnt vmcnt(3)
L_dw110_5:
    s_waitcnt vmcnt(4)
L_dw110_6:
    s_waitcnt vmcnt(5)
L_dw110_7:
    s_waitcnt vmcnt(6)
L_dw110_8:
    s_waitcnt vmcnt(7)
    buffer_load_dwordx4 v[188:191], v1, s[36:39], s56 offen offset:256 nt
    s_add_u32 s56, s86, 51511296
    s_mov_b64 exec, 1
    ds_add_rtn_u32 v4, v2, v3 offset:8
    s_mov_b64 exec, -1
    s_mov_b64 exec, 1
    ds_add_u32 v2, v3 offset:0
    s_mov_b64 exec, -1
    v_cvt_pk_bf16_f32 v14, v44, 0
    v_cvt_pk_bf16_f32 v15, 0, v44
    v_dot2_f32_bf16 v60, v156, v14, 0
    v_dot2_f32_bf16 v61, v156, v15, 0
    v_dot2_f32_bf16 v62, v157, v14, 0
    v_dot2_f32_bf16 v63, v157, v15, 0
    v_dot2_f32_bf16 v64, v158, v14, 0
    v_dot2_f32_bf16 v65, v158, v15, 0
    v_dot2_f32_bf16 v66, v159, v14, 0
    v_dot2_f32_bf16 v67, v159, v15, 0
    s_waitcnt lgkmcnt(0)
    v_readfirstlane_b32 s52, v4
    s_sub_u32 s68, s68, s69
    s_and_b32 s52, s52, 3
    s_lshl_b32 s52, s52, 3
    s_mov_b32 s69, 0x1000000
    s_lshr_b32 s69, s69, s52
    s_sext_i32_i8 s69, s69
    s_add_u32 s68, s68, s69
    s_cmp_gt_i32 s68, 7
    s_cbranch_scc1 L_dw111_8
    s_cmp_gt_i32 s68, 6
    s_cbranch_scc1 L_dw111_7
    s_cmp_gt_i32 s68, 5
    s_cbranch_scc1 L_dw111_6
    s_cmp_gt_i32 s68, 4
    s_cbranch_scc1 L_dw111_5
    s_waitcnt vmcnt(3)
L_dw111_5:
    s_waitcnt vmcnt(4)
L_dw111_6:
    s_waitcnt vmcnt(5)
L_dw111_7:
    s_waitcnt vmcnt(6)
L_dw111_8:
    s_waitcnt vmcnt(7)
    buffer_load_dwordx4 v[192:195], v1, s[36:39], s56 offen offset:0 nt
    v_dot2_f32_bf16 v68, v160, v14, 0
    v_dot2_f32_bf16 v69, v160, v15, 0
    v_dot2_f32_bf16 v70, v161, v14, 0
    v_dot2_f32_bf16 v71, v161, v15, 0
    v_dot2_f32_bf16 v72, v162, v14, 0
    v_dot2_f32_bf16 v73, v162, v15, 0
    v_dot2_f32_bf16 v74, v163, v14, 0
    v_dot2_f32_bf16 v75, v163, v15, 0
    s_cmp_gt_i32 s68, 7
    s_cbranch_scc1 L_dw112_8
    s_cmp_gt_i32 s68, 6
    s_cbranch_scc1 L_dw112_7
    s_cmp_gt_i32 s68, 5
    s_cbranch_scc1 L_dw112_6
    s_cmp_gt_i32 s68, 4
    s_cbranch_scc1 L_dw112_5
    s_waitcnt vmcnt(3)
L_dw112_5:
    s_waitcnt vmcnt(4)
L_dw112_6:
    s_waitcnt vmcnt(5)
L_dw112_7:
    s_waitcnt vmcnt(6)
L_dw112_8:
    s_waitcnt vmcnt(7)
    buffer_load_dwordx4 v[196:199], v1, s[36:39], s56 offen offset:128 nt
    v_dot2_f32_bf16 v76, v164, v14, 0
    v_dot2_f32_bf16 v77, v164, v15, 0
    v_dot2_f32_bf16 v78, v165, v14, 0
    v_dot2_f32_bf16 v79, v165, v15, 0
    v_dot2_f32_bf16 v80, v166, v14, 0
    v_dot2_f32_bf16 v81, v166, v15, 0
    v_dot2_f32_bf16 v82, v167, v14, 0
    v_dot2_f32_bf16 v83, v167, v15, 0
    s_cmp_gt_i32 s68, 7
    s_cbranch_scc1 L_dw113_8
    s_cmp_gt_i32 s68, 6
    s_cbranch_scc1 L_dw113_7
    s_cmp_gt_i32 s68, 5
    s_cbranch_scc1 L_dw113_6
    s_cmp_gt_i32 s68, 4
    s_cbranch_scc1 L_dw113_5
    s_waitcnt vmcnt(3)
L_dw113_5:
    s_waitcnt vmcnt(4)
L_dw113_6:
    s_waitcnt vmcnt(5)
L_dw113_7:
    s_waitcnt vmcnt(6)
L_dw113_8:
    s_waitcnt vmcnt(7)
    buffer_load_dwordx4 v[200:203], v1, s[36:39], s56 offen offset:256 nt
    s_add_u32 s56, s87, 50331648
    ds_read_b32 v5, v2 offset:4
    v_cvt_pk_bf16_f32 v14, v45, 0
    v_cvt_pk_bf16_f32 v15, 0, v45
    v_dot2c_f32_bf16 v60, v168, v14
    v_dot2c_f32_bf16 v61, v168, v15
    v_dot2c_f32_bf16 v62, v169, v14
    v_dot2c_f32_bf16 v63, v169, v15
    v_dot2c_f32_bf16 v64, v170, v14
    v_dot2c_f32_bf16 v65, v170, v15
    v_dot2c_f32_bf16 v66, v171, v14
    v_dot2c_f32_bf16 v67, v171, v15
    s_waitcnt lgkmcnt(0)
    v_readfirstlane_b32 s68, v5
    s_add_u32 s68, s68, s69
    s_cmp_gt_i32 s68, 7
    s_cbranch_scc1 L_dw114_8
    s_cmp_gt_i32 s68, 6
    s_cbranch_scc1 L_dw114_7
    s_cmp_gt_i32 s68, 5
    s_cbranch_scc1 L_dw114_6
    s_cmp_gt_i32 s68, 4
    s_cbranch_scc1 L_dw114_5
    s_waitcnt vmcnt(3)
L_dw114_5:
    s_waitcnt vmcnt(4)
L_dw114_6:
    s_waitcnt vmcnt(5)
L_dw114_7:
    s_waitcnt vmcnt(6)
L_dw114_8:
    s_waitcnt vmcnt(7)
    buffer_load_dwordx4 v[204:207], v1, s[36:39], s56 offen offset:0 nt
    v_dot2c_f32_bf16 v68, v172, v14
    v_dot2c_f32_bf16 v69, v172, v15
    v_dot2c_f32_bf16 v70, v173, v14
    v_dot2c_f32_bf16 v71, v173, v15
    v_dot2c_f32_bf16 v72, v174, v14
    v_dot2c_f32_bf16 v73, v174, v15
    v_dot2c_f32_bf16 v74, v175, v14
    v_dot2c_f32_bf16 v75, v175, v15
    s_cmp_gt_i32 s68, 7
    s_cbranch_scc1 L_dw115_8
    s_cmp_gt_i32 s68, 6
    s_cbranch_scc1 L_dw115_7
    s_cmp_gt_i32 s68, 5
    s_cbranch_scc1 L_dw115_6
    s_cmp_gt_i32 s68, 4
    s_cbranch_scc1 L_dw115_5
    s_waitcnt vmcnt(3)
L_dw115_5:
    s_waitcnt vmcnt(4)
L_dw115_6:
    s_waitcnt vmcnt(5)
L_dw115_7:
    s_waitcnt vmcnt(6)
L_dw115_8:
    s_waitcnt vmcnt(7)
    buffer_load_dwordx4 v[208:211], v1, s[36:39], s56 offen offset:128 nt
    v_dot2c_f32_bf16 v76, v176, v14
    v_dot2c_f32_bf16 v77, v176, v15
    v_dot2c_f32_bf16 v78, v177, v14
    v_dot2c_f32_bf16 v79, v177, v15
    v_dot2c_f32_bf16 v80, v178, v14
    v_dot2c_f32_bf16 v81, v178, v15
    v_dot2c_f32_bf16 v82, v179, v14
    v_dot2c_f32_bf16 v83, v179, v15
    s_cmp_gt_i32 s68, 7
    s_cbranch_scc1 L_dw116_8
    s_cmp_gt_i32 s68, 6
    s_cbranch_scc1 L_dw116_7
    s_cmp_gt_i32 s68, 5
    s_cbranch_scc1 L_dw116_6
    s_cmp_gt_i32 s68, 4
    s_cbranch_scc1 L_dw116_5
    s_waitcnt vmcnt(3)
L_dw116_5:
    s_waitcnt vmcnt(4)
L_dw116_6:
    s_waitcnt vmcnt(5)
L_dw116_7:
    s_waitcnt vmcnt(6)
L_dw116_8:
    s_waitcnt vmcnt(7)
    buffer_load_dwordx4 v[212:215], v1, s[36:39], s56 offen offset:256 nt
    s_add_u32 s56, s87, 50724864
    s_mov_b64 exec, 1
    ds_add_rtn_u32 v4, v2, v3 offset:8
    s_mov_b64 exec, -1
    v_cvt_pk_bf16_f32 v14, v46, 0
    v_cvt_pk_bf16_f32 v15, 0, v46
    v_dot2c_f32_bf16 v60, v180, v14
    v_dot2c_f32_bf16 v61, v180, v15
    v_dot2c_f32_bf16 v62, v181, v14
    v_dot2c_f32_bf16 v63, v181, v15
    v_dot2c_f32_bf16 v64, v182, v14
    v_dot2c_f32_bf16 v65, v182, v15
    v_dot2c_f32_bf16 v66, v183, v14
    v_dot2c_f32_bf16 v67, v183, v15
    v_lshrrev_b32 v10, 3, v0
    v_and_b32 v10, 3, v10
    v_xor_b32 v10, s3, v10
    v_lshrrev_b32 v11, 2, v0
    v_lshlrev_b32 v11, 7, v11
    v_lshl_add_u32 v10, v10, 5, v11
    v_and_b32 v11, 3, v0
    v_lshl_add_u32 v10, v11, 3, v10
    v_add_u32 v16, 42240, v10
    s_movk_i32 s53, 576
    v_and_b32 v10, 1, v0
    v_and_b32 v11, 48, v0
    v_mad_u32_u24 v17, v10, s53, v11
    s_lshl2_add_u32 s65, s49, s3
    s_mul_i32 s65, s65, 6144
    s_lshl3_add_u32 s53, s48, s30
    s_lshl_b32 s53, s53, 7
    s_add_u32 s65, s65, s53
    s_add_u32 s65, s65, 524288
    v_lshrrev_b32 v10, 3, v0
    v_mul_u32_u24 v10, 3072, v10
    v_add_u32 v18, v10, v253
    v_and_b32 v10, 15, v0
    s_lshl_b32 s53, s3, 7
    v_lshl_add_u32 v19, v10, 3, s53
    s_waitcnt lgkmcnt(0)
    v_readfirstlane_b32 s52, v4
    s_sub_u32 s68, s68, s69
    s_and_b32 s52, s52, 3
    s_lshl_b32 s52, s52, 3
    s_mov_b32 s69, 0x1000000
    s_lshr_b32 s69, s69, s52
    s_sext_i32_i8 s69, s69
    s_add_u32 s68, s68, s69
    s_cmp_gt_i32 s68, 7
    s_cbranch_scc1 L_dw117_8
    s_cmp_gt_i32 s68, 6
    s_cbranch_scc1 L_dw117_7
    s_cmp_gt_i32 s68, 5
    s_cbranch_scc1 L_dw117_6
    s_cmp_gt_i32 s68, 4
    s_cbranch_scc1 L_dw117_5
    s_waitcnt vmcnt(3)
L_dw117_5:
    s_waitcnt vmcnt(4)
L_dw117_6:
    s_waitcnt vmcnt(5)
L_dw117_7:
    s_waitcnt vmcnt(6)
L_dw117_8:
    s_waitcnt vmcnt(7)
    buffer_load_dwordx4 v[216:219], v1, s[36:39], s56 offen offset:0 nt
    ds_read_b32 v5, v2 offset:4
    v_dot2c_f32_bf16 v68, v184, v14
    v_dot2c_f32_bf16 v69, v184, v15
    v_dot2c_f32_bf16 v70, v185, v14
    v_dot2c_f32_bf16 v71, v185, v15
    v_dot2c_f32_bf16 v72, v186, v14
    v_dot2c_f32_bf16 v73, v186, v15
    v_dot2c_f32_bf16 v74, v187, v14
    v_dot2c_f32_bf16 v75, v187, v15
    s_waitcnt lgkmcnt(0)
    v_readfirstlane_b32 s68, v5
    s_add_u32 s68, s68, s69
    s_cmp_gt_i32 s68, 7
    s_cbranch_scc1 L_dw118_8
    s_cmp_gt_i32 s68, 6
    s_cbranch_scc1 L_dw118_7
    s_cmp_gt_i32 s68, 5
    s_cbranch_scc1 L_dw118_6
    s_cmp_gt_i32 s68, 4
    s_cbranch_scc1 L_dw118_5
    s_waitcnt vmcnt(3)
L_dw118_5:
    s_waitcnt vmcnt(4)
L_dw118_6:
    s_waitcnt vmcnt(5)
L_dw118_7:
    s_waitcnt vmcnt(6)
L_dw118_8:
    s_waitcnt vmcnt(7)
    buffer_load_dwordx4 v[220:223], v1, s[36:39], s56 offen offset:128 nt
    s_mov_b64 exec, 1
    ds_add_u32 v2, v3 offset:0
    s_mov_b64 exec, -1
    v_dot2c_f32_bf16 v76, v188, v14
    v_dot2c_f32_bf16 v77, v188, v15
    v_dot2c_f32_bf16 v78, v189, v14
    v_dot2c_f32_bf16 v79, v189, v15
    v_dot2c_f32_bf16 v80, v190, v14
    v_dot2c_f32_bf16 v81, v190, v15
    v_dot2c_f32_bf16 v82, v191, v14
    v_dot2c_f32_bf16 v83, v191, v15
    s_cmp_gt_i32 s68, 7
    s_cbranch_scc1 L_dw119_8
    s_cmp_gt_i32 s68, 6
    s_cbranch_scc1 L_dw119_7
    s_cmp_gt_i32 s68, 5
    s_cbranch_scc1 L_dw119_6
    s_cmp_gt_i32 s68, 4
    s_cbranch_scc1 L_dw119_5
    s_waitcnt vmcnt(3)
L_dw119_5:
    s_waitcnt vmcnt(4)
L_dw119_6:
    s_waitcnt vmcnt(5)
L_dw119_7:
    s_waitcnt vmcnt(6)
L_dw119_8:
    s_waitcnt vmcnt(7)
    buffer_load_dwordx4 v[224:227], v1, s[36:39], s56 offen offset:256 nt
    s_add_u32 s56, s87, 51118080
    v_cvt_pk_bf16_f32 v14, v47, 0
    v_cvt_pk_bf16_f32 v15, 0, v47
    v_dot2c_f32_bf16 v60, v192, v14
    v_dot2c_f32_bf16 v61, v192, v15
    v_dot2c_f32_bf16 v62, v193, v14
    v_dot2c_f32_bf16 v63, v193, v15
    v_dot2c_f32_bf16 v64, v194, v14
    v_dot2c_f32_bf16 v65, v194, v15
    v_dot2c_f32_bf16 v66, v195, v14
    v_dot2c_f32_bf16 v67, v195, v15
    s_nop 2
    v_permlane32_swap_b32 v60, v64
    v_permlane32_swap_b32 v61, v65
    v_permlane32_swap_b32 v62, v66
    v_permlane32_swap_b32 v63, v67
    v_add_f32 v60, v60, v64
    v_add_f32 v61, v61, v65
    v_add_f32 v62, v62, v66
    v_add_f32 v63, v63, v67
    s_nop 0
    v_permlane16_swap_b32 v60, v62
    v_permlane16_swap_b32 v61, v63
    v_add_f32 v60, v60, v62
    v_add_f32 v61, v61, v63
    s_nop 0
    v_add_f32_dpp v6, v60, v60 row_ror:8 row_mask:0xf bank_mask:0x3
    v_add_f32_dpp v6, v61, v61 row_ror:8 row_mask:0xf bank_mask:0xc
    ds_write_b32 v254, v6 offset:29952
    s_cmp_gt_i32 s68, 7
    s_cbranch_scc1 L_dw120_8
    s_cmp_gt_i32 s68, 6
    s_cbranch_scc1 L_dw120_7
    s_cmp_gt_i32 s68, 5
    s_cbranch_scc1 L_dw120_6
    s_cmp_gt_i32 s68, 4
    s_cbranch_scc1 L_dw120_5
    s_waitcnt vmcnt(3)
L_dw120_5:
    s_waitcnt vmcnt(4)
L_dw120_6:
    s_waitcnt vmcnt(5)
L_dw120_7:
    s_waitcnt vmcnt(6)
L_dw120_8:
    s_waitcnt vmcnt(7)
    buffer_load_dwordx4 v[228:231], v1, s[36:39], s56 offen offset:0 nt
    v_dot2c_f32_bf16 v68, v196, v14
    v_dot2c_f32_bf16 v69, v196, v15
    v_dot2c_f32_bf16 v70, v197, v14
    v_dot2c_f32_bf16 v71, v197, v15
    v_dot2c_f32_bf16 v72, v198, v14
    v_dot2c_f32_bf16 v73, v198, v15
    v_dot2c_f32_bf16 v74, v199, v14
    v_dot2c_f32_bf16 v75, v199, v15
    s_nop 2
    v_permlane32_swap_b32 v68, v72
    v_permlane32_swap_b32 v69, v73
    v_permlane32_swap_b32 v70, v74
    v_permlane32_swap_b32 v71, v75
    v_add_f32 v68, v68, v72
    v_add_f32 v69, v69, v73
    v_add_f32 v70, v70, v74
    v_add_f32 v71, v71, v75
    s_nop 0
    v_permlane16_swap_b32 v68, v70
    v_permlane16_swap_b32 v69, v71
    v_add_f32 v68, v68, v70
    v_add_f32 v69, v69, v71
    s_nop 0
    v_add_f32_dpp v7, v68, v68 row_ror:8 row_mask:0xf bank_mask:0x3
    v_add_f32_dpp v7, v69, v69 row_ror:8 row_mask:0xf bank_mask:0xc
    ds_write_b32 v254, v7 offset:30208
    s_cmp_gt_i32 s68, 7
    s_cbranch_scc1 L_dw121_8
    s_cmp_gt_i32 s68, 6
    s_cbranch_scc1 L_dw121_7
    s_cmp_gt_i32 s68, 5
    s_cbranch_scc1 L_dw121_6
    s_cmp_gt_i32 s68, 4
    s_cbranch_scc1 L_dw121_5
    s_waitcnt vmcnt(3)
L_dw121_5:
    s_waitcnt vmcnt(4)
L_dw121_6:
    s_waitcnt vmcnt(5)
L_dw121_7:
    s_waitcnt vmcnt(6)
L_dw121_8:
    s_waitcnt vmcnt(7)
    buffer_load_dwordx4 v[232:235], v1, s[36:39], s56 offen offset:128 nt
    ds_read_b32 v5, v2 offset:4
    v_dot2c_f32_bf16 v76, v200, v14
    v_dot2c_f32_bf16 v77, v200, v15
    v_dot2c_f32_bf16 v78, v201, v14
    v_dot2c_f32_bf16 v79, v201, v15
    v_dot2c_f32_bf16 v80, v202, v14
    v_dot2c_f32_bf16 v81, v202, v15
    v_dot2c_f32_bf16 v82, v203, v14
    v_dot2c_f32_bf16 v83, v203, v15
    s_nop 2
    v_permlane32_swap_b32 v76, v80
    v_permlane32_swap_b32 v77, v81
    v_permlane32_swap_b32 v78, v82
    v_permlane32_swap_b32 v79, v83
    v_add_f32 v76, v76, v80
    v_add_f32 v77, v77, v81
    v_add_f32 v78, v78, v82
    v_add_f32 v79, v79, v83
    s_nop 0
    v_permlane16_swap_b32 v76, v78
    v_permlane16_swap_b32 v77, v79
    v_add_f32 v76, v76, v78
    v_add_f32 v77, v77, v79
    s_nop 0
    v_add_f32_dpp v8, v76, v76 row_ror:8 row_mask:0xf bank_mask:0x3
    v_add_f32_dpp v8, v77, v77 row_ror:8 row_mask:0xf bank_mask:0xc
    ds_write_b32 v254, v8 offset:30464
    s_mov_b64 exec, 1
    ds_add_u32 v2, v3 offset:48
    s_mov_b64 exec, -1
    s_waitcnt lgkmcnt(0)
    v_readfirstlane_b32 s68, v5
    s_add_u32 s68, s68, s69
    s_cmp_gt_i32 s68, 7
    s_cbranch_scc1 L_dw122_8
    s_cmp_gt_i32 s68, 6
    s_cbranch_scc1 L_dw122_7
    s_cmp_gt_i32 s68, 5
    s_cbranch_scc1 L_dw122_6
    s_cmp_gt_i32 s68, 4
    s_cbranch_scc1 L_dw122_5
    s_waitcnt vmcnt(3)
L_dw122_5:
    s_waitcnt vmcnt(4)
L_dw122_6:
    s_waitcnt vmcnt(5)
L_dw122_7:
    s_waitcnt vmcnt(6)
L_dw122_8:
    s_waitcnt vmcnt(7)
    buffer_load_dwordx4 v[236:239], v1, s[36:39], s56 offen offset:256 nt
    s_add_u32 s56, s87, 51511296
    s_mov_b64 exec, 1
    ds_add_rtn_u32 v4, v2, v3 offset:8
    s_mov_b64 exec, -1
    v_cvt_pk_bf16_f32 v14, v48, 0
    v_cvt_pk_bf16_f32 v15, 0, v48
    v_dot2_f32_bf16 v60, v204, v14, 0
    v_dot2_f32_bf16 v61, v204, v15, 0
    v_dot2_f32_bf16 v62, v205, v14, 0
    v_dot2_f32_bf16 v63, v205, v15, 0
    v_dot2_f32_bf16 v64, v206, v14, 0
    v_dot2_f32_bf16 v65, v206, v15, 0
    v_dot2_f32_bf16 v66, v207, v14, 0
    v_dot2_f32_bf16 v67, v207, v15, 0
    s_waitcnt lgkmcnt(0)
    v_readfirstlane_b32 s52, v4
    s_sub_u32 s68, s68, s69
    s_and_b32 s52, s52, 3
    s_lshl_b32 s52, s52, 3
    s_mov_b32 s69, 0x1000000
    s_lshr_b32 s69, s69, s52
    s_sext_i32_i8 s69, s69
    s_add_u32 s68, s68, s69
    s_cmp_gt_i32 s68, 7
    s_cbranch_scc1 L_dw123_8
    s_cmp_gt_i32 s68, 6
    s_cbranch_scc1 L_dw123_7
    s_cmp_gt_i32 s68, 5
    s_cbranch_scc1 L_dw123_6
    s_cmp_gt_i32 s68, 4
    s_cbranch_scc1 L_dw123_5
    s_waitcnt vmcnt(3)
L_dw123_5:
    s_waitcnt vmcnt(4)
L_dw123_6:
    s_waitcnt vmcnt(5)
L_dw123_7:
    s_waitcnt vmcnt(6)
L_dw123_8:
    s_waitcnt vmcnt(7)
    buffer_load_dwordx4 v[240:243], v1, s[36:39], s56 offen offset:0 nt
    v_dot2_f32_bf16 v68, v208, v14, 0
    v_dot2_f32_bf16 v69, v208, v15, 0
    v_dot2_f32_bf16 v70, v209, v14, 0
    v_dot2_f32_bf16 v71, v209, v15, 0
    v_dot2_f32_bf16 v72, v210, v14, 0
    v_dot2_f32_bf16 v73, v210, v15, 0
    v_dot2_f32_bf16 v74, v211, v14, 0
    v_dot2_f32_bf16 v75, v211, v15, 0
    s_cmp_gt_i32 s68, 7
    s_cbranch_scc1 L_dw124_8
    s_cmp_gt_i32 s68, 6
    s_cbranch_scc1 L_dw124_7
    s_cmp_gt_i32 s68, 5
    s_cbranch_scc1 L_dw124_6
    s_cmp_gt_i32 s68, 4
    s_cbranch_scc1 L_dw124_5
    s_waitcnt vmcnt(3)
L_dw124_5:
    s_waitcnt vmcnt(4)
L_dw124_6:
    s_waitcnt vmcnt(5)
L_dw124_7:
    s_waitcnt vmcnt(6)
L_dw124_8:
    s_waitcnt vmcnt(7)
    buffer_load_dwordx4 v[244:247], v1, s[36:39], s56 offen offset:128 nt
    v_dot2_f32_bf16 v76, v212, v14, 0
    v_dot2_f32_bf16 v77, v212, v15, 0
    v_dot2_f32_bf16 v78, v213, v14, 0
    v_dot2_f32_bf16 v79, v213, v15, 0
    v_dot2_f32_bf16 v80, v214, v14, 0
    v_dot2_f32_bf16 v81, v214, v15, 0
    v_dot2_f32_bf16 v82, v215, v14, 0
    v_dot2_f32_bf16 v83, v215, v15, 0
    s_cmp_gt_i32 s68, 7
    s_cbranch_scc1 L_dw125_8
    s_cmp_gt_i32 s68, 6
    s_cbranch_scc1 L_dw125_7
    s_cmp_gt_i32 s68, 5
    s_cbranch_scc1 L_dw125_6
    s_cmp_gt_i32 s68, 4
    s_cbranch_scc1 L_dw125_5
    s_waitcnt vmcnt(3)
L_dw125_5:
    s_waitcnt vmcnt(4)
L_dw125_6:
    s_waitcnt vmcnt(5)
L_dw125_7:
    s_waitcnt vmcnt(6)
L_dw125_8:
    s_waitcnt vmcnt(7)
    buffer_load_dwordx4 v[248:251], v1, s[36:39], s56 offen offset:256 nt
    s_add_u32 s56, s88, 50331648
    ds_read_b32 v5, v2 offset:4
    v_cvt_pk_bf16_f32 v14, v49, 0
    v_cvt_pk_bf16_f32 v15, 0, v49
    v_dot2c_f32_bf16 v60, v216, v14
    v_dot2c_f32_bf16 v61, v216, v15
    v_dot2c_f32_bf16 v62, v217, v14
    v_dot2c_f32_bf16 v63, v217, v15
    v_dot2c_f32_bf16 v64, v218, v14
    v_dot2c_f32_bf16 v65, v218, v15
    v_dot2c_f32_bf16 v66, v219, v14
    v_dot2c_f32_bf16 v67, v219, v15
    s_waitcnt lgkmcnt(0)
    v_readfirstlane_b32 s68, v5
    s_add_u32 s68, s68, s69
    s_cmp_gt_i32 s68, 7
    s_cbranch_scc1 L_dw126_8
    s_cmp_gt_i32 s68, 6
    s_cbranch_scc1 L_dw126_7
    s_cmp_gt_i32 s68, 5
    s_cbranch_scc1 L_dw126_6
    s_cmp_gt_i32 s68, 4
    s_cbranch_scc1 L_dw126_5
    s_waitcnt vmcnt(3)
L_dw126_5:
    s_waitcnt vmcnt(4)
L_dw126_6:
    s_waitcnt vmcnt(5)
L_dw126_7:
    s_waitcnt vmcnt(6)
L_dw126_8:
    s_waitcnt vmcnt(7)
    buffer_load_dwordx4 v[84:87], v1, s[36:39], s56 offen offset:0 nt
    s_mov_b64 exec, 1
    ds_add_u32 v2, v3 offset:0
    s_mov_b64 exec, -1
    v_dot2c_f32_bf16 v68, v220, v14
    v_dot2c_f32_bf16 v69, v220, v15
    v_dot2c_f32_bf16 v70, v221, v14
    v_dot2c_f32_bf16 v71, v221, v15
    v_dot2c_f32_bf16 v72, v222, v14
    v_dot2c_f32_bf16 v73, v222, v15
    v_dot2c_f32_bf16 v74, v223, v14
    v_dot2c_f32_bf16 v75, v223, v15
    s_cmp_gt_i32 s68, 7
    s_cbranch_scc1 L_dw127_8
    s_cmp_gt_i32 s68, 6
    s_cbranch_scc1 L_dw127_7
    s_cmp_gt_i32 s68, 5
    s_cbranch_scc1 L_dw127_6
    s_cmp_gt_i32 s68, 4
    s_cbranch_scc1 L_dw127_5
    s_waitcnt vmcnt(3)
L_dw127_5:
    s_waitcnt vmcnt(4)
L_dw127_6:
    s_waitcnt vmcnt(5)
L_dw127_7:
    s_waitcnt vmcnt(6)
L_dw127_8:
    s_waitcnt vmcnt(7)
    buffer_load_dwordx4 v[88:91], v1, s[36:39], s56 offen offset:128 nt
    v_dot2c_f32_bf16 v76, v224, v14
    v_dot2c_f32_bf16 v77, v224, v15
    v_dot2c_f32_bf16 v78, v225, v14
    v_dot2c_f32_bf16 v79, v225, v15
    v_dot2c_f32_bf16 v80, v226, v14
    v_dot2c_f32_bf16 v81, v226, v15
    v_dot2c_f32_bf16 v82, v227, v14
    v_dot2c_f32_bf16 v83, v227, v15
    s_cmp_gt_i32 s68, 7
    s_cbranch_scc1 L_dw128_8
    s_cmp_gt_i32 s68, 6
    s_cbranch_scc1 L_dw128_7
    s_cmp_gt_i32 s68, 5
    s_cbranch_scc1 L_dw128_6
    s_cmp_gt_i32 s68, 4
    s_cbranch_scc1 L_dw128_5
    s_waitcnt vmcnt(3)
L_dw128_5:
    s_waitcnt vmcnt(4)
L_dw128_6:
    s_waitcnt vmcnt(5)
L_dw128_7:
    s_waitcnt vmcnt(6)
L_dw128_8:
    s_waitcnt vmcnt(7)
    buffer_load_dwordx4 v[92:95], v1, s[36:39], s56 offen offset:256 nt
    s_add_u32 s56, s88, 50724864
    s_mov_b64 exec, 1
    ds_add_rtn_u32 v4, v2, v3 offset:8
    s_mov_b64 exec, -1
    v_cvt_pk_bf16_f32 v14, v50, 0
    v_cvt_pk_bf16_f32 v15, 0, v50
    v_dot2c_f32_bf16 v60, v228, v14
    v_dot2c_f32_bf16 v61, v228, v15
    v_dot2c_f32_bf16 v62, v229, v14
    v_dot2c_f32_bf16 v63, v229, v15
    v_dot2c_f32_bf16 v64, v230, v14
    v_dot2c_f32_bf16 v65, v230, v15
    v_dot2c_f32_bf16 v66, v231, v14
    v_dot2c_f32_bf16 v67, v231, v15
    s_waitcnt lgkmcnt(0)
    v_readfirstlane_b32 s52, v4
    s_sub_u32 s68, s68, s69
    s_and_b32 s52, s52, 3
    s_lshl_b32 s52, s52, 3
    s_mov_b32 s69, 0x1000000
    s_lshr_b32 s69, s69, s52
    s_sext_i32_i8 s69, s69
    s_add_u32 s68, s68, s69
    s_cmp_gt_i32 s68, 7
    s_cbranch_scc1 L_dw129_8
    s_cmp_gt_i32 s68, 6
    s_cbranch_scc1 L_dw129_7
    s_cmp_gt_i32 s68, 5
    s_cbranch_scc1 L_dw129_6
    s_cmp_gt_i32 s68, 4
    s_cbranch_scc1 L_dw129_5
    s_waitcnt vmcnt(3)
L_dw129_5:
    s_waitcnt vmcnt(4)
L_dw129_6:
    s_waitcnt vmcnt(5)
L_dw129_7:
    s_waitcnt vmcnt(6)
L_dw129_8:
    s_waitcnt vmcnt(7)
    buffer_load_dwordx4 v[96:99], v1, s[36:39], s56 offen offset:0 nt
    ds_read_b32 v5, v2 offset:4
    v_dot2c_f32_bf16 v68, v232, v14
    v_dot2c_f32_bf16 v69, v232, v15
    v_dot2c_f32_bf16 v70, v233, v14
    v_dot2c_f32_bf16 v71, v233, v15
    v_dot2c_f32_bf16 v72, v234, v14
    v_dot2c_f32_bf16 v73, v234, v15
    v_dot2c_f32_bf16 v74, v235, v14
    v_dot2c_f32_bf16 v75, v235, v15
    s_waitcnt lgkmcnt(0)
    v_readfirstlane_b32 s68, v5
    s_add_u32 s68, s68, s69
    s_cmp_gt_i32 s68, 7
    s_cbranch_scc1 L_dw130_8
    s_cmp_gt_i32 s68, 6
    s_cbranch_scc1 L_dw130_7
    s_cmp_gt_i32 s68, 5
    s_cbranch_scc1 L_dw130_6
    s_cmp_gt_i32 s68, 4
    s_cbranch_scc1 L_dw130_5
    s_waitcnt vmcnt(3)
L_dw130_5:
    s_waitcnt vmcnt(4)
L_dw130_6:
    s_waitcnt vmcnt(5)
L_dw130_7:
    s_waitcnt vmcnt(6)
L_dw130_8:
    s_waitcnt vmcnt(7)
    buffer_load_dwordx4 v[100:103], v1, s[36:39], s56 offen offset:128 nt
    v_dot2c_f32_bf16 v76, v236, v14
    v_dot2c_f32_bf16 v77, v236, v15
    v_dot2c_f32_bf16 v78, v237, v14
    v_dot2c_f32_bf16 v79, v237, v15
    v_dot2c_f32_bf16 v80, v238, v14
    v_dot2c_f32_bf16 v81, v238, v15
    v_dot2c_f32_bf16 v82, v239, v14
    v_dot2c_f32_bf16 v83, v239, v15
    s_cmp_gt_i32 s68, 7
    s_cbranch_scc1 L_dw131_8
    s_cmp_gt_i32 s68, 6
    s_cbranch_scc1 L_dw131_7
    s_cmp_gt_i32 s68, 5
    s_cbranch_scc1 L_dw131_6
    s_cmp_gt_i32 s68, 4
    s_cbranch_scc1 L_dw131_5
    s_waitcnt vmcnt(3)
L_dw131_5:
    s_waitcnt vmcnt(4)
L_dw131_6:
    s_waitcnt vmcnt(5)
L_dw131_7:
    s_waitcnt vmcnt(6)
L_dw131_8:
    s_waitcnt vmcnt(7)
    buffer_load_dwordx4 v[104:107], v1, s[36:39], s56 offen offset:256 nt
    s_add_u32 s56, s88, 51118080
    v_cvt_pk_bf16_f32 v14, v51, 0
    v_cvt_pk_bf16_f32 v15, 0, v51
    v_dot2c_f32_bf16 v60, v240, v14
    v_dot2c_f32_bf16 v61, v240, v15
    v_dot2c_f32_bf16 v62, v241, v14
    v_dot2c_f32_bf16 v63, v241, v15
    v_dot2c_f32_bf16 v64, v242, v14
    v_dot2c_f32_bf16 v65, v242, v15
    v_dot2c_f32_bf16 v66, v243, v14
    v_dot2c_f32_bf16 v67, v243, v15
    s_nop 2
    v_permlane32_swap_b32 v60, v64
    v_permlane32_swap_b32 v61, v65
    v_permlane32_swap_b32 v62, v66
    v_permlane32_swap_b32 v63, v67
    v_add_f32 v60, v60, v64
    v_add_f32 v61, v61, v65
    v_add_f32 v62, v62, v66
    v_add_f32 v63, v63, v67
    s_nop 0
    v_permlane16_swap_b32 v60, v62
    v_permlane16_swap_b32 v61, v63
    v_add_f32 v60, v60, v62
    v_add_f32 v61, v61, v63
    s_nop 0
    v_add_f32_dpp v6, v60, v60 row_ror:8 row_mask:0xf bank_mask:0x3
    v_add_f32_dpp v6, v61, v61 row_ror:8 row_mask:0xf bank_mask:0xc
    ds_write_b32 v254, v6 offset:33024
    s_cmp_gt_i32 s68, 7
    s_cbranch_scc1 L_dw132_8
    s_cmp_gt_i32 s68, 6
    s_cbranch_scc1 L_dw132_7
    s_cmp_gt_i32 s68, 5
    s_cbranch_scc1 L_dw132_6
    s_cmp_gt_i32 s68, 4
    s_cbranch_scc1 L_dw132_5
    s_waitcnt vmcnt(3)
L_dw132_5:
    s_waitcnt vmcnt(4)
L_dw132_6:
    s_waitcnt vmcnt(5)
L_dw132_7:
    s_waitcnt vmcnt(6)
L_dw132_8:
    s_waitcnt vmcnt(7)
    buffer_load_dwordx4 v[108:111], v1, s[36:39], s56 offen offset:0 nt
    v_dot2c_f32_bf16 v68, v244, v14
    v_dot2c_f32_bf16 v69, v244, v15
    v_dot2c_f32_bf16 v70, v245, v14
    v_dot2c_f32_bf16 v71, v245, v15
    v_dot2c_f32_bf16 v72, v246, v14
    v_dot2c_f32_bf16 v73, v246, v15
    v_dot2c_f32_bf16 v74, v247, v14
    v_dot2c_f32_bf16 v75, v247, v15
    s_nop 2
    v_permlane32_swap_b32 v68, v72
    v_permlane32_swap_b32 v69, v73
    v_permlane32_swap_b32 v70, v74
    v_permlane32_swap_b32 v71, v75
    v_add_f32 v68, v68, v72
    v_add_f32 v69, v69, v73
    v_add_f32 v70, v70, v74
    v_add_f32 v71, v71, v75
    s_nop 0
    v_permlane16_swap_b32 v68, v70
    v_permlane16_swap_b32 v69, v71
    v_add_f32 v68, v68, v70
    v_add_f32 v69, v69, v71
    s_nop 0
    v_add_f32_dpp v7, v68, v68 row_ror:8 row_mask:0xf bank_mask:0x3
    v_add_f32_dpp v7, v69, v69 row_ror:8 row_mask:0xf bank_mask:0xc
    ds_write_b32 v254, v7 offset:33280
    s_cmp_gt_i32 s68, 7
    s_cbranch_scc1 L_dw133_8
    s_cmp_gt_i32 s68, 6
    s_cbranch_scc1 L_dw133_7
    s_cmp_gt_i32 s68, 5
    s_cbranch_scc1 L_dw133_6
    s_cmp_gt_i32 s68, 4
    s_cbranch_scc1 L_dw133_5
    s_waitcnt vmcnt(3)
L_dw133_5:
    s_waitcnt vmcnt(4)
L_dw133_6:
    s_waitcnt vmcnt(5)
L_dw133_7:
    s_waitcnt vmcnt(6)
L_dw133_8:
    s_waitcnt vmcnt(7)
    buffer_load_dwordx4 v[112:115], v1, s[36:39], s56 offen offset:128 nt
    ds_read_b32 v5, v2 offset:4
    v_dot2c_f32_bf16 v76, v248, v14
    v_dot2c_f32_bf16 v77, v248, v15
    v_dot2c_f32_bf16 v78, v249, v14
    v_dot2c_f32_bf16 v79, v249, v15
    v_dot2c_f32_bf16 v80, v250, v14
    v_dot2c_f32_bf16 v81, v250, v15
    v_dot2c_f32_bf16 v82, v251, v14
    v_dot2c_f32_bf16 v83, v251, v15
    s_nop 2
    v_permlane32_swap_b32 v76, v80
    v_permlane32_swap_b32 v77, v81
    v_permlane32_swap_b32 v78, v82
    v_permlane32_swap_b32 v79, v83
    v_add_f32 v76, v76, v80
    v_add_f32 v77, v77, v81
    v_add_f32 v78, v78, v82
    v_add_f32 v79, v79, v83
    s_nop 0
    v_permlane16_swap_b32 v76, v78
    v_permlane16_swap_b32 v77, v79
    v_add_f32 v76, v76, v78
    v_add_f32 v77, v77, v79
    s_nop 0
    v_add_f32_dpp v8, v76, v76 row_ror:8 row_mask:0xf bank_mask:0x3
    v_add_f32_dpp v8, v77, v77 row_ror:8 row_mask:0xf bank_mask:0xc
    ds_write_b32 v254, v8 offset:33536
    s_mov_b64 exec, 1
    ds_add_u32 v2, v3 offset:52
    s_mov_b64 exec, -1
    s_waitcnt lgkmcnt(0)
    v_readfirstlane_b32 s68, v5
    s_add_u32 s68, s68, s69
    s_cmp_gt_i32 s68, 7
    s_cbranch_scc1 L_dw134_8
    s_cmp_gt_i32 s68, 6
    s_cbranch_scc1 L_dw134_7
    s_cmp_gt_i32 s68, 5
    s_cbranch_scc1 L_dw134_6
    s_cmp_gt_i32 s68, 4
    s_cbranch_scc1 L_dw134_5
    s_waitcnt vmcnt(3)
L_dw134_5:
    s_waitcnt vmcnt(4)
L_dw134_6:
    s_waitcnt vmcnt(5)
L_dw134_7:
    s_waitcnt vmcnt(6)
L_dw134_8:
    s_waitcnt vmcnt(7)
    buffer_load_dwordx4 v[116:119], v1, s[36:39], s56 offen offset:256 nt
    s_add_u32 s56, s88, 51511296
    s_mov_b64 exec, 1
    ds_add_rtn_u32 v4, v2, v3 offset:8
    s_mov_b64 exec, -1
    s_mov_b64 exec, 1
    ds_add_u32 v2, v3 offset:0
    s_mov_b64 exec, -1
    v_cvt_pk_bf16_f32 v14, v52, 0
    v_cvt_pk_bf16_f32 v15, 0, v52
    v_dot2_f32_bf16 v60, v84, v14, 0
    v_dot2_f32_bf16 v61, v84, v15, 0
    v_dot2_f32_bf16 v62, v85, v14, 0
    v_dot2_f32_bf16 v63, v85, v15, 0
    v_dot2_f32_bf16 v64, v86, v14, 0
    v_dot2_f32_bf16 v65, v86, v15, 0
    v_dot2_f32_bf16 v66, v87, v14, 0
    v_dot2_f32_bf16 v67, v87, v15, 0
    s_waitcnt lgkmcnt(0)
    v_readfirstlane_b32 s52, v4
    s_sub_u32 s68, s68, s69
    s_and_b32 s52, s52, 3
    s_lshl_b32 s52, s52, 3
    s_mov_b32 s69, 0x1000000
    s_lshr_b32 s69, s69, s52
    s_sext_i32_i8 s69, s69
    s_add_u32 s68, s68, s69
    s_cmp_gt_i32 s68, 7
    s_cbranch_scc1 L_dw135_8
    s_cmp_gt_i32 s68, 6
    s_cbranch_scc1 L_dw135_7
    s_cmp_gt_i32 s68, 5
    s_cbranch_scc1 L_dw135_6
    s_cmp_gt_i32 s68, 4
    s_cbranch_scc1 L_dw135_5
    s_waitcnt vmcnt(3)
L_dw135_5:
    s_waitcnt vmcnt(4)
L_dw135_6:
    s_waitcnt vmcnt(5)
L_dw135_7:
    s_waitcnt vmcnt(6)
L_dw135_8:
    s_waitcnt vmcnt(7)
    buffer_load_dwordx4 v[120:123], v1, s[36:39], s56 offen offset:0 nt
    v_dot2_f32_bf16 v68, v88, v14, 0
    v_dot2_f32_bf16 v69, v88, v15, 0
    v_dot2_f32_bf16 v70, v89, v14, 0
    v_dot2_f32_bf16 v71, v89, v15, 0
    v_dot2_f32_bf16 v72, v90, v14, 0
    v_dot2_f32_bf16 v73, v90, v15, 0
    v_dot2_f32_bf16 v74, v91, v14, 0
    v_dot2_f32_bf16 v75, v91, v15, 0
    s_cmp_gt_i32 s68, 7
    s_cbranch_scc1 L_dw136_8
    s_cmp_gt_i32 s68, 6
    s_cbranch_scc1 L_dw136_7
    s_cmp_gt_i32 s68, 5
    s_cbranch_scc1 L_dw136_6
    s_cmp_gt_i32 s68, 4
    s_cbranch_scc1 L_dw136_5
    s_waitcnt vmcnt(3)
L_dw136_5:
    s_waitcnt vmcnt(4)
L_dw136_6:
    s_waitcnt vmcnt(5)
L_dw136_7:
    s_waitcnt vmcnt(6)
L_dw136_8:
    s_waitcnt vmcnt(7)
    buffer_load_dwordx4 v[124:127], v1, s[36:39], s56 offen offset:128 nt
    v_dot2_f32_bf16 v76, v92, v14, 0
    v_dot2_f32_bf16 v77, v92, v15, 0
    v_dot2_f32_bf16 v78, v93, v14, 0
    v_dot2_f32_bf16 v79, v93, v15, 0
    v_dot2_f32_bf16 v80, v94, v14, 0
    v_dot2_f32_bf16 v81, v94, v15, 0
    v_dot2_f32_bf16 v82, v95, v14, 0
    v_dot2_f32_bf16 v83, v95, v15, 0
    s_cmp_gt_i32 s68, 7
    s_cbranch_scc1 L_dw137_8
    s_cmp_gt_i32 s68, 6
    s_cbranch_scc1 L_dw137_7
    s_cmp_gt_i32 s68, 5
    s_cbranch_scc1 L_dw137_6
    s_cmp_gt_i32 s68, 4
    s_cbranch_scc1 L_dw137_5
    s_waitcnt vmcnt(3)
L_dw137_5:
    s_waitcnt vmcnt(4)
L_dw137_6:
    s_waitcnt vmcnt(5)
L_dw137_7:
    s_waitcnt vmcnt(6)
L_dw137_8:
    s_waitcnt vmcnt(7)
    buffer_load_dwordx4 v[128:131], v1, s[36:39], s56 offen offset:256 nt
    s_add_u32 s56, s89, 50331648
    ds_read_b32 v5, v2 offset:4
    v_cvt_pk_bf16_f32 v14, v53, 0
    v_cvt_pk_bf16_f32 v15, 0, v53
    v_dot2c_f32_bf16 v60, v96, v14
    v_dot2c_f32_bf16 v61, v96, v15
    v_dot2c_f32_bf16 v62, v97, v14
    v_dot2c_f32_bf16 v63, v97, v15
    v_dot2c_f32_bf16 v64, v98, v14
    v_dot2c_f32_bf16 v65, v98, v15
    v_dot2c_f32_bf16 v66, v99, v14
    v_dot2c_f32_bf16 v67, v99, v15
    s_waitcnt lgkmcnt(0)
    v_readfirstlane_b32 s68, v5
    s_add_u32 s68, s68, s69
    s_cmp_gt_i32 s68, 7
    s_cbranch_scc1 L_dw138_8
    s_cmp_gt_i32 s68, 6
    s_cbranch_scc1 L_dw138_7
    s_cmp_gt_i32 s68, 5
    s_cbranch_scc1 L_dw138_6
    s_cmp_gt_i32 s68, 4
    s_cbranch_scc1 L_dw138_5
    s_waitcnt vmcnt(3)
L_dw138_5:
    s_waitcnt vmcnt(4)
L_dw138_6:
    s_waitcnt vmcnt(5)
L_dw138_7:
    s_waitcnt vmcnt(6)
L_dw138_8:
    s_waitcnt vmcnt(7)
    buffer_load_dwordx4 v[132:135], v1, s[36:39], s56 offen offset:0 nt
    v_dot2c_f32_bf16 v68, v100, v14
    v_dot2c_f32_bf16 v69, v100, v15
    v_dot2c_f32_bf16 v70, v101, v14
    v_dot2c_f32_bf16 v71, v101, v15
    v_dot2c_f32_bf16 v72, v102, v14
    v_dot2c_f32_bf16 v73, v102, v15
    v_dot2c_f32_bf16 v74, v103, v14
    v_dot2c_f32_bf16 v75, v103, v15
    s_cmp_gt_i32 s68, 7
    s_cbranch_scc1 L_dw139_8
    s_cmp_gt_i32 s68, 6
    s_cbranch_scc1 L_dw139_7
    s_cmp_gt_i32 s68, 5
    s_cbranch_scc1 L_dw139_6
    s_cmp_gt_i32 s68, 4
    s_cbranch_scc1 L_dw139_5
    s_waitcnt vmcnt(3)
L_dw139_5:
    s_waitcnt vmcnt(4)
L_dw139_6:
    s_waitcnt vmcnt(5)
L_dw139_7:
    s_waitcnt vmcnt(6)
L_dw139_8:
    s_waitcnt vmcnt(7)
    buffer_load_dwordx4 v[136:139], v1, s[36:39], s56 offen offset:128 nt
    v_dot2c_f32_bf16 v76, v104, v14
    v_dot2c_f32_bf16 v77, v104, v15
    v_dot2c_f32_bf16 v78, v105, v14
    v_dot2c_f32_bf16 v79, v105, v15
    v_dot2c_f32_bf16 v80, v106, v14
    v_dot2c_f32_bf16 v81, v106, v15
    v_dot2c_f32_bf16 v82, v107, v14
    v_dot2c_f32_bf16 v83, v107, v15
    s_cmp_gt_i32 s68, 7
    s_cbranch_scc1 L_dw140_8
    s_cmp_gt_i32 s68, 6
    s_cbranch_scc1 L_dw140_7
    s_cmp_gt_i32 s68, 5
    s_cbranch_scc1 L_dw140_6
    s_cmp_gt_i32 s68, 4
    s_cbranch_scc1 L_dw140_5
    s_waitcnt vmcnt(3)
L_dw140_5:
    s_waitcnt vmcnt(4)
L_dw140_6:
    s_waitcnt vmcnt(5)
L_dw140_7:
    s_waitcnt vmcnt(6)
L_dw140_8:
    s_waitcnt vmcnt(7)
    buffer_load_dwordx4 v[140:143], v1, s[36:39], s56 offen offset:256 nt
    s_add_u32 s56, s89, 50724864
    s_mov_b64 exec, 1
    ds_add_rtn_u32 v4, v2, v3 offset:8
    s_mov_b64 exec, -1
    v_cvt_pk_bf16_f32 v14, v54, 0
    v_cvt_pk_bf16_f32 v15, 0, v54
    v_dot2c_f32_bf16 v60, v108, v14
    v_dot2c_f32_bf16 v61, v108, v15
    v_dot2c_f32_bf16 v62, v109, v14
    v_dot2c_f32_bf16 v63, v109, v15
    v_dot2c_f32_bf16 v64, v110, v14
    v_dot2c_f32_bf16 v65, v110, v15
    v_dot2c_f32_bf16 v66, v111, v14
    v_dot2c_f32_bf16 v67, v111, v15
    s_waitcnt lgkmcnt(0)
    v_readfirstlane_b32 s52, v4
    s_sub_u32 s68, s68, s69
    s_and_b32 s52, s52, 3
    s_lshl_b32 s52, s52, 3
    s_mov_b32 s69, 0x1000000
    s_lshr_b32 s69, s69, s52
    s_sext_i32_i8 s69, s69
    s_add_u32 s68, s68, s69
    s_cmp_gt_i32 s68, 7
    s_cbranch_scc1 L_dw141_8
    s_cmp_gt_i32 s68, 6
    s_cbranch_scc1 L_dw141_7
    s_cmp_gt_i32 s68, 5
    s_cbranch_scc1 L_dw141_6
    s_cmp_gt_i32 s68, 4
    s_cbranch_scc1 L_dw141_5
    s_waitcnt vmcnt(3)
L_dw141_5:
    s_waitcnt vmcnt(4)
L_dw141_6:
    s_waitcnt vmcnt(5)
L_dw141_7:
    s_waitcnt vmcnt(6)
L_dw141_8:
    s_waitcnt vmcnt(7)
    buffer_load_dwordx4 v[144:147], v1, s[36:39], s56 offen offset:0 nt
    ds_read_b32 v5, v2 offset:4
    v_dot2c_f32_bf16 v68, v112, v14
    v_dot2c_f32_bf16 v69, v112, v15
    v_dot2c_f32_bf16 v70, v113, v14
    v_dot2c_f32_bf16 v71, v113, v15
    v_dot2c_f32_bf16 v72, v114, v14
    v_dot2c_f32_bf16 v73, v114, v15
    v_dot2c_f32_bf16 v74, v115, v14
    v_dot2c_f32_bf16 v75, v115, v15
    s_waitcnt lgkmcnt(0)
    v_readfirstlane_b32 s68, v5
    s_add_u32 s68, s68, s69
    s_cmp_gt_i32 s68, 7
    s_cbranch_scc1 L_dw142_8
    s_cmp_gt_i32 s68, 6
    s_cbranch_scc1 L_dw142_7
    s_cmp_gt_i32 s68, 5
    s_cbranch_scc1 L_dw142_6
    s_cmp_gt_i32 s68, 4
    s_cbranch_scc1 L_dw142_5
    s_waitcnt vmcnt(3)
L_dw142_5:
    s_waitcnt vmcnt(4)
L_dw142_6:
    s_waitcnt vmcnt(5)
L_dw142_7:
    s_waitcnt vmcnt(6)
L_dw142_8:
    s_waitcnt vmcnt(7)
    buffer_load_dwordx4 v[148:151], v1, s[36:39], s56 offen offset:128 nt
    s_mov_b64 exec, 1
    ds_add_u32 v2, v3 offset:0
    s_mov_b64 exec, -1
    v_dot2c_f32_bf16 v76, v116, v14
    v_dot2c_f32_bf16 v77, v116, v15
    v_dot2c_f32_bf16 v78, v117, v14
    v_dot2c_f32_bf16 v79, v117, v15
    v_dot2c_f32_bf16 v80, v118, v14
    v_dot2c_f32_bf16 v81, v118, v15
    v_dot2c_f32_bf16 v82, v119, v14
    v_dot2c_f32_bf16 v83, v119, v15
    s_cmp_gt_i32 s68, 7
    s_cbranch_scc1 L_dw143_8
    s_cmp_gt_i32 s68, 6
    s_cbranch_scc1 L_dw143_7
    s_cmp_gt_i32 s68, 5
    s_cbranch_scc1 L_dw143_6
    s_cmp_gt_i32 s68, 4
    s_cbranch_scc1 L_dw143_5
    s_waitcnt vmcnt(3)
L_dw143_5:
    s_waitcnt vmcnt(4)
L_dw143_6:
    s_waitcnt vmcnt(5)
L_dw143_7:
    s_waitcnt vmcnt(6)
L_dw143_8:
    s_waitcnt vmcnt(7)
    buffer_load_dwordx4 v[152:155], v1, s[36:39], s56 offen offset:256 nt
    s_add_u32 s56, s89, 51118080
    v_cvt_pk_bf16_f32 v14, v55, 0
    v_cvt_pk_bf16_f32 v15, 0, v55
    v_dot2c_f32_bf16 v60, v120, v14
    v_dot2c_f32_bf16 v61, v120, v15
    v_dot2c_f32_bf16 v62, v121, v14
    v_dot2c_f32_bf16 v63, v121, v15
    v_dot2c_f32_bf16 v64, v122, v14
    v_dot2c_f32_bf16 v65, v122, v15
    v_dot2c_f32_bf16 v66, v123, v14
    v_dot2c_f32_bf16 v67, v123, v15
    s_nop 2
    v_permlane32_swap_b32 v60, v64
    v_permlane32_swap_b32 v61, v65
    v_permlane32_swap_b32 v62, v66
    v_permlane32_swap_b32 v63, v67
    v_add_f32 v60, v60, v64
    v_add_f32 v61, v61, v65
    v_add_f32 v62, v62, v66
    v_add_f32 v63, v63, v67
    s_nop 0
    v_permlane16_swap_b32 v60, v62
    v_permlane16_swap_b32 v61, v63
    v_add_f32 v60, v60, v62
    v_add_f32 v61, v61, v63
    s_nop 0
    v_add_f32_dpp v6, v60, v60 row_ror:8 row_mask:0xf bank_mask:0x3
    v_add_f32_dpp v6, v61, v61 row_ror:8 row_mask:0xf bank_mask:0xc
    ds_write_b32 v254, v6 offset:36096
    s_cmp_gt_i32 s68, 7
    s_cbranch_scc1 L_dw144_8
    s_cmp_gt_i32 s68, 6
    s_cbranch_scc1 L_dw144_7
    s_cmp_gt_i32 s68, 5
    s_cbranch_scc1 L_dw144_6
    s_cmp_gt_i32 s68, 4
    s_cbranch_scc1 L_dw144_5
    s_waitcnt vmcnt(3)
L_dw144_5:
    s_waitcnt vmcnt(4)
L_dw144_6:
    s_waitcnt vmcnt(5)
L_dw144_7:
    s_waitcnt vmcnt(6)
L_dw144_8:
    s_waitcnt vmcnt(7)
    buffer_load_dwordx4 v[156:159], v1, s[36:39], s56 offen offset:0 nt
    v_dot2c_f32_bf16 v68, v124, v14
    v_dot2c_f32_bf16 v69, v124, v15
    v_dot2c_f32_bf16 v70, v125, v14
    v_dot2c_f32_bf16 v71, v125, v15
    v_dot2c_f32_bf16 v72, v126, v14
    v_dot2c_f32_bf16 v73, v126, v15
    v_dot2c_f32_bf16 v74, v127, v14
    v_dot2c_f32_bf16 v75, v127, v15
    s_nop 2
    v_permlane32_swap_b32 v68, v72
    v_permlane32_swap_b32 v69, v73
    v_permlane32_swap_b32 v70, v74
    v_permlane32_swap_b32 v71, v75
    v_add_f32 v68, v68, v72
    v_add_f32 v69, v69, v73
    v_add_f32 v70, v70, v74
    v_add_f32 v71, v71, v75
    s_nop 0
    v_permlane16_swap_b32 v68, v70
    v_permlane16_swap_b32 v69, v71
    v_add_f32 v68, v68, v70
    v_add_f32 v69, v69, v71
    s_nop 0
    v_add_f32_dpp v7, v68, v68 row_ror:8 row_mask:0xf bank_mask:0x3
    v_add_f32_dpp v7, v69, v69 row_ror:8 row_mask:0xf bank_mask:0xc
    ds_write_b32 v254, v7 offset:36352
    s_cmp_gt_i32 s68, 7
    s_cbranch_scc1 L_dw145_8
    s_cmp_gt_i32 s68, 6
    s_cbranch_scc1 L_dw145_7
    s_cmp_gt_i32 s68, 5
    s_cbranch_scc1 L_dw145_6
    s_cmp_gt_i32 s68, 4
    s_cbranch_scc1 L_dw145_5
    s_waitcnt vmcnt(3)
L_dw145_5:
    s_waitcnt vmcnt(4)
L_dw145_6:
    s_waitcnt vmcnt(5)
L_dw145_7:
    s_waitcnt vmcnt(6)
L_dw145_8:
    s_waitcnt vmcnt(7)
    buffer_load_dwordx4 v[160:163], v1, s[36:39], s56 offen offset:128 nt
    ds_read_b32 v5, v2 offset:4
    v_dot2c_f32_bf16 v76, v128, v14
    v_dot2c_f32_bf16 v77, v128, v15
    v_dot2c_f32_bf16 v78, v129, v14
    v_dot2c_f32_bf16 v79, v129, v15
    v_dot2c_f32_bf16 v80, v130, v14
    v_dot2c_f32_bf16 v81, v130, v15
    v_dot2c_f32_bf16 v82, v131, v14
    v_dot2c_f32_bf16 v83, v131, v15
    s_nop 2
    v_permlane32_swap_b32 v76, v80
    v_permlane32_swap_b32 v77, v81
    v_permlane32_swap_b32 v78, v82
    v_permlane32_swap_b32 v79, v83
    v_add_f32 v76, v76, v80
    v_add_f32 v77, v77, v81
    v_add_f32 v78, v78, v82
    v_add_f32 v79, v79, v83
    s_nop 0
    v_permlane16_swap_b32 v76, v78
    v_permlane16_swap_b32 v77, v79
    v_add_f32 v76, v76, v78
    v_add_f32 v77, v77, v79
    s_nop 0
    v_add_f32_dpp v8, v76, v76 row_ror:8 row_mask:0xf bank_mask:0x3
    v_add_f32_dpp v8, v77, v77 row_ror:8 row_mask:0xf bank_mask:0xc
    ds_write_b32 v254, v8 offset:36608
    s_mov_b64 exec, 1
    ds_add_u32 v2, v3 offset:56
    s_mov_b64 exec, -1
    s_waitcnt lgkmcnt(0)
    v_readfirstlane_b32 s68, v5
    s_add_u32 s68, s68, s69
    s_cmp_gt_i32 s68, 7
    s_cbranch_scc1 L_dw146_8
    s_cmp_gt_i32 s68, 6
    s_cbranch_scc1 L_dw146_7
    s_cmp_gt_i32 s68, 5
    s_cbranch_scc1 L_dw146_6
    s_cmp_gt_i32 s68, 4
    s_cbranch_scc1 L_dw146_5
    s_waitcnt vmcnt(3)
L_dw146_5:
    s_waitcnt vmcnt(4)
L_dw146_6:
    s_waitcnt vmcnt(5)
L_dw146_7:
    s_waitcnt vmcnt(6)
L_dw146_8:
    s_waitcnt vmcnt(7)
    buffer_load_dwordx4 v[164:167], v1, s[36:39], s56 offen offset:256 nt
    s_add_u32 s56, s89, 51511296
    s_mov_b64 exec, 1
    ds_add_rtn_u32 v4, v2, v3 offset:8
    s_mov_b64 exec, -1
    v_cvt_pk_bf16_f32 v14, v56, 0
    v_cvt_pk_bf16_f32 v15, 0, v56
    v_dot2_f32_bf16 v60, v132, v14, 0
    v_dot2_f32_bf16 v61, v132, v15, 0
    v_dot2_f32_bf16 v62, v133, v14, 0
    v_dot2_f32_bf16 v63, v133, v15, 0
    v_dot2_f32_bf16 v64, v134, v14, 0
    v_dot2_f32_bf16 v65, v134, v15, 0
    v_dot2_f32_bf16 v66, v135, v14, 0
    v_dot2_f32_bf16 v67, v135, v15, 0
    s_waitcnt lgkmcnt(0)
    v_readfirstlane_b32 s52, v4
    s_sub_u32 s68, s68, s69
    s_and_b32 s52, s52, 3
    s_lshl_b32 s52, s52, 3
    s_mov_b32 s69, 0x1000000
    s_lshr_b32 s69, s69, s52
    s_sext_i32_i8 s69, s69
    s_add_u32 s68, s68, s69
    s_cmp_gt_i32 s68, 7
    s_cbranch_scc1 L_dw147_8
    s_cmp_gt_i32 s68, 6
    s_cbranch_scc1 L_dw147_7
    s_cmp_gt_i32 s68, 5
    s_cbranch_scc1 L_dw147_6
    s_cmp_gt_i32 s68, 4
    s_cbranch_scc1 L_dw147_5
    s_waitcnt vmcnt(3)
L_dw147_5:
    s_waitcnt vmcnt(4)
L_dw147_6:
    s_waitcnt vmcnt(5)
L_dw147_7:
    s_waitcnt vmcnt(6)
L_dw147_8:
    s_waitcnt vmcnt(7)
    buffer_load_dwordx4 v[168:171], v1, s[36:39], s56 offen offset:0 nt
    v_dot2_f32_bf16 v68, v136, v14, 0
    v_dot2_f32_bf16 v69, v136, v15, 0
    v_dot2_f32_bf16 v70, v137, v14, 0
    v_dot2_f32_bf16 v71, v137, v15, 0
    v_dot2_f32_bf16 v72, v138, v14, 0
    v_dot2_f32_bf16 v73, v138, v15, 0
    v_dot2_f32_bf16 v74, v139, v14, 0
    v_dot2_f32_bf16 v75, v139, v15, 0
    s_cmp_gt_i32 s68, 7
    s_cbranch_scc1 L_dw148_8
    s_cmp_gt_i32 s68, 6
    s_cbranch_scc1 L_dw148_7
    s_cmp_gt_i32 s68, 5
    s_cbranch_scc1 L_dw148_6
    s_cmp_gt_i32 s68, 4
    s_cbranch_scc1 L_dw148_5
    s_waitcnt vmcnt(3)
L_dw148_5:
    s_waitcnt vmcnt(4)
L_dw148_6:
    s_waitcnt vmcnt(5)
L_dw148_7:
    s_waitcnt vmcnt(6)
L_dw148_8:
    s_waitcnt vmcnt(7)
    buffer_load_dwordx4 v[172:175], v1, s[36:39], s56 offen offset:128 nt
    v_dot2_f32_bf16 v76, v140, v14, 0
    v_dot2_f32_bf16 v77, v140, v15, 0
    v_dot2_f32_bf16 v78, v141, v14, 0
    v_dot2_f32_bf16 v79, v141, v15, 0
    v_dot2_f32_bf16 v80, v142, v14, 0
    v_dot2_f32_bf16 v81, v142, v15, 0
    v_dot2_f32_bf16 v82, v143, v14, 0
    v_dot2_f32_bf16 v83, v143, v15, 0
    s_cmp_gt_i32 s68, 7
    s_cbranch_scc1 L_dw149_8
    s_cmp_gt_i32 s68, 6
    s_cbranch_scc1 L_dw149_7
    s_cmp_gt_i32 s68, 5
    s_cbranch_scc1 L_dw149_6
    s_cmp_gt_i32 s68, 4
    s_cbranch_scc1 L_dw149_5
    s_waitcnt vmcnt(3)
L_dw149_5:
    s_waitcnt vmcnt(4)
L_dw149_6:
    s_waitcnt vmcnt(5)
L_dw149_7:
    s_waitcnt vmcnt(6)
L_dw149_8:
    s_waitcnt vmcnt(7)
    buffer_load_dwordx4 v[176:179], v1, s[36:39], s56 offen offset:256 nt
    ds_read_b32 v5, v2 offset:4
    v_cvt_pk_bf16_f32 v14, v57, 0
    v_cvt_pk_bf16_f32 v15, 0, v57
    v_dot2c_f32_bf16 v60, v144, v14
    v_dot2c_f32_bf16 v61, v144, v15
    v_dot2c_f32_bf16 v62, v145, v14
    v_dot2c_f32_bf16 v63, v145, v15
    v_dot2c_f32_bf16 v64, v146, v14
    v_dot2c_f32_bf16 v65, v146, v15
    v_dot2c_f32_bf16 v66, v147, v14
    v_dot2c_f32_bf16 v67, v147, v15
    s_waitcnt lgkmcnt(0)
    v_readfirstlane_b32 s68, v5
    s_add_u32 s68, s68, s69
    s_waitcnt vmcnt(7)
    s_mov_b64 exec, 1
    ds_add_u32 v2, v3 offset:64
    s_mov_b64 exec, -1
    v_dot2c_f32_bf16 v68, v148, v14
    v_dot2c_f32_bf16 v69, v148, v15
    v_dot2c_f32_bf16 v70, v149, v14
    v_dot2c_f32_bf16 v71, v149, v15
    v_dot2c_f32_bf16 v72, v150, v14
    v_dot2c_f32_bf16 v73, v150, v15
    v_dot2c_f32_bf16 v74, v151, v14
    v_dot2c_f32_bf16 v75, v151, v15
    s_waitcnt vmcnt(6)
    v_dot2c_f32_bf16 v76, v152, v14
    v_dot2c_f32_bf16 v77, v152, v15
    v_dot2c_f32_bf16 v78, v153, v14
    v_dot2c_f32_bf16 v79, v153, v15
    v_dot2c_f32_bf16 v80, v154, v14
    v_dot2c_f32_bf16 v81, v154, v15
    v_dot2c_f32_bf16 v82, v155, v14
    v_dot2c_f32_bf16 v83, v155, v15
    s_waitcnt vmcnt(5)
    v_cvt_pk_bf16_f32 v14, v58, 0
    v_cvt_pk_bf16_f32 v15, 0, v58
    v_dot2c_f32_bf16 v60, v156, v14
    v_dot2c_f32_bf16 v61, v156, v15
    v_dot2c_f32_bf16 v62, v157, v14
    v_dot2c_f32_bf16 v63, v157, v15
    v_dot2c_f32_bf16 v64, v158, v14
    v_dot2c_f32_bf16 v65, v158, v15
    v_dot2c_f32_bf16 v66, v159, v14
    v_dot2c_f32_bf16 v67, v159, v15
    s_waitcnt vmcnt(4)
    ds_read_b32 v5, v2 offset:4
    v_dot2c_f32_bf16 v68, v160, v14
    v_dot2c_f32_bf16 v69, v160, v15
    v_dot2c_f32_bf16 v70, v161, v14
    v_dot2c_f32_bf16 v71, v161, v15
    v_dot2c_f32_bf16 v72, v162, v14
    v_dot2c_f32_bf16 v73, v162, v15
    v_dot2c_f32_bf16 v74, v163, v14
    v_dot2c_f32_bf16 v75, v163, v15
    s_waitcnt lgkmcnt(0)
    v_readfirstlane_b32 s68, v5
    s_add_u32 s68, s68, s69
    s_waitcnt vmcnt(3)
    v_dot2c_f32_bf16 v76, v164, v14
    v_dot2c_f32_bf16 v77, v164, v15
    v_dot2c_f32_bf16 v78, v165, v14
    v_dot2c_f32_bf16 v79, v165, v15
    v_dot2c_f32_bf16 v80, v166, v14
    v_dot2c_f32_bf16 v81, v166, v15
    v_dot2c_f32_bf16 v82, v167, v14
    v_dot2c_f32_bf16 v83, v167, v15
    s_waitcnt vmcnt(2)
    v_cvt_pk_bf16_f32 v14, v59, 0
    v_cvt_pk_bf16_f32 v15, 0, v59
    v_dot2c_f32_bf16 v60, v168, v14
    v_dot2c_f32_bf16 v61, v168, v15
    v_dot2c_f32_bf16 v62, v169, v14
    v_dot2c_f32_bf16 v63, v169, v15
    v_dot2c_f32_bf16 v64, v170, v14
    v_dot2c_f32_bf16 v65, v170, v15
    v_dot2c_f32_bf16 v66, v171, v14
    v_dot2c_f32_bf16 v67, v171, v15
    s_nop 2
    v_permlane32_swap_b32 v60, v64
    v_permlane32_swap_b32 v61, v65
    v_permlane32_swap_b32 v62, v66
    v_permlane32_swap_b32 v63, v67
    v_add_f32 v60, v60, v64
    v_add_f32 v61, v61, v65
    v_add_f32 v62, v62, v66
    v_add_f32 v63, v63, v67
    s_nop 0
    v_permlane16_swap_b32 v60, v62
    v_permlane16_swap_b32 v61, v63
    v_add_f32 v60, v60, v62
    v_add_f32 v61, v61, v63
    s_nop 0
    v_add_f32_dpp v6, v60, v60 row_ror:8 row_mask:0xf bank_mask:0x3
    v_add_f32_dpp v6, v61, v61 row_ror:8 row_mask:0xf bank_mask:0xc
    ds_write_b32 v254, v6 offset:39168
    s_waitcnt vmcnt(1)
    v_dot2c_f32_bf16 v68, v172, v14
    v_dot2c_f32_bf16 v69, v172, v15
    v_dot2c_f32_bf16 v70, v173, v14
    v_dot2c_f32_bf16 v71, v173, v15
    v_dot2c_f32_bf16 v72, v174, v14
    v_dot2c_f32_bf16 v73, v174, v15
    v_dot2c_f32_bf16 v74, v175, v14
    v_dot2c_f32_bf16 v75, v175, v15
    s_nop 2
    v_permlane32_swap_b32 v68, v72
    v_permlane32_swap_b32 v69, v73
    v_permlane32_swap_b32 v70, v74
    v_permlane32_swap_b32 v71, v75
    v_add_f32 v68, v68, v72
    v_add_f32 v69, v69, v73
    v_add_f32 v70, v70, v74
    v_add_f32 v71, v71, v75
    s_nop 0
    v_permlane16_swap_b32 v68, v70
    v_permlane16_swap_b32 v69, v71
    v_add_f32 v68, v68, v70
    v_add_f32 v69, v69, v71
    s_nop 0
    v_add_f32_dpp v7, v68, v68 row_ror:8 row_mask:0xf bank_mask:0x3
    v_add_f32_dpp v7, v69, v69 row_ror:8 row_mask:0xf bank_mask:0xc
    ds_write_b32 v254, v7 offset:39424
    s_waitcnt vmcnt(0)
    ds_read_b32 v5, v2 offset:4
    v_dot2c_f32_bf16 v76, v176, v14
    v_dot2c_f32_bf16 v77, v176, v15
    v_dot2c_f32_bf16 v78, v177, v14
    v_dot2c_f32_bf16 v79, v177, v15
    v_dot2c_f32_bf16 v80, v178, v14
    v_dot2c_f32_bf16 v81, v178, v15
    v_dot2c_f32_bf16 v82, v179, v14
    v_dot2c_f32_bf16 v83, v179, v15
    s_nop 2
    v_permlane32_swap_b32 v76, v80
    v_permlane32_swap_b32 v77, v81
    v_permlane32_swap_b32 v78, v82
    v_permlane32_swap_b32 v79, v83
    v_add_f32 v76, v76, v80
    v_add_f32 v77, v77, v81
    v_add_f32 v78, v78, v82
    v_add_f32 v79, v79, v83
    s_nop 0
    v_permlane16_swap_b32 v76, v78
    v_permlane16_swap_b32 v77, v79
    v_add_f32 v76, v76, v78
    v_add_f32 v77, v77, v79
    s_nop 0
    v_add_f32_dpp v8, v76, v76 row_ror:8 row_mask:0xf bank_mask:0x3
    v_add_f32_dpp v8, v77, v77 row_ror:8 row_mask:0xf bank_mask:0xc
    ds_write_b32 v254, v8 offset:39680
    s_mov_b64 exec, 1
    ds_add_u32 v2, v3 offset:60
    s_mov_b64 exec, -1
    s_cmp_lt_u32 s49, 10
    s_cbranch_scc0 L_sexit
    s_mov_b32 s57, 524288
L_lw150:
    ds_read_b32 v10, v2 offset:68
    s_waitcnt lgkmcnt(0)
    v_readfirstlane_b32 s52, v10
    s_cmp_ge_u32 s52, 6
    s_cbranch_scc1 L_lwok150
    s_sub_u32 s57, s57, 1
    s_cbranch_scc1 L_lwok150
    s_branch L_lw150
L_lwok150:
    s_mov_b32 s57, 524288
L_lw151:
    ds_read_b32 v10, v2 offset:28
    s_waitcnt lgkmcnt(0)
    v_readfirstlane_b32 s52, v10
    s_cmp_ge_u32 s52, 1
    s_cbranch_scc1 L_lwok151
    s_sub_u32 s57, s57, 1
    s_cbranch_scc1 L_lwok151
    s_branch L_lw151
L_lwok151:
    ds_read_b64 v[22:23], v19 offset:512
    ds_read_b64_tr_b16 v[84:85], v16 offset:0
    ds_read_b64_tr_b16 v[86:87], v16 offset:2048
    ds_read_b128 v[116:119], v17 offset:1024
    ds_read_b64_tr_b16 v[88:89], v16 offset:4096
    ds_read_b64_tr_b16 v[90:91], v16 offset:6144
    ds_read_b128 v[120:123], v17 offset:1088
    ds_read_b64_tr_b16 v[92:93], v16 offset:8192
    ds_read_b64_tr_b16 v[94:95], v16 offset:10240
    ds_read_b128 v[124:127], v17 offset:1152
    ds_read_b64_tr_b16 v[96:97], v16 offset:12288
    ds_read_b64_tr_b16 v[98:99], v16 offset:14336
    ds_read_b128 v[128:131], v17 offset:1216
    s_waitcnt lgkmcnt(9)
    v_mfma_f32_16x16x32_bf16 v[60:63], v[116:119], v[84:87], 0
    s_waitcnt lgkmcnt(6)
    v_mfma_f32_16x16x32_bf16 v[64:67], v[120:123], v[88:91], 0
    s_waitcnt lgkmcnt(3)
    v_mfma_f32_16x16x32_bf16 v[60:63], v[124:127], v[92:95], v[60:63]
    s_waitcnt lgkmcnt(0)
    v_mfma_f32_16x16x32_bf16 v[64:67], v[128:131], v[96:99], v[64:67]
    s_mov_b32 s57, 524288
L_lw152:
    ds_read_b32 v10, v2 offset:28
    s_waitcnt lgkmcnt(0)
    v_readfirstlane_b32 s52, v10
    s_cmp_ge_u32 s52, 2
    s_cbranch_scc1 L_lwok152
    s_sub_u32 s57, s57, 1
    s_cbranch_scc1 L_lwok152
    s_branch L_lw152
L_lwok152:
    ds_read_b64_tr_b16 v[100:101], v16 offset:16384
    ds_read_b64_tr_b16 v[102:103], v16 offset:18432
    ds_read_b64_tr_b16 v[104:105], v16 offset:20480
    ds_read_b64_tr_b16 v[106:107], v16 offset:22528
    ds_read_b64_tr_b16 v[108:109], v16 offset:24576
    ds_read_b64_tr_b16 v[110:111], v16 offset:26624
    ds_read_b64_tr_b16 v[112:113], v16 offset:28672
    ds_read_b64_tr_b16 v[114:115], v16 offset:30720
    s_barrier
    ds_read_b128 v[132:135], v17 offset:1280
    ds_read_b128 v[136:139], v17 offset:1344
    ds_read_b128 v[140:143], v17 offset:1408
    ds_read_b128 v[144:147], v17 offset:1472
    s_waitcnt lgkmcnt(3)
    v_mfma_f32_16x16x32_bf16 v[60:63], v[132:135], v[100:103], v[60:63]
    s_waitcnt lgkmcnt(2)
    v_mfma_f32_16x16x32_bf16 v[64:67], v[136:139], v[104:107], v[64:67]
    s_waitcnt lgkmcnt(1)
    v_mfma_f32_16x16x32_bf16 v[60:63], v[140:143], v[108:111], v[60:63]
    s_waitcnt lgkmcnt(0)
    v_mfma_f32_16x16x32_bf16 v[64:67], v[144:147], v[112:115], v[64:67]
    s_mov_b64 exec, 0xffff
    s_nop 6
    v_add_f32 v20, v60, v64
    v_add_f32 v21, v61, v65
    buffer_store_dwordx4 v[20:23], v18, s[40:43], s65 offen sc1
    s_mov_b64 exec, 1
    ds_add_u32 v2, v3 offset:64
    s_mov_b64 exec, -1
L_sexit:
    s_endpgm
L_end:
.section .rodata,"a"
.p2align 6
.amdhsa_kernel gated_mix__gqa_block_cached__dense_activation_mish__decode_kernel
  .amdhsa_next_free_vgpr 256
  .amdhsa_next_free_sgpr 100
  .amdhsa_accum_offset 256
  .amdhsa_group_segment_fixed_size 0
  .amdhsa_kernarg_size 104
  .amdhsa_user_sgpr_count 2
  .amdhsa_user_sgpr_kernarg_segment_ptr 1
  .amdhsa_system_sgpr_workgroup_id_x 1
  .amdhsa_float_denorm_mode_32 3
.end_amdhsa_kernel
```
